```python
import torch

def _softmax(x, axis=-1):
    return torch.softmax(x, dim=axis)
def _gelu(x):
    return torch.nn.functional.gelu(x, approximate="tanh")
def _silu(x):
    return torch.nn.functional.silu(x)
def _sigmoid(x):
    return torch.sigmoid(x)
def _layernorm(x, axis=-1, eps=1e-5):
    m = x.mean(dim=axis, keepdim=True)
    v = x.var(dim=axis, keepdim=True, unbiased=False)
    return (x - m) / torch.sqrt(v + eps)
def _scatter_add(tgt, idx, src, axis=0):
    return tgt.clone().index_add_(axis, idx, src)
def _segment_sum(src, seg, n):
    out = torch.zeros((n,) + src.shape[1:], dtype=src.dtype)
    return out.index_add_(0, seg, src)
def _pad(x, pw):
    flat = tuple(v for pair in reversed(pw) for v in pair)
    return torch.nn.functional.pad(x, flat)

kernel_name = 'gated_mix__spectral_fnet__grouped_kv_mqa__prompt'

def setup_inputs():

    _w = (lambda a: (lambda t: t.to(torch.bfloat16) if t.is_floating_point() else t)(torch.as_tensor(a)))
    def _A_setup():
        B, S, D = 1, 2048, 576
        ns = torch.arange(S)[:, None] * torch.arange(S)[None, :]
        nd = torch.arange(D)[:, None] * torch.arange(D)[None, :]
        Ws_re = torch.cos(-2.0 * torch.pi * ns / S).to(float)
        Ws_im = torch.sin(-2.0 * torch.pi * ns / S).to(float)
        Wd_re = torch.cos(-2.0 * torch.pi * nd / D).to(float)
        Wd_im = torch.sin(-2.0 * torch.pi * nd / D).to(float)
        return {
            "x": _w((lambda *s: torch.randn(*s, dtype=torch.bfloat16) * 0.05)(B, S, D)),
            "dft_seq_re": _w(Ws_re),
            "dft_seq_im": _w(Ws_im),
            "dft_hid_re": _w(Wd_re),
            "dft_hid_im": _w(Wd_im),
        }
    _A_in = _A_setup()

    def _B_setup():
        B, S, D, H = 1, 2048, 576, 32
        Dh = D // H
        return {
            "x": _w((lambda *s: torch.randn(*s, dtype=torch.bfloat16) * 0.05)(B, S, D)),
            "wq": _w((lambda *s: torch.randn(*s, dtype=torch.bfloat16) * 3.2)(D, H * Dh)),
            "wk": _w((lambda *s: torch.randn(*s, dtype=torch.bfloat16) * 3.2)(D, Dh)),
            "wv": _w((lambda *s: torch.randn(*s, dtype=torch.bfloat16) * 0.4)(D, Dh)),
            "wo": _w((lambda *s: torch.randn(*s, dtype=torch.bfloat16) * 0.4)(H * Dh, D)),
        }
    _B_in = _B_setup()

    return {
        "A_x": _A_in["x"],
        "A_dft_seq_re": _A_in["dft_seq_re"],
        "A_dft_seq_im": _A_in["dft_seq_im"],
        "A_dft_hid_re": _A_in["dft_hid_re"],
        "A_dft_hid_im": _A_in["dft_hid_im"],
        "B_x": _B_in["x"],
        "B_wq": _B_in["wq"],
        "B_wk": _B_in["wk"],
        "B_wv": _B_in["wv"],
        "B_wo": _B_in["wo"],
        "gate_w": _w((lambda *s: torch.randn(*s, dtype=torch.bfloat16) * 0.05)(576) * 16.0),
    }

def reference(A_x, A_dft_seq_re, A_dft_seq_im, A_dft_hid_re, A_dft_hid_im, B_x, B_wq, B_wk, B_wv, B_wo, gate_w):
    def _A_ref(x, dft_seq_re, dft_seq_im, dft_hid_re, dft_hid_im):
        a = torch.einsum("bsd,ed->bse", x, dft_hid_re)
        b = torch.einsum("bsd,ed->bse", x, dft_hid_im)
        y = torch.einsum("ts,bse->bte", dft_seq_re, a) - torch.einsum("ts,bse->bte", dft_seq_im, b)
        return y

    def _B_ref(x, wq, wk, wv, wo):
        B, S, D = x.shape
        H = 32
        Dh = D // H
        q = (lambda x, *d: x.permute(*d))((x @ wq).reshape(B, S, H, Dh), 0, 2, 1, 3)
        k = x @ wk
        v = x @ wv
        scores = torch.einsum("bhqd,bkd->bhqk", q, k) * (Dh ** -0.5)
        p = _softmax(scores, axis=-1)
        o = torch.einsum("bhqk,bkd->bhqd", p, v)
        return (lambda x, *d: x.permute(*d))(o, 0, 2, 1, 3).reshape(B, S, H * Dh) @ wo

    x = A_x
    g = _sigmoid((x * gate_w).sum(-1, keepdims=True))
    a = _A_ref(x, A_dft_seq_re, A_dft_seq_im, A_dft_hid_re, A_dft_hid_im)
    b = _B_ref(x, B_wq, B_wk, B_wv, B_wo)
    return g * a + (1 - g) * b
```

```asm
; @launch grid=(256,1,1) block=(768,1,1) lds=163840
.amdgcn_target "amdgcn-amd-amdhsa--gfx950"
.text
.globl gated_mix__spectral_fnet__grouped_kv_mqa__prompt_kernel
.p2align 12
.fill 832, 4, 0xbf810000
.p2align 8
.type gated_mix__spectral_fnet__grouped_kv_mqa__prompt_kernel,@function
gated_mix__spectral_fnet__grouped_kv_mqa__prompt_kernel:
    s_cmp_ge_u32 s2, 256
    s_cbranch_scc1 Lend
    s_load_dwordx16 s[16:31], s[0:1], 0
    s_load_dwordx8 s[32:39], s[0:1], 64
    s_load_dwordx4 s[40:43], s[0:1], 96
    v_cmp_gt_u32 vcc, 128, v0
    s_cbranch_vccz Lnopf
    s_getpc_b64 s[12:13]
Lpc:
    s_lshr_b32 s14, s2, 3
    s_lshl_b32 s14, s14, 11
    v_lshl_add_u32 v4, v0, 4, s14
    v_min_u32 v4, Lend-Lpc-12, v4
    global_load_dwordx4 v[120:123], v4, s[12:13]
Lnopf:
    v_lshrrev_b32 v2, 6, v0
    v_and_b32 v1, 63, v0
    v_readfirstlane_b32 s3, v2
    s_nop 0
    s_add_u32 s3, s3, 8
    s_cmp_ge_u32 s3, 12
    s_cselect_b32 s4, 12, 0
    s_sub_u32 s3, s3, s4
    v_mov_b32 v3, 0
    v_lshlrev_b32 v4, 2, v1
    v_add_u32 v4, 158208, v4
    s_and_b32 s4, s2, 7
    s_lshl_b32 s4, s4, 2
    s_bfe_u32 s5, s2, 0x20003
    s_add_u32 s4, s4, s5
    s_lshr_b32 s5, s2, 5
    s_mul_i32 s8, s4, 1
    s_add_u32 s8, s8, s5
    s_mul_i32 s10, s8, 7282
    s_lshr_b32 s10, s10, 16
    s_mul_i32 s10, s10, 9
    s_sub_u32 s8, s8, s10
    s_bfe_u32 s9, s2, 0x30003
    s_cmp_lg_u32 s3, 8
    s_cbranch_scc1 Lnoinit
    ds_write_b32 v4, v3
Lnoinit:
    v_mov_b32 v3, 158208
    s_cmp_ge_u32 s3, 8
    s_cbranch_scc0 Lroles
Lhelper:
    s_setprio 3
    s_sub_u32 s10, s3, 8
    s_movk_i32 s14, 1024
    s_cmp_eq_u32 s10, 1
    s_cselect_b32 s53, 2048, s14
    s_cselect_b32 s54, 1536, s14
    s_cmp_eq_u32 s10, 0
    s_cselect_b32 s53, 0, s53
    s_cselect_b32 s54, 0, s54
    s_cmp_eq_u32 s10, 3
    s_cselect_b32 s54, 512, s54
    s_add_u32 s14, s10, 1
    s_and_b32 s14, s14, 2
    s_sub_i32 s55, 1, s14
    s_lshl_b32 s52, s4, 4
    v_lshrrev_b32 v142, 3, v1
    v_lshrrev_b32 v5, 4, v1
    v_xor_b32 v140, v5, v1
    v_and_b32 v140, 7, v140
    v_lshlrev_b32 v140, 4, v140
    v_xor_b32 v141, 64, v140
    v_add_u32 v4, s52, v142
    v_mad_i32_i24 v7, v4, s55, 0
    v_add_u32 v7, s53, v7
    v_mov_b32 v6, s54
    v_cmp_eq_u32 vcc, 0, v4
    s_mul_i32 s12, s55, 9216
    s_nop 0
    v_cndmask_b32 v6, v7, v6, vcc
    v_mul_u32_u24 v6, 1152, v6
    v_mul_u32_u24 v7, 1152, v7
    v_add_u32 v104, v6, v140
    v_add3_u32 v105, v7, v141, s12
    s_cmp_lt_u32 s5, 3
    s_cselect_b32 s12, 0, 3
    s_sub_u32 s12, s5, s12
    s_lshl_b32 s12, s12, 4
    v_mul_u32_u24 v106, 36, v1
    v_add_u32 v106, s12, v106
    s_lshl_b32 s58, s10, 11
    s_mov_b32 s57, s8
    v_and_b32 v4, 15, v1
    v_lshrrev_b32 v6, 1, v4
    v_xor_b32 v6, v6, v5
    v_lshlrev_b32 v6, 4, v6
    v_lshl_add_u32 v6, v4, 7, v6
    v_add_u32 v6, s58, v6
    v_xor_b32 v7, 64, v6
    v_lshrrev_b32 v164, 2, v4
    v_lshl_add_u32 v164, v5, 3, v164
    v_lshlrev_b32 v160, 4, v164
    v_and_b32 v165, 1, v4
    v_lshl_add_u32 v160, v165, 3, v160
    v_add_u32 v160, 138240, v160
    s_lshr_b32 s13, s4, 1
    s_mul_i32 s56, s13, 9216
    s_add_u32 s56, s56, 458752
    s_and_b32 s13, s4, 1
    s_lshl_b32 s14, s13, 1
    s_lshr_b32 s59, s10, 1
    s_add_u32 s59, s59, s14
    s_lshl_b32 s13, s13, 2
    s_add_u32 s13, s13, s10
    s_mul_i32 s13, s13, 576
    s_lshl_b32 s14, s5, 7
    s_add_u32 s13, s13, s14
    s_add_u32 s60, s13, 3712
    s_lshl_b32 s13, s59, 10
    s_lshl_b32 s14, s5, 9
    s_add_u32 s13, s13, s14
    s_lshl_b32 s14, s59, 2
    s_add_u32 s14, s14, 8704
    s_cmp_eq_u32 s5, 2
    s_cselect_b32 s13, s14, s13
    s_cmp_ge_u32 s5, 3
    s_cselect_b32 s13, s60, s13
    s_add_u32 s56, s56, s13
    s_waitcnt lgkmcnt(0)
    s_mov_b32 s44, s42
    s_mov_b32 s45, s43
    s_mov_b32 s46, 7471104
    s_mov_b32 s47, 0x20000
    s_mov_b32 s92, s36
    s_mov_b32 s93, s37
    s_mov_b32 s94, 1152
    s_mov_b32 s95, 0x20000
    s_mov_b32 s48, s16
    s_mov_b32 s49, s17
    s_mov_b32 s50, 2359296
    s_mov_b32 s51, 0x20000
    s_cmp_ge_u32 s5, 6
    s_cbranch_scc1 Lnoex
    s_cmp_lt_u32 s5, 3
    s_cselect_b32 s92, s30, s32
    s_cselect_b32 s93, s31, s33
    s_mov_b32 s94, 20736
    s_mov_b32 s95, 0x20000
    s_lshl_b32 s13, s10, 10
    s_add_u32 s13, s13, 138240
    s_add_u32 s14, s10, s8
    s_cmp_ge_u32 s14, 9
    s_cselect_b32 s12, 9, 0
    s_sub_u32 s14, s14, s12
    s_mul_i32 s12, s14, 2304
    s_mov_b32 m0, s13
    s_nop 0
    buffer_load_dwordx4 v106, s[92:95], s12 offen lds
    s_add_u32 s13, s13, 4096
    s_add_u32 s14, s14, 4
    s_cmp_ge_u32 s14, 9
    s_cselect_b32 s12, 9, 0
    s_sub_u32 s14, s14, s12
    s_mul_i32 s12, s14, 2304
    s_mov_b32 m0, s13
    s_nop 0
    buffer_load_dwordx4 v106, s[92:95], s12 offen lds
    s_add_u32 s13, s13, 4096
    s_add_u32 s14, s14, 4
    s_cmp_eq_u32 s10, 0
    s_cbranch_scc0 Lnoex
    s_cmp_ge_u32 s14, 9
    s_cselect_b32 s12, 9, 0
    s_sub_u32 s14, s14, s12
    s_mul_i32 s12, s14, 2304
    s_mov_b32 m0, s13
    s_nop 0
    buffer_load_dwordx4 v106, s[92:95], s12 offen lds
Lnoex:
    s_lshl_b32 s12, s57, 7
    s_add_u32 m0, s58, 119808
    s_nop 0
    buffer_load_dwordx4 v104, s[48:51], s12 offen lds
    s_add_u32 m0, s58, 120832
    s_nop 0
    buffer_load_dwordx4 v105, s[48:51], s12 offen lds
    s_add_u32 s57, s57, 1
    s_cmp_eq_u32 s57, 9
    s_cselect_b32 s57, 0, s57
    s_lshl_b32 s12, s57, 7
    s_add_u32 m0, s58, 129024
    s_nop 0
    buffer_load_dwordx4 v104, s[48:51], s12 offen lds
    s_add_u32 m0, s58, 130048
    s_nop 0
    buffer_load_dwordx4 v105, s[48:51], s12 offen lds
    s_add_u32 s57, s57, 1
    s_cmp_eq_u32 s57, 9
    s_cselect_b32 s57, 0, s57
    s_lshl_b32 s12, s57, 7
    s_add_u32 m0, s58, 0
    s_nop 0
    buffer_load_dwordx4 v104, s[48:51], s12 offen lds
    s_add_u32 m0, s58, 1024
    s_nop 0
    buffer_load_dwordx4 v105, s[48:51], s12 offen lds
    s_add_u32 s57, s57, 1
    s_cmp_eq_u32 s57, 9
    s_cselect_b32 s57, 0, s57
    s_and_b32 s14, s10, 1
    s_lshl_b32 s14, s14, 4
    v_add_lshl_u32 v164, v4, s14, 4
    v_lshl_add_u32 v159, v5, 3, v164
    v_lshrrev_b32 v164, 1, v5
    v_mul_u32_u24 v164, 288, v164
    v_lshl_add_u32 v164, v4, 4, v164
    v_and_b32 v165, 1, v5
    v_lshl_add_u32 v164, v165, 3, v164
    s_cmp_ge_u32 s5, 3
    s_cselect_b64 vcc, -1, 0
    v_cndmask_b32 v159, v159, v164, vcc
    s_cmp_eq_u32 s5, 5
    s_cselect_b32 s13, 2, 8
    v_cmp_gt_u32 s[60:61], s13, v4
    s_lshl_b32 s12, s57, 7
    s_add_u32 m0, s58, 8192
    s_nop 0
    buffer_load_dwordx4 v104, s[48:51], s12 offen lds
    s_add_u32 m0, s58, 9216
    s_nop 0
    buffer_load_dwordx4 v105, s[48:51], s12 offen lds
    s_add_u32 s57, s57, 1
    s_cmp_eq_u32 s57, 9
    s_cselect_b32 s57, 0, s57
    v_add_u32 v164, 0, v1
    v_mul_u32_u24 v165, 7282, v164
    v_lshrrev_b32 v165, 16, v165
    v_mul_u32_u24 v166, 9, v165
    v_sub_u32 v166, v164, v166
    v_mad_u32_u24 v167, v165, 11, v166
    v_add_u32 v165, s52, v165
    v_mad_i32_i24 v144, v165, s55, 0
    v_add_u32 v144, s53, v144
    v_mov_b32 v164, s54
    v_cmp_eq_u32 vcc, 0, v165
    s_nop 1
    v_cndmask_b32 v144, v144, v164, vcc
    s_mul_i32 s13, s5, 9
    v_mul_u32_u24 v144, 72, v144
    v_add3_u32 v144, v144, v166, s13
    v_lshl_or_b32 v144, v167, 18, v144
    s_lshl_b32 s12, s57, 7
    s_add_u32 m0, s58, 16384
    s_nop 0
    buffer_load_dwordx4 v104, s[48:51], s12 offen lds
    s_add_u32 m0, s58, 17408
    s_nop 0
    buffer_load_dwordx4 v105, s[48:51], s12 offen lds
    s_add_u32 s57, s57, 1
    s_cmp_eq_u32 s57, 9
    s_cselect_b32 s57, 0, s57
    v_add_u32 v164, 64, v1
    v_mul_u32_u24 v165, 7282, v164
    v_lshrrev_b32 v165, 16, v165
    v_mul_u32_u24 v166, 9, v165
    v_sub_u32 v166, v164, v166
    v_mad_u32_u24 v167, v165, 11, v166
    v_add_u32 v165, s52, v165
    v_mad_i32_i24 v145, v165, s55, 0
    v_add_u32 v145, s53, v145
    v_mov_b32 v164, s54
    v_cmp_eq_u32 vcc, 0, v165
    s_nop 1
    v_cndmask_b32 v145, v145, v164, vcc
    s_mul_i32 s13, s5, 9
    v_mul_u32_u24 v145, 72, v145
    v_add3_u32 v145, v145, v166, s13
    v_lshl_or_b32 v145, v167, 18, v145
    s_lshl_b32 s12, s57, 7
    s_add_u32 m0, s58, 73728
    s_nop 0
    buffer_load_dwordx4 v104, s[48:51], s12 offen lds
    s_add_u32 m0, s58, 74752
    s_nop 0
    buffer_load_dwordx4 v105, s[48:51], s12 offen lds
    s_add_u32 s57, s57, 1
    s_cmp_eq_u32 s57, 9
    s_cselect_b32 s57, 0, s57
    v_add_u32 v164, 128, v1
    v_mul_u32_u24 v165, 7282, v164
    v_lshrrev_b32 v165, 16, v165
    v_mul_u32_u24 v166, 9, v165
    v_sub_u32 v166, v164, v166
    v_mad_u32_u24 v167, v165, 11, v166
    v_add_u32 v165, s52, v165
    v_mad_i32_i24 v146, v165, s55, 0
    v_add_u32 v146, s53, v146
    v_mov_b32 v164, s54
    v_cmp_eq_u32 vcc, 0, v165
    s_nop 1
    v_cndmask_b32 v146, v146, v164, vcc
    s_mul_i32 s13, s5, 9
    v_mul_u32_u24 v146, 72, v146
    v_add3_u32 v146, v146, v166, s13
    v_lshl_or_b32 v146, v167, 18, v146
    s_lshl_b32 s12, s57, 7
    s_add_u32 m0, s58, 81920
    s_nop 0
    buffer_load_dwordx4 v104, s[48:51], s12 offen lds
    s_add_u32 m0, s58, 82944
    s_nop 0
    buffer_load_dwordx4 v105, s[48:51], s12 offen lds
    s_add_u32 s57, s57, 1
    s_cmp_eq_u32 s57, 9
    s_cselect_b32 s57, 0, s57
    s_lshl_b32 s12, s57, 7
    s_add_u32 m0, s58, 90112
    s_nop 0
    buffer_load_dwordx4 v104, s[48:51], s12 offen lds
    s_add_u32 m0, s58, 91136
    s_nop 0
    buffer_load_dwordx4 v105, s[48:51], s12 offen lds
    s_add_u32 s57, s57, 1
    s_cmp_eq_u32 s57, 9
    s_cselect_b32 s57, 0, s57
    s_lshl_b32 s12, s57, 7
    s_add_u32 m0, s58, 147456
    s_nop 0
    buffer_load_dwordx4 v104, s[48:51], s12 offen lds
    s_add_u32 m0, s58, 148480
    s_nop 0
    buffer_load_dwordx4 v105, s[48:51], s12 offen lds
    buffer_load_dword v2, off, s[44:47], 0
    s_waitcnt vmcnt(19)
    s_barrier
    s_cmp_ge_u32 s5, 3
    s_cbranch_scc1 Lvpass
    v_add_u32 v6, 119808, v6
    v_add_u32 v7, 119808, v7
    ds_read_b64_tr_b16 v[80:81], v160 offset:0
    ds_read_b64_tr_b16 v[82:83], v160 offset:64
    ds_read_b64_tr_b16 v[84:85], v160 offset:512
    ds_read_b64_tr_b16 v[86:87], v160 offset:576
    s_waitcnt vmcnt(17)
    ds_read_b128 v[8:11], v6 offset:0
    ds_read_b128 v[12:15], v7 offset:0
    ds_read_b64_tr_b16 v[88:89], v160 offset:1024
    ds_read_b64_tr_b16 v[90:91], v160 offset:1088
    ds_read_b64_tr_b16 v[92:93], v160 offset:1536
    ds_read_b64_tr_b16 v[94:95], v160 offset:1600
    s_waitcnt vmcnt(15)
    ds_read_b128 v[16:19], v6 offset:9216
    ds_read_b128 v[20:23], v7 offset:9216
    v_add_u32 v6, 4294847488, v6
    v_add_u32 v7, 4294847488, v7
    ds_read_b64_tr_b16 v[96:97], v160 offset:2048
    ds_read_b64_tr_b16 v[98:99], v160 offset:2112
    ds_read_b64_tr_b16 v[100:101], v160 offset:2560
    ds_read_b64_tr_b16 v[102:103], v160 offset:2624
    s_waitcnt vmcnt(13)
    ds_read_b128 v[24:27], v6 offset:0
    ds_read_b128 v[28:31], v7 offset:0
    s_waitcnt lgkmcnt(12)
    v_mfma_f32_16x16x32_bf16 v[152:155], v[80:83], v[8:11], 0
    v_mfma_f32_16x16x32_bf16 v[152:155], v[84:87], v[12:15], v[152:155]
    ds_read_b64_tr_b16 v[80:81], v160 offset:3072
    ds_read_b64_tr_b16 v[82:83], v160 offset:3136
    ds_read_b64_tr_b16 v[84:85], v160 offset:3584
    ds_read_b64_tr_b16 v[86:87], v160 offset:3648
    s_waitcnt vmcnt(11)
    ds_read_b128 v[32:35], v6 offset:8192
    ds_read_b128 v[36:39], v7 offset:8192
    s_waitcnt lgkmcnt(12)
    v_mfma_f32_16x16x32_bf16 v[152:155], v[88:91], v[16:19], v[152:155]
    v_mfma_f32_16x16x32_bf16 v[152:155], v[92:95], v[20:23], v[152:155]
    ds_read_b64_tr_b16 v[88:89], v160 offset:4096
    ds_read_b64_tr_b16 v[90:91], v160 offset:4160
    ds_read_b64_tr_b16 v[92:93], v160 offset:4608
    ds_read_b64_tr_b16 v[94:95], v160 offset:4672
    s_waitcnt vmcnt(9)
    ds_read_b128 v[40:43], v6 offset:16384
    ds_read_b128 v[44:47], v7 offset:16384
    s_waitcnt lgkmcnt(12)
    v_mfma_f32_16x16x32_bf16 v[152:155], v[96:99], v[24:27], v[152:155]
    v_mfma_f32_16x16x32_bf16 v[152:155], v[100:103], v[28:31], v[152:155]
    v_add_u32 v6, 73728, v6
    v_add_u32 v7, 73728, v7
    ds_read_b64_tr_b16 v[96:97], v160 offset:5120
    ds_read_b64_tr_b16 v[98:99], v160 offset:5184
    ds_read_b64_tr_b16 v[100:101], v160 offset:5632
    ds_read_b64_tr_b16 v[102:103], v160 offset:5696
    s_waitcnt vmcnt(7)
    ds_read_b128 v[48:51], v6 offset:0
    ds_read_b128 v[52:55], v7 offset:0
    s_waitcnt lgkmcnt(12)
    v_mfma_f32_16x16x32_bf16 v[152:155], v[80:83], v[32:35], v[152:155]
    v_mfma_f32_16x16x32_bf16 v[152:155], v[84:87], v[36:39], v[152:155]
    ds_read_b64_tr_b16 v[80:81], v160 offset:6144
    ds_read_b64_tr_b16 v[82:83], v160 offset:6208
    ds_read_b64_tr_b16 v[84:85], v160 offset:6656
    ds_read_b64_tr_b16 v[86:87], v160 offset:6720
    s_waitcnt vmcnt(5)
    ds_read_b128 v[56:59], v6 offset:8192
    ds_read_b128 v[60:63], v7 offset:8192
    s_waitcnt lgkmcnt(12)
    v_mfma_f32_16x16x32_bf16 v[152:155], v[88:91], v[40:43], v[152:155]
    v_mfma_f32_16x16x32_bf16 v[152:155], v[92:95], v[44:47], v[152:155]
    ds_read_b64_tr_b16 v[88:89], v160 offset:7168
    ds_read_b64_tr_b16 v[90:91], v160 offset:7232
    ds_read_b64_tr_b16 v[92:93], v160 offset:7680
    ds_read_b64_tr_b16 v[94:95], v160 offset:7744
    s_waitcnt vmcnt(3)
    ds_read_b128 v[64:67], v6 offset:16384
    ds_read_b128 v[68:71], v7 offset:16384
    s_waitcnt lgkmcnt(12)
    v_mfma_f32_16x16x32_bf16 v[152:155], v[96:99], v[48:51], v[152:155]
    v_mfma_f32_16x16x32_bf16 v[152:155], v[100:103], v[52:55], v[152:155]
    v_add_u32 v6, 73728, v6
    v_add_u32 v7, 73728, v7
    ds_read_b64_tr_b16 v[96:97], v160 offset:8192
    ds_read_b64_tr_b16 v[98:99], v160 offset:8256
    ds_read_b64_tr_b16 v[100:101], v160 offset:8704
    ds_read_b64_tr_b16 v[102:103], v160 offset:8768
    s_waitcnt vmcnt(1)
    ds_read_b128 v[72:75], v6 offset:0
    ds_read_b128 v[76:79], v7 offset:0
    s_mov_b64 exec, 1
    v_mov_b32 v166, 1
    ds_add_u32 v3, v166 offset:56
    s_mov_b64 exec, -1
    s_waitcnt lgkmcnt(13)
    v_mfma_f32_16x16x32_bf16 v[152:155], v[80:83], v[56:59], v[152:155]
    v_mfma_f32_16x16x32_bf16 v[152:155], v[84:87], v[60:63], v[152:155]
    s_waitcnt lgkmcnt(7)
    v_mfma_f32_16x16x32_bf16 v[152:155], v[88:91], v[64:67], v[152:155]
    v_mfma_f32_16x16x32_bf16 v[152:155], v[92:95], v[68:71], v[152:155]
    s_waitcnt lgkmcnt(0)
    v_mfma_f32_16x16x32_bf16 v[152:155], v[96:99], v[72:75], v[152:155]
    v_mfma_f32_16x16x32_bf16 v[152:155], v[100:103], v[76:79], v[152:155]
    s_nop 7
    v_mul_f32 v152, 0x3eae1a93, v152
    v_mul_f32 v153, 0x3eae1a93, v153
    v_mul_f32 v154, 0x3eae1a93, v154
    v_mul_f32 v155, 0x3eae1a93, v155
    v_cvt_pk_bf16_f32 v152, v152, v153
    v_cvt_pk_bf16_f32 v153, v154, v155
    s_cmp_eq_u32 s5, 2
    s_cbranch_scc1 Lkb
    s_mov_b32 exec_hi, 0
    buffer_store_dwordx2 v[152:153], v159, s[44:47], s56 offen sc1
    s_mov_b64 exec, -1
    s_branch Lnokv
Lkb:
    s_mov_b64 exec, 0xffff
    buffer_store_dword v152, v159, s[44:47], s56 offen sc1
    s_mov_b64 exec, -1
    s_branch Lnokv
Lxonly:
    v_add_u32 v6, 119808, v6
    v_add_u32 v7, 119808, v7
    s_waitcnt vmcnt(17)
    ds_read_b128 v[8:11], v6 offset:0
    ds_read_b128 v[12:15], v7 offset:0
    s_waitcnt vmcnt(15)
    ds_read_b128 v[16:19], v6 offset:9216
    ds_read_b128 v[20:23], v7 offset:9216
    v_add_u32 v6, 4294847488, v6
    v_add_u32 v7, 4294847488, v7
    s_waitcnt vmcnt(13)
    ds_read_b128 v[24:27], v6 offset:0
    ds_read_b128 v[28:31], v7 offset:0
    s_waitcnt vmcnt(11)
    ds_read_b128 v[32:35], v6 offset:8192
    ds_read_b128 v[36:39], v7 offset:8192
    s_waitcnt vmcnt(9)
    ds_read_b128 v[40:43], v6 offset:16384
    ds_read_b128 v[44:47], v7 offset:16384
    v_add_u32 v6, 73728, v6
    v_add_u32 v7, 73728, v7
    s_waitcnt vmcnt(7)
    ds_read_b128 v[48:51], v6 offset:0
    ds_read_b128 v[52:55], v7 offset:0
    s_waitcnt vmcnt(5)
    ds_read_b128 v[56:59], v6 offset:8192
    ds_read_b128 v[60:63], v7 offset:8192
    s_waitcnt vmcnt(3)
    ds_read_b128 v[64:67], v6 offset:16384
    ds_read_b128 v[68:71], v7 offset:16384
    v_add_u32 v6, 73728, v6
    v_add_u32 v7, 73728, v7
    s_waitcnt vmcnt(1)
    ds_read_b128 v[72:75], v6 offset:0
    ds_read_b128 v[76:79], v7 offset:0
    s_mov_b64 exec, 1
    v_mov_b32 v166, 1
    ds_add_u32 v3, v166 offset:56
    s_mov_b64 exec, -1
    s_waitcnt lgkmcnt(0)
    s_branch Lnokv
Lvpass:
    s_cmp_ge_u32 s5, 6
    s_cbranch_scc1 Lxonly
    v_add_u32 v6, 119808, v6
    v_add_u32 v7, 119808, v7
    ds_read_b64_tr_b16 v[80:81], v160 offset:0
    ds_read_b64_tr_b16 v[82:83], v160 offset:64
    ds_read_b64_tr_b16 v[84:85], v160 offset:512
    ds_read_b64_tr_b16 v[86:87], v160 offset:576
    s_waitcnt vmcnt(17)
    ds_read_b128 v[8:11], v6 offset:0
    ds_read_b128 v[12:15], v7 offset:0
    ds_read_b64_tr_b16 v[88:89], v160 offset:1024
    ds_read_b64_tr_b16 v[90:91], v160 offset:1088
    ds_read_b64_tr_b16 v[92:93], v160 offset:1536
    ds_read_b64_tr_b16 v[94:95], v160 offset:1600
    s_waitcnt vmcnt(15)
    ds_read_b128 v[16:19], v6 offset:9216
    ds_read_b128 v[20:23], v7 offset:9216
    v_add_u32 v6, 4294847488, v6
    v_add_u32 v7, 4294847488, v7
    ds_read_b64_tr_b16 v[96:97], v160 offset:2048
    ds_read_b64_tr_b16 v[98:99], v160 offset:2112
    ds_read_b64_tr_b16 v[100:101], v160 offset:2560
    ds_read_b64_tr_b16 v[102:103], v160 offset:2624
    s_waitcnt vmcnt(13)
    ds_read_b128 v[24:27], v6 offset:0
    ds_read_b128 v[28:31], v7 offset:0
    s_waitcnt lgkmcnt(12)
    v_mfma_f32_16x16x32_bf16 v[152:155], v[8:11], v[80:83], 0
    v_mfma_f32_16x16x32_bf16 v[152:155], v[12:15], v[84:87], v[152:155]
    ds_read_b64_tr_b16 v[80:81], v160 offset:3072
    ds_read_b64_tr_b16 v[82:83], v160 offset:3136
    ds_read_b64_tr_b16 v[84:85], v160 offset:3584
    ds_read_b64_tr_b16 v[86:87], v160 offset:3648
    s_waitcnt vmcnt(11)
    ds_read_b128 v[32:35], v6 offset:8192
    ds_read_b128 v[36:39], v7 offset:8192
    s_waitcnt lgkmcnt(12)
    v_mfma_f32_16x16x32_bf16 v[152:155], v[16:19], v[88:91], v[152:155]
    v_mfma_f32_16x16x32_bf16 v[152:155], v[20:23], v[92:95], v[152:155]
    ds_read_b64_tr_b16 v[88:89], v160 offset:4096
    ds_read_b64_tr_b16 v[90:91], v160 offset:4160
    ds_read_b64_tr_b16 v[92:93], v160 offset:4608
    ds_read_b64_tr_b16 v[94:95], v160 offset:4672
    s_waitcnt vmcnt(9)
    ds_read_b128 v[40:43], v6 offset:16384
    ds_read_b128 v[44:47], v7 offset:16384
    s_waitcnt lgkmcnt(12)
    v_mfma_f32_16x16x32_bf16 v[152:155], v[24:27], v[96:99], v[152:155]
    v_mfma_f32_16x16x32_bf16 v[152:155], v[28:31], v[100:103], v[152:155]
    v_add_u32 v6, 73728, v6
    v_add_u32 v7, 73728, v7
    ds_read_b64_tr_b16 v[96:97], v160 offset:5120
    ds_read_b64_tr_b16 v[98:99], v160 offset:5184
    ds_read_b64_tr_b16 v[100:101], v160 offset:5632
    ds_read_b64_tr_b16 v[102:103], v160 offset:5696
    s_waitcnt vmcnt(7)
    ds_read_b128 v[48:51], v6 offset:0
    ds_read_b128 v[52:55], v7 offset:0
    s_waitcnt lgkmcnt(12)
    v_mfma_f32_16x16x32_bf16 v[152:155], v[32:35], v[80:83], v[152:155]
    v_mfma_f32_16x16x32_bf16 v[152:155], v[36:39], v[84:87], v[152:155]
    ds_read_b64_tr_b16 v[80:81], v160 offset:6144
    ds_read_b64_tr_b16 v[82:83], v160 offset:6208
    ds_read_b64_tr_b16 v[84:85], v160 offset:6656
    ds_read_b64_tr_b16 v[86:87], v160 offset:6720
    s_waitcnt vmcnt(5)
    ds_read_b128 v[56:59], v6 offset:8192
    ds_read_b128 v[60:63], v7 offset:8192
    s_waitcnt lgkmcnt(12)
    v_mfma_f32_16x16x32_bf16 v[152:155], v[40:43], v[88:91], v[152:155]
    v_mfma_f32_16x16x32_bf16 v[152:155], v[44:47], v[92:95], v[152:155]
    ds_read_b64_tr_b16 v[88:89], v160 offset:7168
    ds_read_b64_tr_b16 v[90:91], v160 offset:7232
    ds_read_b64_tr_b16 v[92:93], v160 offset:7680
    ds_read_b64_tr_b16 v[94:95], v160 offset:7744
    s_waitcnt vmcnt(3)
    ds_read_b128 v[64:67], v6 offset:16384
    ds_read_b128 v[68:71], v7 offset:16384
    s_waitcnt lgkmcnt(12)
    v_mfma_f32_16x16x32_bf16 v[152:155], v[48:51], v[96:99], v[152:155]
    v_mfma_f32_16x16x32_bf16 v[152:155], v[52:55], v[100:103], v[152:155]
    v_add_u32 v6, 73728, v6
    v_add_u32 v7, 73728, v7
    ds_read_b64_tr_b16 v[96:97], v160 offset:8192
    ds_read_b64_tr_b16 v[98:99], v160 offset:8256
    ds_read_b64_tr_b16 v[100:101], v160 offset:8704
    ds_read_b64_tr_b16 v[102:103], v160 offset:8768
    s_waitcnt vmcnt(1)
    ds_read_b128 v[72:75], v6 offset:0
    ds_read_b128 v[76:79], v7 offset:0
    s_mov_b64 exec, 1
    v_mov_b32 v166, 1
    ds_add_u32 v3, v166 offset:56
    s_mov_b64 exec, -1
    s_waitcnt lgkmcnt(13)
    v_mfma_f32_16x16x32_bf16 v[152:155], v[56:59], v[80:83], v[152:155]
    v_mfma_f32_16x16x32_bf16 v[152:155], v[60:63], v[84:87], v[152:155]
    s_waitcnt lgkmcnt(7)
    v_mfma_f32_16x16x32_bf16 v[152:155], v[64:67], v[88:91], v[152:155]
    v_mfma_f32_16x16x32_bf16 v[152:155], v[68:71], v[92:95], v[152:155]
    s_waitcnt lgkmcnt(0)
    v_mfma_f32_16x16x32_bf16 v[152:155], v[72:75], v[96:99], v[152:155]
    v_mfma_f32_16x16x32_bf16 v[152:155], v[76:79], v[100:103], v[152:155]
    s_nop 7
    v_mul_f32 v152, 0x4b800000, v152
    v_mul_f32 v153, 0x4b800000, v153
    v_mul_f32 v154, 0x4b800000, v154
    v_mul_f32 v155, 0x4b800000, v155
    v_cvt_pk_bf16_f32 v152, v152, v153
    v_cvt_pk_bf16_f32 v153, v154, v155
    s_mov_b64 exec, s[60:61]
    buffer_store_dwordx2 v[152:153], v159, s[44:47], s56 offen sc1
    s_mov_b64 exec, -1
Lnokv:
    s_mov_b64 exec, 1
    v_mov_b32 v166, 1
    ds_add_u32 v3, v166 offset:60
    s_mov_b64 exec, -1
    v_lshlrev_b32 v161, 4, v5
    v_add_u32 v161, 158464, v161
    v_lshrrev_b32 v164, 2, v4
    v_lshlrev_b32 v164, 1, v164
    v_lshl_add_u32 v164, v5, 3, v164
    v_mul_u32_u24 v164, 144, v164
    v_and_b32 v165, 3, v4
    v_lshl_add_u32 v157, v165, 3, v164
    v_add_u32 v148, 27648, v157
    v_add_u32 v149, 101376, v157
    v_lshlrev_b32 v162, 4, v1
    s_lshl_b32 s13, s10, 4
    v_add_u32 v164, s13, v4
    v_mul_u32_u24 v164, 168, v164
    v_lshl_add_u32 v164, v5, 3, v164
    v_add_u32 v158, 147456, v164
    v_add_u32 v164, s52, v4
    v_mad_i32_i24 v156, v164, s55, 0
    v_add_u32 v156, s53, v156
    v_mov_b32 v165, s54
    v_cmp_eq_u32 vcc, 0, v164
    s_lshl_b32 s13, s10, 2
    v_add_u32 v163, s13, v3
    v_cndmask_b32 v156, v156, v165, vcc
    s_mov_b32 s15, 200000
Lspin_1:
    ds_read_b32 v164, v3 offset:108
    s_waitcnt lgkmcnt(0)
    v_readfirstlane_b32 s14, v164
    s_nop 0
    s_cmp_ge_u32 s14, 2
    s_cbranch_scc1 Lsd_2
    s_sleep 0
    s_sub_u32 s15, s15, 1
    s_cbranch_scc0 Lspin_1
Lsd_2:
    ds_read_b128 v[80:83], v161 offset:0
    ds_read_b128 v[84:87], v161 offset:64
    ds_read_b128 v[88:91], v161 offset:128
    ds_read_b128 v[92:95], v161 offset:192
    ds_read_b128 v[96:99], v161 offset:256
    ds_read_b128 v[100:103], v161 offset:320
    ds_read_b128 v[104:107], v161 offset:384
    ds_read_b128 v[108:111], v161 offset:448
    ds_read_b128 v[112:115], v161 offset:512
    ds_read_b128 v[116:119], v161 offset:576
    ds_read_b128 v[120:123], v161 offset:640
    ds_read_b128 v[124:127], v161 offset:704
    s_waitcnt lgkmcnt(11)
    v_mfma_f32_16x16x32_bf16 v[152:155], v[80:83], v[8:11], 0
    ds_read_b128 v[80:83], v161 offset:768
    s_waitcnt lgkmcnt(11)
    v_mfma_f32_16x16x32_bf16 v[152:155], v[84:87], v[12:15], v[152:155]
    ds_read_b128 v[84:87], v161 offset:832
    s_waitcnt lgkmcnt(11)
    v_mfma_f32_16x16x32_bf16 v[152:155], v[88:91], v[16:19], v[152:155]
    ds_read_b128 v[88:91], v161 offset:896
    s_waitcnt lgkmcnt(11)
    v_mfma_f32_16x16x32_bf16 v[152:155], v[92:95], v[20:23], v[152:155]
    ds_read_b128 v[92:95], v161 offset:960
    s_waitcnt lgkmcnt(11)
    v_mfma_f32_16x16x32_bf16 v[152:155], v[96:99], v[24:27], v[152:155]
    ds_read_b128 v[96:99], v161 offset:1024
    s_waitcnt lgkmcnt(11)
    v_mfma_f32_16x16x32_bf16 v[152:155], v[100:103], v[28:31], v[152:155]
    ds_read_b128 v[100:103], v161 offset:1088
    s_waitcnt lgkmcnt(11)
    v_mfma_f32_16x16x32_bf16 v[152:155], v[104:107], v[32:35], v[152:155]
    s_waitcnt lgkmcnt(10)
    v_mfma_f32_16x16x32_bf16 v[152:155], v[108:111], v[36:39], v[152:155]
    s_waitcnt lgkmcnt(9)
    v_mfma_f32_16x16x32_bf16 v[152:155], v[112:115], v[40:43], v[152:155]
    s_waitcnt lgkmcnt(8)
    v_mfma_f32_16x16x32_bf16 v[152:155], v[116:119], v[44:47], v[152:155]
    s_waitcnt lgkmcnt(7)
    v_mfma_f32_16x16x32_bf16 v[152:155], v[120:123], v[48:51], v[152:155]
    s_waitcnt lgkmcnt(6)
    v_mfma_f32_16x16x32_bf16 v[152:155], v[124:127], v[52:55], v[152:155]
    s_waitcnt lgkmcnt(5)
    v_mfma_f32_16x16x32_bf16 v[152:155], v[80:83], v[56:59], v[152:155]
    s_waitcnt lgkmcnt(4)
    v_mfma_f32_16x16x32_bf16 v[152:155], v[84:87], v[60:63], v[152:155]
    s_waitcnt lgkmcnt(3)
    v_mfma_f32_16x16x32_bf16 v[152:155], v[88:91], v[64:67], v[152:155]
    s_waitcnt lgkmcnt(2)
    v_mfma_f32_16x16x32_bf16 v[152:155], v[92:95], v[68:71], v[152:155]
    s_waitcnt lgkmcnt(1)
    v_mfma_f32_16x16x32_bf16 v[152:155], v[96:99], v[72:75], v[152:155]
    s_waitcnt lgkmcnt(0)
    v_mfma_f32_16x16x32_bf16 v[152:155], v[100:103], v[76:79], v[152:155]
    s_waitcnt vmcnt(0)
    v_readfirstlane_b32 s6, v2
    s_nop 0
    s_mul_i32 s6, s6, 1664525
    s_add_u32 s6, s6, 1013904223
    s_not_b32 s7, s6
    s_cmp_ge_u32 s5, 6
    s_cbranch_scc1 Lnofk
    s_waitcnt vmcnt(0)
    s_mov_b64 exec, 1
    v_mov_b32 v164, 1
    ds_add_rtn_u32 v164, v3, v164 offset:4
    s_mov_b64 exec, -1
    s_waitcnt lgkmcnt(0)
    v_readfirstlane_b32 s14, v164
    s_nop 0
    s_cmp_eq_u32 s14, 3
    s_cbranch_scc0 Lnf_3
    s_mul_i32 s13, s4, 6
    s_add_u32 s13, s13, s5
    s_add_u32 s13, s13, 0
    s_lshl_b32 s14, s13, 7
    s_add_u32 s14, s14, 4096
    s_mov_b64 exec, 1
    v_mov_b32 v164, s6
    v_mov_b32 v165, s7
    buffer_store_dwordx2 v[164:165], off, s[44:47], s14 sc1
    s_mov_b64 exec, -1
Lnf_3:
Lnofk:
    s_mov_b32 s58, 0
    s_cmp_ge_u32 s58, 2
    s_cbranch_scc1 Lpg_4
    s_mov_b32 s15, 200000
Lpl_5:
    ds_read_b128 v[164:167], v3 offset:80
    s_waitcnt lgkmcnt(0)
    v_min3_u32 v164, v164, v165, v166
    v_min_u32 v164, v164, v167
    s_nop 0
    v_readfirstlane_b32 s58, v164
    s_nop 0
    s_cmp_ge_u32 s58, 2
    s_cbranch_scc1 Lpg_4
    s_sub_u32 s15, s15, 1
    s_cbranch_scc0 Lpl_5
Lpg_4:
    ds_read_b64_tr_b16 v[80:81], v148 offset:0
    ds_read_b64_tr_b16 v[82:83], v148 offset:144
    ds_read_b64_tr_b16 v[84:85], v148 offset:32
    ds_read_b64_tr_b16 v[86:87], v148 offset:176
    ds_read_b64_tr_b16 v[88:89], v148 offset:64
    ds_read_b64_tr_b16 v[90:91], v148 offset:208
    ds_read_b64_tr_b16 v[92:93], v148 offset:96
    ds_read_b64_tr_b16 v[94:95], v148 offset:240
    ds_read_b64_tr_b16 v[96:97], v148 offset:128
    ds_read_b64_tr_b16 v[98:99], v148 offset:272
    s_waitcnt lgkmcnt(8)
    v_mfma_f32_16x16x32_bf16 v[120:123], v[80:83], v[8:11], 0
    ds_read_b64_tr_b16 v[100:101], v148 offset:4608
    ds_read_b64_tr_b16 v[102:103], v148 offset:4752
    s_waitcnt lgkmcnt(8)
    v_mfma_f32_16x16x32_bf16 v[124:127], v[84:87], v[8:11], 0
    ds_read_b64_tr_b16 v[104:105], v148 offset:4640
    ds_read_b64_tr_b16 v[106:107], v148 offset:4784
    s_waitcnt lgkmcnt(8)
    v_mfma_f32_16x16x32_bf16 v[128:131], v[88:91], v[8:11], 0
    ds_read_b64_tr_b16 v[108:109], v148 offset:4672
    ds_read_b64_tr_b16 v[110:111], v148 offset:4816
    s_waitcnt lgkmcnt(8)
    v_mfma_f32_16x16x32_bf16 v[132:135], v[92:95], v[8:11], 0
    ds_read_b64_tr_b16 v[112:113], v148 offset:4704
    ds_read_b64_tr_b16 v[114:115], v148 offset:4848
    s_waitcnt lgkmcnt(8)
    v_mfma_f32_16x16x32_bf16 v[136:139], v[96:99], v[8:11], 0
    ds_read_b64_tr_b16 v[116:117], v148 offset:4736
    ds_read_b64_tr_b16 v[118:119], v148 offset:4880
    s_waitcnt lgkmcnt(8)
    v_mfma_f32_16x16x32_bf16 v[120:123], v[100:103], v[12:15], v[120:123]
    ds_read_b64_tr_b16 v[80:81], v148 offset:9216
    ds_read_b64_tr_b16 v[82:83], v148 offset:9360
    s_waitcnt lgkmcnt(8)
    v_mfma_f32_16x16x32_bf16 v[124:127], v[104:107], v[12:15], v[124:127]
    ds_read_b64_tr_b16 v[84:85], v148 offset:9248
    ds_read_b64_tr_b16 v[86:87], v148 offset:9392
    s_waitcnt lgkmcnt(8)
    v_mfma_f32_16x16x32_bf16 v[128:131], v[108:111], v[12:15], v[128:131]
    ds_read_b64_tr_b16 v[88:89], v148 offset:9280
    ds_read_b64_tr_b16 v[90:91], v148 offset:9424
    s_waitcnt lgkmcnt(8)
    v_mfma_f32_16x16x32_bf16 v[132:135], v[112:115], v[12:15], v[132:135]
    ds_read_b64_tr_b16 v[92:93], v148 offset:9312
    ds_read_b64_tr_b16 v[94:95], v148 offset:9456
    s_waitcnt lgkmcnt(8)
    v_mfma_f32_16x16x32_bf16 v[136:139], v[116:119], v[12:15], v[136:139]
    ds_read_b64_tr_b16 v[96:97], v148 offset:9344
    ds_read_b64_tr_b16 v[98:99], v148 offset:9488
    s_waitcnt lgkmcnt(8)
    v_mfma_f32_16x16x32_bf16 v[120:123], v[80:83], v[16:19], v[120:123]
    ds_read_b128 v[164:167], v3 offset:80
    ds_read_b64_tr_b16 v[100:101], v148 offset:13824
    ds_read_b64_tr_b16 v[102:103], v148 offset:13968
    s_waitcnt lgkmcnt(8)
    v_mfma_f32_16x16x32_bf16 v[124:127], v[84:87], v[16:19], v[124:127]
    ds_read_b64_tr_b16 v[104:105], v148 offset:13856
    ds_read_b64_tr_b16 v[106:107], v148 offset:14000
    s_waitcnt lgkmcnt(8)
    v_mfma_f32_16x16x32_bf16 v[128:131], v[88:91], v[16:19], v[128:131]
    ds_read_b64_tr_b16 v[108:109], v148 offset:13888
    ds_read_b64_tr_b16 v[110:111], v148 offset:14032
    s_waitcnt lgkmcnt(8)
    v_mfma_f32_16x16x32_bf16 v[132:135], v[92:95], v[16:19], v[132:135]
    ds_read_b64_tr_b16 v[112:113], v148 offset:13920
    ds_read_b64_tr_b16 v[114:115], v148 offset:14064
    s_waitcnt lgkmcnt(8)
    v_mfma_f32_16x16x32_bf16 v[136:139], v[96:99], v[16:19], v[136:139]
    ds_read_b64_tr_b16 v[116:117], v148 offset:13952
    ds_read_b64_tr_b16 v[118:119], v148 offset:14096
    s_waitcnt lgkmcnt(8)
    v_mfma_f32_16x16x32_bf16 v[120:123], v[100:103], v[20:23], v[120:123]
    v_min3_u32 v164, v164, v165, v166
    v_min_u32 v164, v164, v167
    s_nop 0
    v_readfirstlane_b32 s58, v164
    s_nop 0
    s_cmp_ge_u32 s58, 4
    s_cbranch_scc1 Lpg_6
    s_mov_b32 s15, 200000
Lpl_7:
    ds_read_b128 v[164:167], v3 offset:80
    s_waitcnt lgkmcnt(0)
    v_min3_u32 v164, v164, v165, v166
    v_min_u32 v164, v164, v167
    s_nop 0
    v_readfirstlane_b32 s58, v164
    s_nop 0
    s_cmp_ge_u32 s58, 4
    s_cbranch_scc1 Lpg_6
    s_sub_u32 s15, s15, 1
    s_cbranch_scc0 Lpl_7
Lpg_6:
    ds_read_b64_tr_b16 v[80:81], v148 offset:18432
    ds_read_b64_tr_b16 v[82:83], v148 offset:18576
    s_waitcnt lgkmcnt(8)
    v_mfma_f32_16x16x32_bf16 v[124:127], v[104:107], v[20:23], v[124:127]
    ds_read_b64_tr_b16 v[84:85], v148 offset:18464
    ds_read_b64_tr_b16 v[86:87], v148 offset:18608
    s_waitcnt lgkmcnt(8)
    v_mfma_f32_16x16x32_bf16 v[128:131], v[108:111], v[20:23], v[128:131]
    ds_read_b64_tr_b16 v[88:89], v148 offset:18496
    ds_read_b64_tr_b16 v[90:91], v148 offset:18640
    s_waitcnt lgkmcnt(8)
    v_mfma_f32_16x16x32_bf16 v[132:135], v[112:115], v[20:23], v[132:135]
    ds_read_b64_tr_b16 v[92:93], v148 offset:18528
    ds_read_b64_tr_b16 v[94:95], v148 offset:18672
    s_waitcnt lgkmcnt(8)
    v_mfma_f32_16x16x32_bf16 v[136:139], v[116:119], v[20:23], v[136:139]
    ds_read_b64_tr_b16 v[96:97], v148 offset:18560
    ds_read_b64_tr_b16 v[98:99], v148 offset:18704
    s_waitcnt lgkmcnt(8)
    v_mfma_f32_16x16x32_bf16 v[120:123], v[80:83], v[24:27], v[120:123]
    ds_read_b64_tr_b16 v[100:101], v148 offset:23040
    ds_read_b64_tr_b16 v[102:103], v148 offset:23184
    s_waitcnt lgkmcnt(8)
    v_mfma_f32_16x16x32_bf16 v[124:127], v[84:87], v[24:27], v[124:127]
    ds_read_b64_tr_b16 v[104:105], v148 offset:23072
    ds_read_b64_tr_b16 v[106:107], v148 offset:23216
    s_waitcnt lgkmcnt(8)
    v_mfma_f32_16x16x32_bf16 v[128:131], v[88:91], v[24:27], v[128:131]
    ds_read_b64_tr_b16 v[108:109], v148 offset:23104
    ds_read_b64_tr_b16 v[110:111], v148 offset:23248
    s_waitcnt lgkmcnt(8)
    v_mfma_f32_16x16x32_bf16 v[132:135], v[92:95], v[24:27], v[132:135]
    ds_read_b64_tr_b16 v[112:113], v148 offset:23136
    ds_read_b64_tr_b16 v[114:115], v148 offset:23280
    s_waitcnt lgkmcnt(8)
    v_mfma_f32_16x16x32_bf16 v[136:139], v[96:99], v[24:27], v[136:139]
    ds_read_b64_tr_b16 v[116:117], v148 offset:23168
    ds_read_b64_tr_b16 v[118:119], v148 offset:23312
    s_waitcnt lgkmcnt(8)
    v_mfma_f32_16x16x32_bf16 v[120:123], v[100:103], v[28:31], v[120:123]
    ds_read_b64_tr_b16 v[80:81], v148 offset:27648
    ds_read_b64_tr_b16 v[82:83], v148 offset:27792
    s_waitcnt lgkmcnt(8)
    v_mfma_f32_16x16x32_bf16 v[124:127], v[104:107], v[28:31], v[124:127]
    ds_read_b64_tr_b16 v[84:85], v148 offset:27680
    ds_read_b64_tr_b16 v[86:87], v148 offset:27824
    s_waitcnt lgkmcnt(8)
    v_mfma_f32_16x16x32_bf16 v[128:131], v[108:111], v[28:31], v[128:131]
    ds_read_b64_tr_b16 v[88:89], v148 offset:27712
    ds_read_b64_tr_b16 v[90:91], v148 offset:27856
    s_waitcnt lgkmcnt(8)
    v_mfma_f32_16x16x32_bf16 v[132:135], v[112:115], v[28:31], v[132:135]
    ds_read_b64_tr_b16 v[92:93], v148 offset:27744
    ds_read_b64_tr_b16 v[94:95], v148 offset:27888
    s_waitcnt lgkmcnt(8)
    v_mfma_f32_16x16x32_bf16 v[136:139], v[116:119], v[28:31], v[136:139]
    ds_read_b64_tr_b16 v[96:97], v148 offset:27776
    ds_read_b64_tr_b16 v[98:99], v148 offset:27920
    s_waitcnt lgkmcnt(8)
    v_mfma_f32_16x16x32_bf16 v[120:123], v[80:83], v[32:35], v[120:123]
    ds_read_b128 v[164:167], v3 offset:80
    ds_read_b64_tr_b16 v[100:101], v148 offset:32256
    ds_read_b64_tr_b16 v[102:103], v148 offset:32400
    s_waitcnt lgkmcnt(8)
    v_mfma_f32_16x16x32_bf16 v[124:127], v[84:87], v[32:35], v[124:127]
    ds_read_b64_tr_b16 v[104:105], v148 offset:32288
    ds_read_b64_tr_b16 v[106:107], v148 offset:32432
    s_waitcnt lgkmcnt(8)
    v_mfma_f32_16x16x32_bf16 v[128:131], v[88:91], v[32:35], v[128:131]
    ds_read_b64_tr_b16 v[108:109], v148 offset:32320
    ds_read_b64_tr_b16 v[110:111], v148 offset:32464
    s_waitcnt lgkmcnt(8)
    v_mfma_f32_16x16x32_bf16 v[132:135], v[92:95], v[32:35], v[132:135]
    ds_read_b64_tr_b16 v[112:113], v148 offset:32352
    ds_read_b64_tr_b16 v[114:115], v148 offset:32496
    s_waitcnt lgkmcnt(8)
    v_mfma_f32_16x16x32_bf16 v[136:139], v[96:99], v[32:35], v[136:139]
    ds_read_b64_tr_b16 v[116:117], v148 offset:32384
    ds_read_b64_tr_b16 v[118:119], v148 offset:32528
    s_waitcnt lgkmcnt(8)
    v_mfma_f32_16x16x32_bf16 v[120:123], v[100:103], v[36:39], v[120:123]
    v_min3_u32 v164, v164, v165, v166
    v_min_u32 v164, v164, v167
    s_nop 0
    v_readfirstlane_b32 s58, v164
    s_nop 0
    s_cmp_ge_u32 s58, 5
    s_cbranch_scc1 Lpg_8
    s_mov_b32 s15, 200000
Lpl_9:
    ds_read_b128 v[164:167], v3 offset:80
    s_waitcnt lgkmcnt(0)
    v_min3_u32 v164, v164, v165, v166
    v_min_u32 v164, v164, v167
    s_nop 0
    v_readfirstlane_b32 s58, v164
    s_nop 0
    s_cmp_ge_u32 s58, 5
    s_cbranch_scc1 Lpg_8
    s_sub_u32 s15, s15, 1
    s_cbranch_scc0 Lpl_9
Lpg_8:
    ds_read_b64_tr_b16 v[80:81], v148 offset:36864
    ds_read_b64_tr_b16 v[82:83], v148 offset:37008
    s_waitcnt lgkmcnt(8)
    v_mfma_f32_16x16x32_bf16 v[124:127], v[104:107], v[36:39], v[124:127]
    ds_read_b64_tr_b16 v[84:85], v148 offset:36896
    ds_read_b64_tr_b16 v[86:87], v148 offset:37040
    s_waitcnt lgkmcnt(8)
    v_mfma_f32_16x16x32_bf16 v[128:131], v[108:111], v[36:39], v[128:131]
    ds_read_b64_tr_b16 v[88:89], v148 offset:36928
    ds_read_b64_tr_b16 v[90:91], v148 offset:37072
    s_waitcnt lgkmcnt(8)
    v_mfma_f32_16x16x32_bf16 v[132:135], v[112:115], v[36:39], v[132:135]
    ds_read_b64_tr_b16 v[92:93], v148 offset:36960
    ds_read_b64_tr_b16 v[94:95], v148 offset:37104
    s_waitcnt lgkmcnt(8)
    v_mfma_f32_16x16x32_bf16 v[136:139], v[116:119], v[36:39], v[136:139]
    ds_read_b64_tr_b16 v[96:97], v148 offset:36992
    ds_read_b64_tr_b16 v[98:99], v148 offset:37136
    s_waitcnt lgkmcnt(8)
    v_mfma_f32_16x16x32_bf16 v[120:123], v[80:83], v[40:43], v[120:123]
    ds_read_b128 v[164:167], v3 offset:80
    ds_read_b64_tr_b16 v[100:101], v148 offset:41472
    ds_read_b64_tr_b16 v[102:103], v148 offset:41616
    s_waitcnt lgkmcnt(8)
    v_mfma_f32_16x16x32_bf16 v[124:127], v[84:87], v[40:43], v[124:127]
    ds_read_b64_tr_b16 v[104:105], v148 offset:41504
    ds_read_b64_tr_b16 v[106:107], v148 offset:41648
    s_waitcnt lgkmcnt(8)
    v_mfma_f32_16x16x32_bf16 v[128:131], v[88:91], v[40:43], v[128:131]
    ds_read_b64_tr_b16 v[108:109], v148 offset:41536
    ds_read_b64_tr_b16 v[110:111], v148 offset:41680
    s_waitcnt lgkmcnt(8)
    v_mfma_f32_16x16x32_bf16 v[132:135], v[92:95], v[40:43], v[132:135]
    ds_read_b64_tr_b16 v[112:113], v148 offset:41568
    ds_read_b64_tr_b16 v[114:115], v148 offset:41712
    s_waitcnt lgkmcnt(8)
    v_mfma_f32_16x16x32_bf16 v[136:139], v[96:99], v[40:43], v[136:139]
    ds_read_b64_tr_b16 v[116:117], v148 offset:41600
    ds_read_b64_tr_b16 v[118:119], v148 offset:41744
    s_waitcnt lgkmcnt(8)
    v_mfma_f32_16x16x32_bf16 v[120:123], v[100:103], v[44:47], v[120:123]
    v_min3_u32 v164, v164, v165, v166
    v_min_u32 v164, v164, v167
    s_nop 0
    v_readfirstlane_b32 s58, v164
    s_nop 0
    s_cmp_ge_u32 s58, 6
    s_cbranch_scc1 Lpg_10
    s_mov_b32 s15, 200000
Lpl_11:
    ds_read_b128 v[164:167], v3 offset:80
    s_waitcnt lgkmcnt(0)
    v_min3_u32 v164, v164, v165, v166
    v_min_u32 v164, v164, v167
    s_nop 0
    v_readfirstlane_b32 s58, v164
    s_nop 0
    s_cmp_ge_u32 s58, 6
    s_cbranch_scc1 Lpg_10
    s_sub_u32 s15, s15, 1
    s_cbranch_scc0 Lpl_11
Lpg_10:
    ds_read_b64_tr_b16 v[80:81], v149 offset:0
    ds_read_b64_tr_b16 v[82:83], v149 offset:144
    s_waitcnt lgkmcnt(8)
    v_mfma_f32_16x16x32_bf16 v[124:127], v[104:107], v[44:47], v[124:127]
    ds_read_b64_tr_b16 v[84:85], v149 offset:32
    ds_read_b64_tr_b16 v[86:87], v149 offset:176
    s_waitcnt lgkmcnt(8)
    v_mfma_f32_16x16x32_bf16 v[128:131], v[108:111], v[44:47], v[128:131]
    ds_read_b64_tr_b16 v[88:89], v149 offset:64
    ds_read_b64_tr_b16 v[90:91], v149 offset:208
    s_waitcnt lgkmcnt(8)
    v_mfma_f32_16x16x32_bf16 v[132:135], v[112:115], v[44:47], v[132:135]
    ds_read_b64_tr_b16 v[92:93], v149 offset:96
    ds_read_b64_tr_b16 v[94:95], v149 offset:240
    s_waitcnt lgkmcnt(8)
    v_mfma_f32_16x16x32_bf16 v[136:139], v[116:119], v[44:47], v[136:139]
    ds_read_b64_tr_b16 v[96:97], v149 offset:128
    ds_read_b64_tr_b16 v[98:99], v149 offset:272
    s_waitcnt lgkmcnt(8)
    v_mfma_f32_16x16x32_bf16 v[120:123], v[80:83], v[48:51], v[120:123]
    ds_read_b128 v[164:167], v3 offset:80
    ds_read_b64_tr_b16 v[100:101], v149 offset:4608
    ds_read_b64_tr_b16 v[102:103], v149 offset:4752
    s_waitcnt lgkmcnt(8)
    v_mfma_f32_16x16x32_bf16 v[124:127], v[84:87], v[48:51], v[124:127]
    ds_read_b64_tr_b16 v[104:105], v149 offset:4640
    ds_read_b64_tr_b16 v[106:107], v149 offset:4784
    s_waitcnt lgkmcnt(8)
    v_mfma_f32_16x16x32_bf16 v[128:131], v[88:91], v[48:51], v[128:131]
    ds_read_b64_tr_b16 v[108:109], v149 offset:4672
    ds_read_b64_tr_b16 v[110:111], v149 offset:4816
    s_waitcnt lgkmcnt(8)
    v_mfma_f32_16x16x32_bf16 v[132:135], v[92:95], v[48:51], v[132:135]
    ds_read_b64_tr_b16 v[112:113], v149 offset:4704
    ds_read_b64_tr_b16 v[114:115], v149 offset:4848
    s_waitcnt lgkmcnt(8)
    v_mfma_f32_16x16x32_bf16 v[136:139], v[96:99], v[48:51], v[136:139]
    ds_read_b64_tr_b16 v[116:117], v149 offset:4736
    ds_read_b64_tr_b16 v[118:119], v149 offset:4880
    s_waitcnt lgkmcnt(8)
    v_mfma_f32_16x16x32_bf16 v[120:123], v[100:103], v[52:55], v[120:123]
    v_min3_u32 v164, v164, v165, v166
    v_min_u32 v164, v164, v167
    s_nop 0
    v_readfirstlane_b32 s58, v164
    s_nop 0
    s_cmp_ge_u32 s58, 7
    s_cbranch_scc1 Lpg_12
    s_mov_b32 s15, 200000
Lpl_13:
    ds_read_b128 v[164:167], v3 offset:80
    s_waitcnt lgkmcnt(0)
    v_min3_u32 v164, v164, v165, v166
    v_min_u32 v164, v164, v167
    s_nop 0
    v_readfirstlane_b32 s58, v164
    s_nop 0
    s_cmp_ge_u32 s58, 7
    s_cbranch_scc1 Lpg_12
    s_sub_u32 s15, s15, 1
    s_cbranch_scc0 Lpl_13
Lpg_12:
    ds_read_b64_tr_b16 v[80:81], v149 offset:9216
    ds_read_b64_tr_b16 v[82:83], v149 offset:9360
    s_waitcnt lgkmcnt(8)
    v_mfma_f32_16x16x32_bf16 v[124:127], v[104:107], v[52:55], v[124:127]
    ds_read_b64_tr_b16 v[84:85], v149 offset:9248
    ds_read_b64_tr_b16 v[86:87], v149 offset:9392
    s_waitcnt lgkmcnt(8)
    v_mfma_f32_16x16x32_bf16 v[128:131], v[108:111], v[52:55], v[128:131]
    ds_read_b64_tr_b16 v[88:89], v149 offset:9280
    ds_read_b64_tr_b16 v[90:91], v149 offset:9424
    s_waitcnt lgkmcnt(8)
    v_mfma_f32_16x16x32_bf16 v[132:135], v[112:115], v[52:55], v[132:135]
    ds_read_b64_tr_b16 v[92:93], v149 offset:9312
    ds_read_b64_tr_b16 v[94:95], v149 offset:9456
    s_waitcnt lgkmcnt(8)
    v_mfma_f32_16x16x32_bf16 v[136:139], v[116:119], v[52:55], v[136:139]
    ds_read_b64_tr_b16 v[96:97], v149 offset:9344
    ds_read_b64_tr_b16 v[98:99], v149 offset:9488
    s_waitcnt lgkmcnt(8)
    v_mfma_f32_16x16x32_bf16 v[120:123], v[80:83], v[56:59], v[120:123]
    ds_read_b128 v[164:167], v3 offset:80
    ds_read_b64_tr_b16 v[100:101], v149 offset:13824
    ds_read_b64_tr_b16 v[102:103], v149 offset:13968
    s_waitcnt lgkmcnt(8)
    v_mfma_f32_16x16x32_bf16 v[124:127], v[84:87], v[56:59], v[124:127]
    ds_read_b64_tr_b16 v[104:105], v149 offset:13856
    ds_read_b64_tr_b16 v[106:107], v149 offset:14000
    s_waitcnt lgkmcnt(8)
    v_mfma_f32_16x16x32_bf16 v[128:131], v[88:91], v[56:59], v[128:131]
    ds_read_b64_tr_b16 v[108:109], v149 offset:13888
    ds_read_b64_tr_b16 v[110:111], v149 offset:14032
    s_waitcnt lgkmcnt(8)
    v_mfma_f32_16x16x32_bf16 v[132:135], v[92:95], v[56:59], v[132:135]
    ds_read_b64_tr_b16 v[112:113], v149 offset:13920
    ds_read_b64_tr_b16 v[114:115], v149 offset:14064
    s_waitcnt lgkmcnt(8)
    v_mfma_f32_16x16x32_bf16 v[136:139], v[96:99], v[56:59], v[136:139]
    ds_read_b64_tr_b16 v[116:117], v149 offset:13952
    ds_read_b64_tr_b16 v[118:119], v149 offset:14096
    s_waitcnt lgkmcnt(8)
    v_mfma_f32_16x16x32_bf16 v[120:123], v[100:103], v[60:63], v[120:123]
    v_min3_u32 v164, v164, v165, v166
    v_min_u32 v164, v164, v167
    s_nop 0
    v_readfirstlane_b32 s58, v164
    s_nop 0
    s_cmp_ge_u32 s58, 8
    s_cbranch_scc1 Lpg_14
    s_mov_b32 s15, 200000
Lpl_15:
    ds_read_b128 v[164:167], v3 offset:80
    s_waitcnt lgkmcnt(0)
    v_min3_u32 v164, v164, v165, v166
    v_min_u32 v164, v164, v167
    s_nop 0
    v_readfirstlane_b32 s58, v164
    s_nop 0
    s_cmp_ge_u32 s58, 8
    s_cbranch_scc1 Lpg_14
    s_sub_u32 s15, s15, 1
    s_cbranch_scc0 Lpl_15
Lpg_14:
    ds_read_b64_tr_b16 v[80:81], v149 offset:18432
    ds_read_b64_tr_b16 v[82:83], v149 offset:18576
    s_waitcnt lgkmcnt(8)
    v_mfma_f32_16x16x32_bf16 v[124:127], v[104:107], v[60:63], v[124:127]
    ds_read_b64_tr_b16 v[84:85], v149 offset:18464
    ds_read_b64_tr_b16 v[86:87], v149 offset:18608
    s_waitcnt lgkmcnt(8)
    v_mfma_f32_16x16x32_bf16 v[128:131], v[108:111], v[60:63], v[128:131]
    ds_read_b64_tr_b16 v[88:89], v149 offset:18496
    ds_read_b64_tr_b16 v[90:91], v149 offset:18640
    s_waitcnt lgkmcnt(8)
    v_mfma_f32_16x16x32_bf16 v[132:135], v[112:115], v[60:63], v[132:135]
    ds_read_b64_tr_b16 v[92:93], v149 offset:18528
    ds_read_b64_tr_b16 v[94:95], v149 offset:18672
    s_waitcnt lgkmcnt(8)
    v_mfma_f32_16x16x32_bf16 v[136:139], v[116:119], v[60:63], v[136:139]
    ds_read_b64_tr_b16 v[96:97], v149 offset:18560
    ds_read_b64_tr_b16 v[98:99], v149 offset:18704
    s_waitcnt lgkmcnt(8)
    v_mfma_f32_16x16x32_bf16 v[120:123], v[80:83], v[64:67], v[120:123]
    ds_read_b128 v[164:167], v3 offset:80
    ds_read_b64_tr_b16 v[100:101], v149 offset:23040
    ds_read_b64_tr_b16 v[102:103], v149 offset:23184
    s_waitcnt lgkmcnt(8)
    v_mfma_f32_16x16x32_bf16 v[124:127], v[84:87], v[64:67], v[124:127]
    ds_read_b64_tr_b16 v[104:105], v149 offset:23072
    ds_read_b64_tr_b16 v[106:107], v149 offset:23216
    s_waitcnt lgkmcnt(8)
    v_mfma_f32_16x16x32_bf16 v[128:131], v[88:91], v[64:67], v[128:131]
    ds_read_b64_tr_b16 v[108:109], v149 offset:23104
    ds_read_b64_tr_b16 v[110:111], v149 offset:23248
    s_waitcnt lgkmcnt(8)
    v_mfma_f32_16x16x32_bf16 v[132:135], v[92:95], v[64:67], v[132:135]
    ds_read_b64_tr_b16 v[112:113], v149 offset:23136
    ds_read_b64_tr_b16 v[114:115], v149 offset:23280
    s_waitcnt lgkmcnt(8)
    v_mfma_f32_16x16x32_bf16 v[136:139], v[96:99], v[64:67], v[136:139]
    ds_read_b64_tr_b16 v[116:117], v149 offset:23168
    ds_read_b64_tr_b16 v[118:119], v149 offset:23312
    s_waitcnt lgkmcnt(8)
    v_mfma_f32_16x16x32_bf16 v[120:123], v[100:103], v[68:71], v[120:123]
    v_min3_u32 v164, v164, v165, v166
    v_min_u32 v164, v164, v167
    s_nop 0
    v_readfirstlane_b32 s58, v164
    s_nop 0
    s_cmp_ge_u32 s58, 9
    s_cbranch_scc1 Lpg_16
    s_mov_b32 s15, 200000
Lpl_17:
    ds_read_b128 v[164:167], v3 offset:80
    s_waitcnt lgkmcnt(0)
    v_min3_u32 v164, v164, v165, v166
    v_min_u32 v164, v164, v167
    s_nop 0
    v_readfirstlane_b32 s58, v164
    s_nop 0
    s_cmp_ge_u32 s58, 9
    s_cbranch_scc1 Lpg_16
    s_sub_u32 s15, s15, 1
    s_cbranch_scc0 Lpl_17
Lpg_16:
    ds_read_b64_tr_b16 v[80:81], v149 offset:27648
    ds_read_b64_tr_b16 v[82:83], v149 offset:27792
    s_waitcnt lgkmcnt(8)
    v_mfma_f32_16x16x32_bf16 v[124:127], v[104:107], v[68:71], v[124:127]
    ds_read_b64_tr_b16 v[84:85], v149 offset:27680
    ds_read_b64_tr_b16 v[86:87], v149 offset:27824
    s_waitcnt lgkmcnt(8)
    v_mfma_f32_16x16x32_bf16 v[128:131], v[108:111], v[68:71], v[128:131]
    ds_read_b64_tr_b16 v[88:89], v149 offset:27712
    ds_read_b64_tr_b16 v[90:91], v149 offset:27856
    s_waitcnt lgkmcnt(8)
    v_mfma_f32_16x16x32_bf16 v[132:135], v[112:115], v[68:71], v[132:135]
    ds_read_b64_tr_b16 v[92:93], v149 offset:27744
    ds_read_b64_tr_b16 v[94:95], v149 offset:27888
    s_waitcnt lgkmcnt(8)
    v_mfma_f32_16x16x32_bf16 v[136:139], v[116:119], v[68:71], v[136:139]
    ds_read_b64_tr_b16 v[96:97], v149 offset:27776
    ds_read_b64_tr_b16 v[98:99], v149 offset:27920
    s_waitcnt lgkmcnt(8)
    v_mfma_f32_16x16x32_bf16 v[120:123], v[80:83], v[72:75], v[120:123]
    ds_read_b64_tr_b16 v[100:101], v149 offset:32256
    ds_read_b64_tr_b16 v[102:103], v149 offset:32400
    s_waitcnt lgkmcnt(8)
    v_mfma_f32_16x16x32_bf16 v[124:127], v[84:87], v[72:75], v[124:127]
    ds_read_b64_tr_b16 v[104:105], v149 offset:32288
    ds_read_b64_tr_b16 v[106:107], v149 offset:32432
    s_waitcnt lgkmcnt(8)
    v_mfma_f32_16x16x32_bf16 v[128:131], v[88:91], v[72:75], v[128:131]
    ds_read_b64_tr_b16 v[108:109], v149 offset:32320
    ds_read_b64_tr_b16 v[110:111], v149 offset:32464
    s_waitcnt lgkmcnt(8)
    v_mfma_f32_16x16x32_bf16 v[132:135], v[92:95], v[72:75], v[132:135]
    ds_read_b64_tr_b16 v[112:113], v149 offset:32352
    ds_read_b64_tr_b16 v[114:115], v149 offset:32496
    s_waitcnt lgkmcnt(8)
    v_mfma_f32_16x16x32_bf16 v[136:139], v[96:99], v[72:75], v[136:139]
    ds_read_b64_tr_b16 v[116:117], v149 offset:32384
    ds_read_b64_tr_b16 v[118:119], v149 offset:32528
    s_waitcnt lgkmcnt(8)
    v_mfma_f32_16x16x32_bf16 v[120:123], v[100:103], v[76:79], v[120:123]
    s_waitcnt lgkmcnt(6)
    v_mfma_f32_16x16x32_bf16 v[124:127], v[104:107], v[76:79], v[124:127]
    s_waitcnt lgkmcnt(4)
    v_mfma_f32_16x16x32_bf16 v[128:131], v[108:111], v[76:79], v[128:131]
    s_waitcnt lgkmcnt(2)
    v_mfma_f32_16x16x32_bf16 v[132:135], v[112:115], v[76:79], v[132:135]
    s_waitcnt lgkmcnt(0)
    v_mfma_f32_16x16x32_bf16 v[136:139], v[116:119], v[76:79], v[136:139]
    v_cvt_pk_bf16_f32 v120, v120, v121
    v_cvt_pk_bf16_f32 v121, v122, v123
    ds_write_b64 v158, v[120:121] offset:0
    v_cvt_pk_bf16_f32 v124, v124, v125
    v_cvt_pk_bf16_f32 v125, v126, v127
    ds_write_b64 v158, v[124:125] offset:32
    v_cvt_pk_bf16_f32 v128, v128, v129
    v_cvt_pk_bf16_f32 v129, v130, v131
    ds_write_b64 v158, v[128:129] offset:64
    v_cvt_pk_bf16_f32 v132, v132, v133
    v_cvt_pk_bf16_f32 v133, v134, v135
    ds_write_b64 v158, v[132:133] offset:96
    v_cvt_pk_bf16_f32 v136, v136, v137
    v_cvt_pk_bf16_f32 v137, v138, v139
    ds_write_b64 v158, v[136:137] offset:128
    s_waitcnt lgkmcnt(0)
    s_barrier
    s_and_b32 s11, s10, 1
    s_cmp_ge_u32 s10, 2
    s_cbranch_scc1 Lnos2
    s_lshl_b32 s15, s11, 3
    s_add_u32 s60, s15, 2
    s_mul_i32 s60, s60, 9216
    s_add_u32 s14, s9, 2
    s_and_b32 s14, s14, 7
    s_lshl_b32 s14, s14, 1
    s_add_u32 s14, s14, s11
    s_mul_i32 s12, s14, 9216
    s_add_u32 s12, s12, 458752
    s_mov_b32 s13, s60
    s_mov_b32 m0, s13
    s_nop 0
    buffer_load_dwordx4 v162, s[44:47], s12 offen offset:0 sc1 lds
    buffer_load_dwordx4 v162, s[44:47], s12 offen offset:1024 sc1 lds
    buffer_load_dwordx4 v162, s[44:47], s12 offen offset:2048 sc1 lds
    buffer_load_dwordx4 v162, s[44:47], s12 offen offset:3072 sc1 lds
    s_add_u32 s12, s12, 4096
    s_add_u32 s13, s13, 4096
    s_mov_b32 m0, s13
    s_nop 0
    buffer_load_dwordx4 v162, s[44:47], s12 offen offset:0 sc1 lds
    buffer_load_dwordx4 v162, s[44:47], s12 offen offset:1024 sc1 lds
    buffer_load_dwordx4 v162, s[44:47], s12 offen offset:2048 sc1 lds
    buffer_load_dwordx4 v162, s[44:47], s12 offen offset:3072 sc1 lds
    s_add_u32 s12, s12, 4096
    s_add_u32 s13, s13, 4096
    s_mov_b32 m0, s13
    s_nop 0
    buffer_load_dwordx4 v162, s[44:47], s12 offen offset:0 sc1 lds
Lnos2:
    s_setprio 3
    v_and_b32 v164, 31, v1
    v_bfe_u32 v165, v1, 1, 3
    v_lshrrev_b32 v136, 5, v1
    v_xor_b32 v165, v165, v136
    v_lshlrev_b32 v165, 4, v165
    v_lshl_add_u32 v165, v164, 7, v165
    v_xor_b32 v136, 0, v165
    v_add_u32 v136, 119808, v136
    v_xor_b32 v137, 32, v165
    v_add_u32 v137, 119808, v137
    v_xor_b32 v138, 64, v165
    v_add_u32 v138, 119808, v138
    v_xor_b32 v139, 96, v165
    v_add_u32 v139, 119808, v139
    s_add_u32 s28, s10, 3
    s_add_u32 s29, s10, 6
    s_cmp_eq_u32 s10, 2
    s_cselect_b32 s29, 12, s29
    s_cmp_eq_u32 s10, 3
    s_cselect_b32 s28, 11, s28
    s_cselect_b32 s29, 13, s29
    s_cselect_b32 s30, 14, s28
    s_cselect_b32 s31, 15, s28
    s_add_u32 s13, s28, s9
    s_and_b32 s13, s13, 7
    s_lshl_b32 s13, s13, 1
    s_lshr_b32 s14, s28, 3
    s_add_u32 s16, s13, s14
    s_add_u32 s13, s29, s9
    s_and_b32 s13, s13, 7
    s_lshl_b32 s13, s13, 1
    s_lshr_b32 s14, s29, 3
    s_add_u32 s17, s13, s14
    s_add_u32 s13, s30, s9
    s_and_b32 s13, s13, 7
    s_lshl_b32 s13, s13, 1
    s_lshr_b32 s14, s30, 3
    s_add_u32 s36, s13, s14
    s_add_u32 s13, s31, s9
    s_and_b32 s13, s13, 7
    s_lshl_b32 s13, s13, 1
    s_lshr_b32 s14, s31, 3
    s_add_u32 s37, s13, s14
    s_sub_u32 s13, s16, 0
    s_mul_i32 s13, s13, 1536
    s_add_u32 s13, s13, 4096
    v_mov_b32 v143, s13
    s_sub_u32 s13, s17, 1
    s_mul_i32 s13, s13, 1536
    s_add_u32 s13, s13, 4096
    v_mov_b32 v164, s13
    v_cmp_le_u32 vcc, 12, v1
    s_nop 1
    v_cndmask_b32 v143, v143, v164, vcc
    s_sub_u32 s13, s36, 2
    s_mul_i32 s13, s13, 1536
    s_add_u32 s13, s13, 4096
    v_mov_b32 v164, s13
    v_cmp_le_u32 vcc, 24, v1
    s_nop 1
    v_cndmask_b32 v143, v143, v164, vcc
    s_sub_u32 s13, s37, 3
    s_mul_i32 s13, s13, 1536
    s_add_u32 s13, s13, 4096
    v_mov_b32 v164, s13
    v_cmp_le_u32 vcc, 36, v1
    s_nop 1
    v_cndmask_b32 v143, v143, v164, vcc
    v_lshl_add_u32 v143, v1, 7, v143
    s_lshr_b32 s12, s2, 3
    s_mul_i32 s13, s12, 43
    s_lshr_b32 s13, s13, 8
    s_mul_i32 s14, s13, 6
    s_sub_u32 s14, s12, s14
    s_mul_i32 s14, s14, 3
    s_add_u32 s53, s14, s10
    s_cmp_ge_u32 s12, 30
    s_cselect_b32 s53, 99, s53
    s_and_b32 s14, s2, 1
    s_mul_i32 s14, s14, 5
    s_add_u32 s52, s13, s14
    s_lshr_b32 s55, s2, 4
    s_bfe_u32 s13, s2, 0x10003
    s_mul_i32 s12, s13, 3
    s_add_u32 s12, s12, s10
    s_cmp_eq_u32 s12, 5
    s_cselect_b32 s12, s55, s12
    s_cselect_b32 s13, 16, s55
    s_cmp_eq_u32 s10, 3
    s_cselect_b32 s55, s55, s13
    s_add_u32 s54, s12, s14
    s_cmp_ge_u32 s12, 5
    s_cselect_b32 s59, 1, 0
    s_bfe_u32 s61, s2, 0x20001
    s_cmp_eq_u32 s53, 16
    s_cselect_b32 s12, 0, s53
    s_cselect_b32 s13, 7, 15
    s_lshl_b32 s12, s12, 11
    s_add_u32 s12, s12, 36864
    v_and_b32 v164, s13, v1
    v_lshl_add_u32 v164, v164, 7, s12
    v_cmp_le_u32 vcc, 48, v1
    s_nop 1
    v_cndmask_b32 v143, v143, v164, vcc
    s_cmp_lt_u32 s53, 17
    s_cselect_b32 s91, 0xffff0000, 0
    s_mov_b32 s90, 0xffffff
    s_cmp_eq_u32 s10, 3
    s_cselect_b32 s91, 0xffff, s91
    s_cselect_b32 s90, -1, s90
    s_setprio 3
    s_cmp_eq_u32 s10, 3
    s_cbranch_scc1 Lproducer
    s_mov_b32 s15, 20000
    s_mov_b64 exec, 0xffffff
Lpoll_18:
    buffer_load_dwordx2 v[164:165], v143, s[44:47], 0 offen sc1
    s_waitcnt vmcnt(0)
    v_cmp_ne_u64 vcc, s[6:7], v[164:165]
    s_cbranch_vccz Lpd_19
    s_sleep 2
    s_sub_u32 s15, s15, 1
    s_cbranch_scc0 Lpoll_18
Lpd_19:
    s_mov_b64 exec, -1
    s_lshl_b32 s12, s10, 2
    v_add_u32 v166, s12, v3
    s_mov_b64 exec, 1
    v_mov_b32 v164, 1
    ds_add_u32 v166, v164 offset:212
    s_mov_b64 exec, -1
    s_mov_b32 s58, 0
    s_mul_i32 s60, s28, 9216
    s_mul_i32 s12, s16, 9216
    s_add_u32 s12, s12, 458752
    s_mov_b32 s13, s60
    s_mov_b32 m0, s13
    s_nop 0
    buffer_load_dwordx4 v162, s[44:47], s12 offen offset:0 sc1 lds
    buffer_load_dwordx4 v162, s[44:47], s12 offen offset:1024 sc1 lds
    buffer_load_dwordx4 v162, s[44:47], s12 offen offset:2048 sc1 lds
    buffer_load_dwordx4 v162, s[44:47], s12 offen offset:3072 sc1 lds
    s_add_u32 s12, s12, 4096
    s_add_u32 s13, s13, 4096
    s_mov_b32 m0, s13
    s_nop 0
    buffer_load_dwordx4 v162, s[44:47], s12 offen offset:0 sc1 lds
    buffer_load_dwordx4 v162, s[44:47], s12 offen offset:1024 sc1 lds
    buffer_load_dwordx4 v162, s[44:47], s12 offen offset:2048 sc1 lds
    buffer_load_dwordx4 v162, s[44:47], s12 offen offset:3072 sc1 lds
    s_add_u32 s12, s12, 4096
    s_add_u32 s13, s13, 4096
    s_mov_b32 m0, s13
    s_nop 0
    buffer_load_dwordx4 v162, s[44:47], s12 offen offset:0 sc1 lds
    s_cmp_lt_u32 s53, 17
    s_cbranch_scc1 Lh1
    s_mov_b64 exec, 1
    v_mov_b32 v164, 5
    ds_write_b32 v163, v164 offset:112
    s_mov_b64 exec, -1
    s_waitcnt vmcnt(0)
    s_mov_b64 exec, 1
    v_mov_b32 v164, 1
    ds_add_u32 v3, v164 offset:152
    s_mov_b64 exec, -1
    s_branch Lh1done
Lh1:
    s_mov_b32 s90, 0
    s_mov_b32 s15, 20000
    s_mov_b64 exec, s[90:91]
    buffer_load_dwordx2 v[164:165], v143, s[44:47], 0 offen sc1
    s_waitcnt vmcnt(0)
    s_mov_b64 exec, 1
    v_mov_b32 v166, 1
    ds_add_u32 v3, v166 offset:152
    s_mov_b64 exec, -1
    s_mov_b64 exec, s[90:91]
    s_branch Lpf_22
Lpoll_20:
    buffer_load_dwordx2 v[164:165], v143, s[44:47], 0 offen sc1
    s_waitcnt vmcnt(0)
Lpf_22:
    v_cmp_ne_u64 vcc, s[6:7], v[164:165]
    s_cbranch_vccz Lpd_21
    s_sleep 2
    s_sub_u32 s15, s15, 1
    s_cbranch_scc0 Lpoll_20
Lpd_21:
    s_mov_b64 exec, -1
    s_mul_i32 s12, s61, 17
    s_add_u32 s12, s12, s53
    s_mul_i32 s56, s12, 19456
    s_add_u32 s56, s56, 655360
    s_mov_b64 s[90:91], -1
    s_cmp_eq_u32 s53, 16
    s_cbranch_scc0 Lnozero
    v_mov_b32 v8, 0
    v_mov_b32 v9, 0
    v_mov_b32 v10, 0
    v_mov_b32 v11, 0
    v_mov_b32 v12, 0
    v_mov_b32 v13, 0
    v_mov_b32 v14, 0
    v_mov_b32 v15, 0
    v_mov_b32 v16, 0
    v_mov_b32 v17, 0
    v_mov_b32 v18, 0
    v_mov_b32 v19, 0
    v_mov_b32 v20, 0
    v_mov_b32 v21, 0
    v_mov_b32 v22, 0
    v_mov_b32 v23, 0
    v_mov_b32 v24, 0
    v_mov_b32 v25, 0
    v_mov_b32 v26, 0
    v_mov_b32 v27, 0
    v_mov_b32 v28, 0
    v_mov_b32 v29, 0
    v_mov_b32 v30, 0
    v_mov_b32 v31, 0
    v_mov_b32 v32, 0
    v_mov_b32 v33, 0
    v_mov_b32 v34, 0
    v_mov_b32 v35, 0
    v_mov_b32 v36, 0
    v_mov_b32 v37, 0
    v_mov_b32 v38, 0
    v_mov_b32 v39, 0
    v_mov_b32 v40, 0
    v_mov_b32 v41, 0
    v_mov_b32 v42, 0
    v_mov_b32 v43, 0
    v_mov_b32 v44, 0
    v_mov_b32 v45, 0
    v_mov_b32 v46, 0
    v_mov_b32 v47, 0
    v_mov_b32 v48, 0
    v_mov_b32 v49, 0
    v_mov_b32 v50, 0
    v_mov_b32 v51, 0
    v_mov_b32 v52, 0
    v_mov_b32 v53, 0
    v_mov_b32 v54, 0
    v_mov_b32 v55, 0
    v_mov_b32 v56, 0
    v_mov_b32 v57, 0
    v_mov_b32 v58, 0
    v_mov_b32 v59, 0
    v_mov_b32 v60, 0
    v_mov_b32 v61, 0
    v_mov_b32 v62, 0
    v_mov_b32 v63, 0
    v_mov_b32 v64, 0
    v_mov_b32 v65, 0
    v_mov_b32 v66, 0
    v_mov_b32 v67, 0
    v_mov_b32 v68, 0
    v_mov_b32 v69, 0
    v_mov_b32 v70, 0
    v_mov_b32 v71, 0
    v_mov_b32 v72, 0
    v_mov_b32 v73, 0
    v_mov_b32 v74, 0
    v_mov_b32 v75, 0
    v_mov_b32 v76, 0
    v_mov_b32 v77, 0
    v_mov_b32 v78, 0
    v_mov_b32 v79, 0
    v_mov_b32 v80, 0
    v_mov_b32 v81, 0
    v_mov_b32 v82, 0
    v_mov_b32 v83, 0
    s_mov_b32 s90, 1
    s_mov_b32 s91, 1
Lnozero:
    s_mov_b64 exec, s[90:91]
    buffer_load_dwordx4 v[8:11], v162, s[44:47], s56 offen offset:0 sc1
    buffer_load_dwordx4 v[12:15], v162, s[44:47], s56 offen offset:1024 sc1
    buffer_load_dwordx4 v[16:19], v162, s[44:47], s56 offen offset:2048 sc1
    buffer_load_dwordx4 v[20:23], v162, s[44:47], s56 offen offset:3072 sc1
    s_mov_b64 exec, -1
    s_add_u32 s56, s56, 4096
    s_mov_b64 exec, s[90:91]
    buffer_load_dwordx4 v[24:27], v162, s[44:47], s56 offen offset:0 sc1
    buffer_load_dwordx4 v[28:31], v162, s[44:47], s56 offen offset:1024 sc1
    buffer_load_dwordx4 v[32:35], v162, s[44:47], s56 offen offset:2048 sc1
    buffer_load_dwordx4 v[36:39], v162, s[44:47], s56 offen offset:3072 sc1
    s_mov_b64 exec, -1
    s_add_u32 s56, s56, 4096
    s_mov_b64 exec, s[90:91]
    buffer_load_dwordx4 v[40:43], v162, s[44:47], s56 offen offset:0 sc1
    buffer_load_dwordx4 v[44:47], v162, s[44:47], s56 offen offset:1024 sc1
    buffer_load_dwordx4 v[48:51], v162, s[44:47], s56 offen offset:2048 sc1
    buffer_load_dwordx4 v[52:55], v162, s[44:47], s56 offen offset:3072 sc1
    s_mov_b64 exec, -1
    s_add_u32 s56, s56, 4096
    s_mov_b64 exec, s[90:91]
    buffer_load_dwordx4 v[56:59], v162, s[44:47], s56 offen offset:0 sc1
    buffer_load_dwordx4 v[60:63], v162, s[44:47], s56 offen offset:1024 sc1
    buffer_load_dwordx4 v[64:67], v162, s[44:47], s56 offen offset:2048 sc1
    buffer_load_dwordx4 v[68:71], v162, s[44:47], s56 offen offset:3072 sc1
    s_mov_b64 exec, -1
    s_add_u32 s56, s56, 4096
    s_mov_b64 exec, s[90:91]
    buffer_load_dwordx4 v[72:75], v162, s[44:47], s56 offen offset:0 sc1
    buffer_load_dwordx4 v[76:79], v162, s[44:47], s56 offen offset:1024 sc1
    buffer_load_dwordx4 v[80:83], v162, s[44:47], s56 offen offset:2048 sc1
    s_mov_b64 exec, -1
    s_add_u32 s56, s56, 4096
    s_cmp_ge_u32 s58, 1
    s_cbranch_scc1 Lpg_23
    s_mov_b32 s15, 200000
Lpl_24:
    ds_read_b32 v164, v3 offset:104
    s_waitcnt lgkmcnt(0)
    v_readfirstlane_b32 s58, v164
    s_nop 0
    s_cmp_ge_u32 s58, 1
    s_cbranch_scc1 Lpg_23
    s_sleep 6
    s_sub_u32 s15, s15, 1
    s_cbranch_scc0 Lpl_24
Lpg_23:
    ds_read_b128 v[104:107], v136 offset:0
    ds_read_b128 v[108:111], v137 offset:0
    ds_read_b128 v[112:115], v138 offset:0
    ds_read_b128 v[116:119], v139 offset:0
    s_waitcnt vmcnt(15)
    s_waitcnt lgkmcnt(0)
    s_mov_b64 exec, 1
    v_mov_b32 v164, 1
    ds_write_b32 v163, v164 offset:112
    s_mov_b64 exec, -1
    s_setprio 2
    v_mfma_f32_32x32x16_bf16 v[120:135], v[8:11], v[104:107], 0
    v_mfma_f32_32x32x16_bf16 v[120:135], v[12:15], v[108:111], v[120:135]
    v_mfma_f32_32x32x16_bf16 v[120:135], v[16:19], v[112:115], v[120:135]
    v_mfma_f32_32x32x16_bf16 v[120:135], v[20:23], v[116:119], v[120:135]
    s_setprio 3
    s_cmp_ge_u32 s58, 2
    s_cbranch_scc1 Lpg_25
    s_mov_b32 s15, 200000
Lpl_26:
    ds_read_b32 v164, v3 offset:104
    s_waitcnt lgkmcnt(0)
    v_readfirstlane_b32 s58, v164
    s_nop 0
    s_cmp_ge_u32 s58, 2
    s_cbranch_scc1 Lpg_25
    s_sleep 6
    s_sub_u32 s15, s15, 1
    s_cbranch_scc0 Lpl_26
Lpg_25:
    ds_read_b128 v[104:107], v136 offset:4096
    ds_read_b128 v[108:111], v137 offset:4096
    ds_read_b128 v[112:115], v138 offset:4096
    ds_read_b128 v[116:119], v139 offset:4096
    s_waitcnt vmcnt(11)
    s_waitcnt lgkmcnt(0)
    s_mov_b64 exec, 1
    v_mov_b32 v164, 2
    ds_write_b32 v163, v164 offset:112
    s_mov_b64 exec, -1
    s_setprio 2
    v_mfma_f32_32x32x16_bf16 v[120:135], v[24:27], v[104:107], v[120:135]
    v_mfma_f32_32x32x16_bf16 v[120:135], v[28:31], v[108:111], v[120:135]
    v_mfma_f32_32x32x16_bf16 v[120:135], v[32:35], v[112:115], v[120:135]
    v_mfma_f32_32x32x16_bf16 v[120:135], v[36:39], v[116:119], v[120:135]
    s_setprio 3
    s_cmp_ge_u32 s58, 3
    s_cbranch_scc1 Lpg_27
    s_mov_b32 s15, 200000
Lpl_28:
    ds_read_b32 v164, v3 offset:104
    s_waitcnt lgkmcnt(0)
    v_readfirstlane_b32 s58, v164
    s_nop 0
    s_cmp_ge_u32 s58, 3
    s_cbranch_scc1 Lpg_27
    s_sleep 6
    s_sub_u32 s15, s15, 1
    s_cbranch_scc0 Lpl_28
Lpg_27:
    ds_read_b128 v[104:107], v136 offset:8192
    ds_read_b128 v[108:111], v137 offset:8192
    ds_read_b128 v[112:115], v138 offset:8192
    ds_read_b128 v[116:119], v139 offset:8192
    s_waitcnt vmcnt(7)
    s_waitcnt lgkmcnt(0)
    s_mov_b64 exec, 1
    v_mov_b32 v164, 3
    ds_write_b32 v163, v164 offset:112
    s_mov_b64 exec, -1
    s_setprio 2
    v_mfma_f32_32x32x16_bf16 v[120:135], v[40:43], v[104:107], v[120:135]
    v_mfma_f32_32x32x16_bf16 v[120:135], v[44:47], v[108:111], v[120:135]
    v_mfma_f32_32x32x16_bf16 v[120:135], v[48:51], v[112:115], v[120:135]
    v_mfma_f32_32x32x16_bf16 v[120:135], v[52:55], v[116:119], v[120:135]
    s_setprio 3
    s_cmp_ge_u32 s58, 4
    s_cbranch_scc1 Lpg_29
    s_mov_b32 s15, 200000
Lpl_30:
    ds_read_b32 v164, v3 offset:104
    s_waitcnt lgkmcnt(0)
    v_readfirstlane_b32 s58, v164
    s_nop 0
    s_cmp_ge_u32 s58, 4
    s_cbranch_scc1 Lpg_29
    s_sleep 6
    s_sub_u32 s15, s15, 1
    s_cbranch_scc0 Lpl_30
Lpg_29:
    ds_read_b128 v[104:107], v136 offset:12288
    ds_read_b128 v[108:111], v137 offset:12288
    ds_read_b128 v[112:115], v138 offset:12288
    ds_read_b128 v[116:119], v139 offset:12288
    s_waitcnt vmcnt(3)
    s_waitcnt lgkmcnt(0)
    s_mov_b64 exec, 1
    v_mov_b32 v164, 4
    ds_write_b32 v163, v164 offset:112
    s_mov_b64 exec, -1
    s_setprio 2
    v_mfma_f32_32x32x16_bf16 v[120:135], v[56:59], v[104:107], v[120:135]
    v_mfma_f32_32x32x16_bf16 v[120:135], v[60:63], v[108:111], v[120:135]
    v_mfma_f32_32x32x16_bf16 v[120:135], v[64:67], v[112:115], v[120:135]
    v_mfma_f32_32x32x16_bf16 v[120:135], v[68:71], v[116:119], v[120:135]
    s_setprio 3
    s_cmp_ge_u32 s58, 5
    s_cbranch_scc1 Lpg_31
    s_mov_b32 s15, 200000
Lpl_32:
    ds_read_b32 v164, v3 offset:104
    s_waitcnt lgkmcnt(0)
    v_readfirstlane_b32 s58, v164
    s_nop 0
    s_cmp_ge_u32 s58, 5
    s_cbranch_scc1 Lpg_31
    s_sleep 6
    s_sub_u32 s15, s15, 1
    s_cbranch_scc0 Lpl_32
Lpg_31:
    ds_read_b128 v[104:107], v136 offset:16384
    ds_read_b128 v[108:111], v137 offset:16384
    ds_read_b128 v[112:115], v138 offset:16384
    s_waitcnt vmcnt(0)
    s_waitcnt lgkmcnt(0)
    s_mov_b64 exec, 1
    v_mov_b32 v164, 5
    ds_write_b32 v163, v164 offset:112
    s_mov_b64 exec, -1
    s_setprio 2
    v_mfma_f32_32x32x16_bf16 v[120:135], v[72:75], v[104:107], v[120:135]
    v_mfma_f32_32x32x16_bf16 v[120:135], v[76:79], v[108:111], v[120:135]
    v_mfma_f32_32x32x16_bf16 v[120:135], v[80:83], v[112:115], v[120:135]
    s_setprio 3
    s_mul_i32 s12, s61, 10
    s_add_u32 s12, s12, s52
    s_mul_i32 s13, s12, 17
    s_add_u32 s57, s13, s53
    s_mul_i32 s56, s12, 34816
    s_lshl_b32 s12, s53, 11
    s_add_u32 s56, s56, s12
    s_add_u32 s56, s56, 4390912
    s_nop 2
    v_cvt_pk_bf16_f32 v120, v120, v121
    v_cvt_pk_bf16_f32 v121, v122, v123
    v_cvt_pk_bf16_f32 v122, v124, v125
    v_cvt_pk_bf16_f32 v123, v126, v127
    v_cvt_pk_bf16_f32 v124, v128, v129
    v_cvt_pk_bf16_f32 v125, v130, v131
    v_cvt_pk_bf16_f32 v126, v132, v133
    v_cvt_pk_bf16_f32 v127, v134, v135
    v_permlane32_swap_b32 v120, v122
    v_permlane32_swap_b32 v121, v123
    buffer_store_dwordx4 v[120:123], v162, s[44:47], s56 offen offset:0 sc1
    v_permlane32_swap_b32 v124, v126
    v_permlane32_swap_b32 v125, v127
    buffer_store_dwordx4 v[124:127], v162, s[44:47], s56 offen offset:1024 sc1
    s_add_u32 s13, s57, 768
    s_waitcnt vmcnt(0)
    s_lshl_b32 s14, s13, 7
    s_add_u32 s14, s14, 4096
    s_mov_b64 exec, 1
    v_mov_b32 v164, s6
    v_mov_b32 v165, s7
    buffer_store_dwordx2 v[164:165], off, s[44:47], s14 sc1
    s_mov_b64 exec, -1
Lh1done:
    s_mul_i32 s60, s29, 9216
    s_mul_i32 s12, s17, 9216
    s_add_u32 s12, s12, 458752
    s_mov_b32 s13, s60
    s_mov_b32 m0, s13
    s_nop 0
    buffer_load_dwordx4 v162, s[44:47], s12 offen offset:0 sc1 lds
    buffer_load_dwordx4 v162, s[44:47], s12 offen offset:1024 sc1 lds
    buffer_load_dwordx4 v162, s[44:47], s12 offen offset:2048 sc1 lds
    buffer_load_dwordx4 v162, s[44:47], s12 offen offset:3072 sc1 lds
    s_add_u32 s12, s12, 4096
    s_add_u32 s13, s13, 4096
    s_mov_b32 m0, s13
    s_nop 0
    buffer_load_dwordx4 v162, s[44:47], s12 offen offset:0 sc1 lds
    buffer_load_dwordx4 v162, s[44:47], s12 offen offset:1024 sc1 lds
    buffer_load_dwordx4 v162, s[44:47], s12 offen offset:2048 sc1 lds
    buffer_load_dwordx4 v162, s[44:47], s12 offen offset:3072 sc1 lds
    s_add_u32 s12, s12, 4096
    s_add_u32 s13, s13, 4096
    s_mov_b32 m0, s13
    s_nop 0
    buffer_load_dwordx4 v162, s[44:47], s12 offen offset:0 sc1 lds
    s_waitcnt vmcnt(0)
    s_mov_b64 exec, 1
    v_mov_b32 v164, 1
    ds_add_u32 v3, v164 offset:156
    s_mov_b64 exec, -1
    s_cmp_eq_u32 s59, 0
    s_cbranch_scc1 Lh2
    s_mov_b64 exec, 1
    v_mov_b32 v164, 14
    ds_write_b32 v163, v164 offset:112
    s_mov_b64 exec, -1
    s_branch Lh2done
Lh2:
    s_mul_i32 s12, s61, 10
    s_add_u32 s12, s12, s54
    s_mul_i32 s57, s12, 17
    s_mul_i32 s56, s12, 34816
    s_add_u32 s56, s56, 4390912
    s_add_u32 s12, s57, 768
    s_lshl_b32 s12, s12, 7
    s_add_u32 s12, s12, 4096
    v_lshl_add_u32 v143, v1, 7, s12
    s_lshl_b32 s12, s55, 6
    s_and_b32 s13, s61, 1
    s_add_u32 s60, s12, s13
    s_cmp_eq_u32 s55, 16
    s_cbranch_scc1 Lh2x
    s_mov_b32 s15, 20000
    s_mov_b64 exec, 0x1ffff
Lpoll_33:
    buffer_load_dwordx2 v[164:165], v143, s[44:47], 0 offen sc1
    s_waitcnt vmcnt(0)
    v_cmp_ne_u64 vcc, s[6:7], v[164:165]
    s_cbranch_vccz Lpd_34
    s_sleep 12
    s_sub_u32 s15, s15, 1
    s_cbranch_scc0 Lpoll_33
Lpd_34:
    s_mov_b64 exec, -1
    v_add_u32 v136, 4294847488, v136
    v_add_u32 v137, 4294847488, v137
    v_add_u32 v138, 4294847488, v138
    v_add_u32 v139, 4294847488, v139
    buffer_load_dwordx4 v[8:11], v162, s[44:47], s56 offen offset:0 sc1
    buffer_load_dwordx4 v[12:15], v162, s[44:47], s56 offen offset:1024 sc1
    buffer_load_dwordx4 v[16:19], v162, s[44:47], s56 offen offset:2048 sc1
    buffer_load_dwordx4 v[20:23], v162, s[44:47], s56 offen offset:3072 sc1
    s_add_u32 s56, s56, 4096
    buffer_load_dwordx4 v[24:27], v162, s[44:47], s56 offen offset:0 sc1
    buffer_load_dwordx4 v[28:31], v162, s[44:47], s56 offen offset:1024 sc1
    buffer_load_dwordx4 v[32:35], v162, s[44:47], s56 offen offset:2048 sc1
    buffer_load_dwordx4 v[36:39], v162, s[44:47], s56 offen offset:3072 sc1
    s_add_u32 s56, s56, 4096
    buffer_load_dwordx4 v[40:43], v162, s[44:47], s56 offen offset:0 sc1
    buffer_load_dwordx4 v[44:47], v162, s[44:47], s56 offen offset:1024 sc1
    buffer_load_dwordx4 v[48:51], v162, s[44:47], s56 offen offset:2048 sc1
    buffer_load_dwordx4 v[52:55], v162, s[44:47], s56 offen offset:3072 sc1
    s_add_u32 s56, s56, 4096
    buffer_load_dwordx4 v[56:59], v162, s[44:47], s56 offen offset:0 sc1
    buffer_load_dwordx4 v[60:63], v162, s[44:47], s56 offen offset:1024 sc1
    buffer_load_dwordx4 v[64:67], v162, s[44:47], s56 offen offset:2048 sc1
    buffer_load_dwordx4 v[68:71], v162, s[44:47], s56 offen offset:3072 sc1
    s_add_u32 s56, s56, 4096
    buffer_load_dwordx4 v[72:75], v162, s[44:47], s56 offen offset:0 sc1
    buffer_load_dwordx4 v[76:79], v162, s[44:47], s56 offen offset:1024 sc1
    buffer_load_dwordx4 v[80:83], v162, s[44:47], s56 offen offset:2048 sc1
    buffer_load_dwordx4 v[84:87], v162, s[44:47], s56 offen offset:3072 sc1
    s_add_u32 s56, s56, 4096
    buffer_load_dwordx4 v[88:91], v162, s[44:47], s56 offen offset:0 sc1
    buffer_load_dwordx4 v[92:95], v162, s[44:47], s56 offen offset:1024 sc1
    buffer_load_dwordx4 v[96:99], v162, s[44:47], s56 offen offset:2048 sc1
    buffer_load_dwordx4 v[100:103], v162, s[44:47], s56 offen offset:3072 sc1
    s_add_u32 s56, s56, 4096
    s_cmp_ge_u32 s58, 6
    s_cbranch_scc1 Lpg_35
    s_mov_b32 s15, 200000
Lpl_36:
    ds_read_b32 v164, v3 offset:104
    s_waitcnt lgkmcnt(0)
    v_readfirstlane_b32 s58, v164
    s_nop 0
    s_cmp_ge_u32 s58, 6
    s_cbranch_scc1 Lpg_35
    s_sleep 6
    s_sub_u32 s15, s15, 1
    s_cbranch_scc0 Lpl_36
Lpg_35:
    ds_read_b128 v[104:107], v136 offset:0
    ds_read_b128 v[108:111], v137 offset:0
    ds_read_b128 v[112:115], v138 offset:0
    ds_read_b128 v[116:119], v139 offset:0
    s_waitcnt vmcnt(20)
    s_waitcnt lgkmcnt(0)
    s_mov_b64 exec, 1
    v_mov_b32 v164, 6
    ds_write_b32 v163, v164 offset:112
    s_mov_b64 exec, -1
    s_setprio 0
    v_mfma_f32_32x32x16_bf16 v[120:135], v[8:11], v[104:107], 0
    v_mfma_f32_32x32x16_bf16 v[120:135], v[12:15], v[108:111], v[120:135]
    v_mfma_f32_32x32x16_bf16 v[120:135], v[16:19], v[112:115], v[120:135]
    v_mfma_f32_32x32x16_bf16 v[120:135], v[20:23], v[116:119], v[120:135]
    s_setprio 3
    buffer_load_dwordx4 v[8:11], v162, s[44:47], s56 offen offset:0 sc1
    buffer_load_dwordx4 v[12:15], v162, s[44:47], s56 offen offset:1024 sc1
    buffer_load_dwordx4 v[16:19], v162, s[44:47], s56 offen offset:2048 sc1
    buffer_load_dwordx4 v[20:23], v162, s[44:47], s56 offen offset:3072 sc1
    s_add_u32 s56, s56, 4096
    s_cmp_ge_u32 s58, 7
    s_cbranch_scc1 Lpg_37
    s_mov_b32 s15, 200000
Lpl_38:
    ds_read_b32 v164, v3 offset:104
    s_waitcnt lgkmcnt(0)
    v_readfirstlane_b32 s58, v164
    s_nop 0
    s_cmp_ge_u32 s58, 7
    s_cbranch_scc1 Lpg_37
    s_sleep 6
    s_sub_u32 s15, s15, 1
    s_cbranch_scc0 Lpl_38
Lpg_37:
    ds_read_b128 v[104:107], v136 offset:4096
    ds_read_b128 v[108:111], v137 offset:4096
    ds_read_b128 v[112:115], v138 offset:4096
    ds_read_b128 v[116:119], v139 offset:4096
    s_waitcnt vmcnt(20)
    s_waitcnt lgkmcnt(0)
    s_mov_b64 exec, 1
    v_mov_b32 v164, 7
    ds_write_b32 v163, v164 offset:112
    s_mov_b64 exec, -1
    s_setprio 0
    v_mfma_f32_32x32x16_bf16 v[120:135], v[24:27], v[104:107], v[120:135]
    v_mfma_f32_32x32x16_bf16 v[120:135], v[28:31], v[108:111], v[120:135]
    v_mfma_f32_32x32x16_bf16 v[120:135], v[32:35], v[112:115], v[120:135]
    v_mfma_f32_32x32x16_bf16 v[120:135], v[36:39], v[116:119], v[120:135]
    s_setprio 3
    buffer_load_dwordx4 v[24:27], v162, s[44:47], s56 offen offset:0 sc1
    buffer_load_dwordx4 v[28:31], v162, s[44:47], s56 offen offset:1024 sc1
    buffer_load_dwordx4 v[32:35], v162, s[44:47], s56 offen offset:2048 sc1
    buffer_load_dwordx4 v[36:39], v162, s[44:47], s56 offen offset:3072 sc1
    s_add_u32 s56, s56, 4096
    s_cmp_ge_u32 s58, 8
    s_cbranch_scc1 Lpg_39
    s_mov_b32 s15, 200000
Lpl_40:
    ds_read_b32 v164, v3 offset:104
    s_waitcnt lgkmcnt(0)
    v_readfirstlane_b32 s58, v164
    s_nop 0
    s_cmp_ge_u32 s58, 8
    s_cbranch_scc1 Lpg_39
    s_sleep 6
    s_sub_u32 s15, s15, 1
    s_cbranch_scc0 Lpl_40
Lpg_39:
    ds_read_b128 v[104:107], v136 offset:8192
    ds_read_b128 v[108:111], v137 offset:8192
    ds_read_b128 v[112:115], v138 offset:8192
    ds_read_b128 v[116:119], v139 offset:8192
    s_waitcnt vmcnt(20)
    s_waitcnt lgkmcnt(0)
    s_mov_b64 exec, 1
    v_mov_b32 v164, 8
    ds_write_b32 v163, v164 offset:112
    s_mov_b64 exec, -1
    s_setprio 0
    v_mfma_f32_32x32x16_bf16 v[120:135], v[40:43], v[104:107], v[120:135]
    v_mfma_f32_32x32x16_bf16 v[120:135], v[44:47], v[108:111], v[120:135]
    v_mfma_f32_32x32x16_bf16 v[120:135], v[48:51], v[112:115], v[120:135]
    v_mfma_f32_32x32x16_bf16 v[120:135], v[52:55], v[116:119], v[120:135]
    s_setprio 3
    buffer_load_dwordx4 v[40:43], v162, s[44:47], s56 offen offset:0 sc1
    s_add_u32 s56, s56, 4096
    s_cmp_ge_u32 s58, 9
    s_cbranch_scc1 Lpg_41
    s_mov_b32 s15, 200000
Lpl_42:
    ds_read_b32 v164, v3 offset:104
    s_waitcnt lgkmcnt(0)
    v_readfirstlane_b32 s58, v164
    s_nop 0
    s_cmp_ge_u32 s58, 9
    s_cbranch_scc1 Lpg_41
    s_sleep 6
    s_sub_u32 s15, s15, 1
    s_cbranch_scc0 Lpl_42
Lpg_41:
    ds_read_b128 v[104:107], v136 offset:12288
    ds_read_b128 v[108:111], v137 offset:12288
    ds_read_b128 v[112:115], v138 offset:12288
    ds_read_b128 v[116:119], v139 offset:12288
    s_waitcnt vmcnt(17)
    s_waitcnt lgkmcnt(0)
    s_mov_b64 exec, 1
    v_mov_b32 v164, 9
    ds_write_b32 v163, v164 offset:112
    s_mov_b64 exec, -1
    s_setprio 0
    v_mfma_f32_32x32x16_bf16 v[120:135], v[56:59], v[104:107], v[120:135]
    v_mfma_f32_32x32x16_bf16 v[120:135], v[60:63], v[108:111], v[120:135]
    v_mfma_f32_32x32x16_bf16 v[120:135], v[64:67], v[112:115], v[120:135]
    v_mfma_f32_32x32x16_bf16 v[120:135], v[68:71], v[116:119], v[120:135]
    s_setprio 3
    s_cmp_ge_u32 s58, 10
    s_cbranch_scc1 Lpg_43
    s_mov_b32 s15, 200000
Lpl_44:
    ds_read_b32 v164, v3 offset:104
    s_waitcnt lgkmcnt(0)
    v_readfirstlane_b32 s58, v164
    s_nop 0
    s_cmp_ge_u32 s58, 10
    s_cbranch_scc1 Lpg_43
    s_sleep 6
    s_sub_u32 s15, s15, 1
    s_cbranch_scc0 Lpl_44
Lpg_43:
    ds_read_b128 v[104:107], v136 offset:16384
    ds_read_b128 v[108:111], v137 offset:16384
    ds_read_b128 v[112:115], v138 offset:16384
    ds_read_b128 v[116:119], v139 offset:16384
    s_waitcnt vmcnt(13)
    s_waitcnt lgkmcnt(0)
    s_mov_b64 exec, 1
    v_mov_b32 v164, 10
    ds_write_b32 v163, v164 offset:112
    s_mov_b64 exec, -1
    s_setprio 0
    v_mfma_f32_32x32x16_bf16 v[120:135], v[72:75], v[104:107], v[120:135]
    v_mfma_f32_32x32x16_bf16 v[120:135], v[76:79], v[108:111], v[120:135]
    v_mfma_f32_32x32x16_bf16 v[120:135], v[80:83], v[112:115], v[120:135]
    v_mfma_f32_32x32x16_bf16 v[120:135], v[84:87], v[116:119], v[120:135]
    s_setprio 3
    s_cmp_ge_u32 s58, 11
    s_cbranch_scc1 Lpg_45
    s_mov_b32 s15, 200000
Lpl_46:
    ds_read_b32 v164, v3 offset:104
    s_waitcnt lgkmcnt(0)
    v_readfirstlane_b32 s58, v164
    s_nop 0
    s_cmp_ge_u32 s58, 11
    s_cbranch_scc1 Lpg_45
    s_sleep 6
    s_sub_u32 s15, s15, 1
    s_cbranch_scc0 Lpl_46
Lpg_45:
    ds_read_b128 v[104:107], v136 offset:20480
    ds_read_b128 v[108:111], v137 offset:20480
    ds_read_b128 v[112:115], v138 offset:20480
    ds_read_b128 v[116:119], v139 offset:20480
    s_waitcnt vmcnt(9)
    s_waitcnt lgkmcnt(0)
    s_mov_b64 exec, 1
    v_mov_b32 v164, 11
    ds_write_b32 v163, v164 offset:112
    s_mov_b64 exec, -1
    s_setprio 0
    v_mfma_f32_32x32x16_bf16 v[120:135], v[88:91], v[104:107], v[120:135]
    v_mfma_f32_32x32x16_bf16 v[120:135], v[92:95], v[108:111], v[120:135]
    v_mfma_f32_32x32x16_bf16 v[120:135], v[96:99], v[112:115], v[120:135]
    v_mfma_f32_32x32x16_bf16 v[120:135], v[100:103], v[116:119], v[120:135]
    s_setprio 3
    s_cmp_ge_u32 s58, 12
    s_cbranch_scc1 Lpg_47
    s_mov_b32 s15, 200000
Lpl_48:
    ds_read_b32 v164, v3 offset:104
    s_waitcnt lgkmcnt(0)
    v_readfirstlane_b32 s58, v164
    s_nop 0
    s_cmp_ge_u32 s58, 12
    s_cbranch_scc1 Lpg_47
    s_sleep 6
    s_sub_u32 s15, s15, 1
    s_cbranch_scc0 Lpl_48
Lpg_47:
    ds_read_b128 v[104:107], v136 offset:0
    ds_read_b128 v[108:111], v137 offset:0
    ds_read_b128 v[112:115], v138 offset:0
    ds_read_b128 v[116:119], v139 offset:0
    s_waitcnt vmcnt(5)
    s_waitcnt lgkmcnt(0)
    s_mov_b64 exec, 1
    v_mov_b32 v164, 12
    ds_write_b32 v163, v164 offset:112
    s_mov_b64 exec, -1
    s_setprio 0
    v_mfma_f32_32x32x16_bf16 v[120:135], v[8:11], v[104:107], v[120:135]
    v_mfma_f32_32x32x16_bf16 v[120:135], v[12:15], v[108:111], v[120:135]
    v_mfma_f32_32x32x16_bf16 v[120:135], v[16:19], v[112:115], v[120:135]
    v_mfma_f32_32x32x16_bf16 v[120:135], v[20:23], v[116:119], v[120:135]
    s_setprio 3
    s_cmp_ge_u32 s58, 13
    s_cbranch_scc1 Lpg_49
    s_mov_b32 s15, 200000
Lpl_50:
    ds_read_b32 v164, v3 offset:104
    s_waitcnt lgkmcnt(0)
    v_readfirstlane_b32 s58, v164
    s_nop 0
    s_cmp_ge_u32 s58, 13
    s_cbranch_scc1 Lpg_49
    s_sleep 6
    s_sub_u32 s15, s15, 1
    s_cbranch_scc0 Lpl_50
Lpg_49:
    ds_read_b128 v[104:107], v136 offset:4096
    ds_read_b128 v[108:111], v137 offset:4096
    ds_read_b128 v[112:115], v138 offset:4096
    ds_read_b128 v[116:119], v139 offset:4096
    s_waitcnt vmcnt(1)
    s_waitcnt lgkmcnt(0)
    s_mov_b64 exec, 1
    v_mov_b32 v164, 13
    ds_write_b32 v163, v164 offset:112
    s_mov_b64 exec, -1
    s_setprio 0
    v_mfma_f32_32x32x16_bf16 v[120:135], v[24:27], v[104:107], v[120:135]
    v_mfma_f32_32x32x16_bf16 v[120:135], v[28:31], v[108:111], v[120:135]
    v_mfma_f32_32x32x16_bf16 v[120:135], v[32:35], v[112:115], v[120:135]
    v_mfma_f32_32x32x16_bf16 v[120:135], v[36:39], v[116:119], v[120:135]
    s_setprio 3
    s_cmp_ge_u32 s58, 14
    s_cbranch_scc1 Lpg_51
    s_mov_b32 s15, 200000
Lpl_52:
    ds_read_b32 v164, v3 offset:104
    s_waitcnt lgkmcnt(0)
    v_readfirstlane_b32 s58, v164
    s_nop 0
    s_cmp_ge_u32 s58, 14
    s_cbranch_scc1 Lpg_51
    s_sleep 6
    s_sub_u32 s15, s15, 1
    s_cbranch_scc0 Lpl_52
Lpg_51:
    ds_read_b128 v[104:107], v136 offset:8192
    s_waitcnt vmcnt(0)
    s_waitcnt lgkmcnt(0)
    s_mov_b64 exec, 1
    v_mov_b32 v164, 14
    ds_write_b32 v163, v164 offset:112
    s_mov_b64 exec, -1
    s_setprio 0
    v_mfma_f32_32x32x16_bf16 v[120:135], v[40:43], v[104:107], v[120:135]
    s_setprio 3
Lh2st:
    s_lshr_b32 s12, s61, 1
    s_mul_i32 s56, s12, 696320
    s_mul_i32 s12, s54, 69632
    s_add_u32 s56, s56, s12
    s_add_u32 s56, s56, 5832704
    v_and_b32 v164, 31, v1
    v_lshl_add_u32 v164, v164, 1, s60
    v_lshrrev_b32 v165, 5, v1
    v_mul_u32_u24 v165, 8704, v165
    v_lshl_add_u32 v164, v164, 3, v165
    s_nop 4
    v_cvt_pk_bf16_f32 v120, v120, v121
    v_cvt_pk_bf16_f32 v121, v122, v123
    buffer_store_dwordx2 v[120:121], v164, s[44:47], s56 offen sc1
    s_add_u32 s56, s56, 17408
    v_cvt_pk_bf16_f32 v124, v124, v125
    v_cvt_pk_bf16_f32 v125, v126, v127
    buffer_store_dwordx2 v[124:125], v164, s[44:47], s56 offen sc1
    s_add_u32 s56, s56, 17408
    v_cvt_pk_bf16_f32 v128, v128, v129
    v_cvt_pk_bf16_f32 v129, v130, v131
    buffer_store_dwordx2 v[128:129], v164, s[44:47], s56 offen sc1
    s_add_u32 s56, s56, 17408
    v_cvt_pk_bf16_f32 v132, v132, v133
    v_cvt_pk_bf16_f32 v133, v134, v135
    buffer_store_dwordx2 v[132:133], v164, s[44:47], s56 offen sc1
    s_waitcnt vmcnt(0)
    s_add_u32 s13, s57, s55
    s_add_u32 s13, s13, 1536
    s_lshl_b32 s14, s13, 7
    s_add_u32 s14, s14, 4096
    s_mov_b64 exec, 1
    v_mov_b32 v164, s6
    v_mov_b32 v165, s7
    buffer_store_dwordx2 v[164:165], off, s[44:47], s14 sc1
    s_mov_b64 exec, -1
    s_branch Lh2done
Lh2x:
    s_mov_b64 exec, 1
    v_mov_b32 v164, 14
    ds_write_b32 v163, v164 offset:112
    s_mov_b64 exec, -1
    s_cmp_lt_u32 s61, 2
    s_cselect_b32 s92, s18, s20
    s_cselect_b32 s93, s19, s21
    s_mov_b32 s94, 8388608
    s_mov_b32 s95, 0x20000
    v_lshrrev_b32 v150, 1, v1
    s_lshl_b32 s12, s60, 12
    v_add_u32 v150, s12, v150
    s_mov_b32 s15, 20000
    s_mov_b64 exec, 0x1ffff
Lpoll_53:
    buffer_load_dwordx2 v[164:165], v143, s[44:47], 0 offen sc1
    s_waitcnt vmcnt(0)
    v_cmp_ne_u64 vcc, s[6:7], v[164:165]
    s_cbranch_vccz Lpd_54
    s_sleep 12
    s_sub_u32 s15, s15, 1
    s_cbranch_scc0 Lpoll_53
Lpd_54:
    s_mov_b64 exec, -1
    buffer_load_dwordx4 v[8:11], v162, s[44:47], s56 offen offset:0 sc1
    buffer_load_dwordx4 v[12:15], v162, s[44:47], s56 offen offset:1024 sc1
    buffer_load_dwordx4 v[16:19], v162, s[44:47], s56 offen offset:2048 sc1
    buffer_load_dwordx4 v[20:23], v162, s[44:47], s56 offen offset:3072 sc1
    s_add_u32 s56, s56, 4096
    buffer_load_dwordx4 v[24:27], v162, s[44:47], s56 offen offset:0 sc1
    buffer_load_dwordx4 v[28:31], v162, s[44:47], s56 offen offset:1024 sc1
    buffer_load_dwordx4 v[32:35], v162, s[44:47], s56 offen offset:2048 sc1
    buffer_load_dwordx4 v[36:39], v162, s[44:47], s56 offen offset:3072 sc1
    s_add_u32 s56, s56, 4096
    buffer_load_dwordx4 v[40:43], v162, s[44:47], s56 offen offset:0 sc1
    buffer_load_dwordx4 v[44:47], v162, s[44:47], s56 offen offset:1024 sc1
    buffer_load_dwordx4 v[48:51], v162, s[44:47], s56 offen offset:2048 sc1
    s_mov_b32 exec_lo, 1
    s_mov_b32 exec_hi, 1
    buffer_load_dwordx4 v[52:55], v150, s[92:95], 0 offen offset:0
    buffer_load_dwordx4 v[56:59], v150, s[92:95], 0 offen offset:32
    buffer_load_dwordx4 v[60:63], v150, s[92:95], 0 offen offset:64
    buffer_load_dwordx4 v[64:67], v150, s[92:95], 0 offen offset:96
    buffer_load_dwordx4 v[68:71], v150, s[92:95], 0 offen offset:128
    buffer_load_dwordx4 v[72:75], v150, s[92:95], 0 offen offset:160
    buffer_load_dwordx4 v[76:79], v150, s[92:95], 0 offen offset:192
    buffer_load_dwordx4 v[80:83], v150, s[92:95], 0 offen offset:224
    buffer_load_dwordx4 v[84:87], v150, s[92:95], 0 offen offset:256
    buffer_load_dwordx4 v[88:91], v150, s[92:95], 0 offen offset:288
    buffer_load_dwordx4 v[92:95], v150, s[92:95], 0 offen offset:320
    s_mov_b64 exec, -1
    s_waitcnt vmcnt(0)
    s_setprio 2
    v_mfma_f32_32x32x16_bf16 v[120:135], v[8:11], v[52:55], 0
    v_mfma_f32_32x32x16_bf16 v[120:135], v[12:15], v[56:59], v[120:135]
    v_mfma_f32_32x32x16_bf16 v[120:135], v[16:19], v[60:63], v[120:135]
    v_mfma_f32_32x32x16_bf16 v[120:135], v[20:23], v[64:67], v[120:135]
    v_mfma_f32_32x32x16_bf16 v[120:135], v[24:27], v[68:71], v[120:135]
    v_mfma_f32_32x32x16_bf16 v[120:135], v[28:31], v[72:75], v[120:135]
    v_mfma_f32_32x32x16_bf16 v[120:135], v[32:35], v[76:79], v[120:135]
    v_mfma_f32_32x32x16_bf16 v[120:135], v[36:39], v[80:83], v[120:135]
    v_mfma_f32_32x32x16_bf16 v[120:135], v[40:43], v[84:87], v[120:135]
    v_mfma_f32_32x32x16_bf16 v[120:135], v[44:47], v[88:91], v[120:135]
    v_mfma_f32_32x32x16_bf16 v[120:135], v[48:51], v[92:95], v[120:135]
    s_setprio 3
    s_add_u32 s56, s56, 3072
    buffer_load_dwordx4 v[8:11], v162, s[44:47], s56 offen offset:0 sc1
    buffer_load_dwordx4 v[12:15], v162, s[44:47], s56 offen offset:1024 sc1
    buffer_load_dwordx4 v[16:19], v162, s[44:47], s56 offen offset:2048 sc1
    buffer_load_dwordx4 v[20:23], v162, s[44:47], s56 offen offset:3072 sc1
    s_add_u32 s56, s56, 4096
    buffer_load_dwordx4 v[24:27], v162, s[44:47], s56 offen offset:0 sc1
    buffer_load_dwordx4 v[28:31], v162, s[44:47], s56 offen offset:1024 sc1
    buffer_load_dwordx4 v[32:35], v162, s[44:47], s56 offen offset:2048 sc1
    buffer_load_dwordx4 v[36:39], v162, s[44:47], s56 offen offset:3072 sc1
    s_add_u32 s56, s56, 4096
    buffer_load_dwordx4 v[40:43], v162, s[44:47], s56 offen offset:0 sc1
    buffer_load_dwordx4 v[44:47], v162, s[44:47], s56 offen offset:1024 sc1
    buffer_load_dwordx4 v[48:51], v162, s[44:47], s56 offen offset:2048 sc1
    s_mov_b32 exec_lo, 1
    s_mov_b32 exec_hi, 1
    buffer_load_dwordx4 v[52:55], v150, s[92:95], 0 offen offset:352
    buffer_load_dwordx4 v[56:59], v150, s[92:95], 0 offen offset:384
    buffer_load_dwordx4 v[60:63], v150, s[92:95], 0 offen offset:416
    buffer_load_dwordx4 v[64:67], v150, s[92:95], 0 offen offset:448
    buffer_load_dwordx4 v[68:71], v150, s[92:95], 0 offen offset:480
    buffer_load_dwordx4 v[72:75], v150, s[92:95], 0 offen offset:512
    buffer_load_dwordx4 v[76:79], v150, s[92:95], 0 offen offset:544
    buffer_load_dwordx4 v[80:83], v150, s[92:95], 0 offen offset:576
    buffer_load_dwordx4 v[84:87], v150, s[92:95], 0 offen offset:608
    buffer_load_dwordx4 v[88:91], v150, s[92:95], 0 offen offset:640
    buffer_load_dwordx4 v[92:95], v150, s[92:95], 0 offen offset:672
    s_mov_b64 exec, -1
    s_waitcnt vmcnt(0)
    s_setprio 2
    v_mfma_f32_32x32x16_bf16 v[120:135], v[8:11], v[52:55], v[120:135]
    v_mfma_f32_32x32x16_bf16 v[120:135], v[12:15], v[56:59], v[120:135]
    v_mfma_f32_32x32x16_bf16 v[120:135], v[16:19], v[60:63], v[120:135]
    v_mfma_f32_32x32x16_bf16 v[120:135], v[20:23], v[64:67], v[120:135]
    v_mfma_f32_32x32x16_bf16 v[120:135], v[24:27], v[68:71], v[120:135]
    v_mfma_f32_32x32x16_bf16 v[120:135], v[28:31], v[72:75], v[120:135]
    v_mfma_f32_32x32x16_bf16 v[120:135], v[32:35], v[76:79], v[120:135]
    v_mfma_f32_32x32x16_bf16 v[120:135], v[36:39], v[80:83], v[120:135]
    v_mfma_f32_32x32x16_bf16 v[120:135], v[40:43], v[84:87], v[120:135]
    v_mfma_f32_32x32x16_bf16 v[120:135], v[44:47], v[88:91], v[120:135]
    v_mfma_f32_32x32x16_bf16 v[120:135], v[48:51], v[92:95], v[120:135]
    s_setprio 3
    s_add_u32 s56, s56, 3072
    buffer_load_dwordx4 v[8:11], v162, s[44:47], s56 offen offset:0 sc1
    buffer_load_dwordx4 v[12:15], v162, s[44:47], s56 offen offset:1024 sc1
    buffer_load_dwordx4 v[16:19], v162, s[44:47], s56 offen offset:2048 sc1
    buffer_load_dwordx4 v[20:23], v162, s[44:47], s56 offen offset:3072 sc1
    s_add_u32 s56, s56, 4096
    buffer_load_dwordx4 v[24:27], v162, s[44:47], s56 offen offset:0 sc1
    buffer_load_dwordx4 v[28:31], v162, s[44:47], s56 offen offset:1024 sc1
    buffer_load_dwordx4 v[32:35], v162, s[44:47], s56 offen offset:2048 sc1
    buffer_load_dwordx4 v[36:39], v162, s[44:47], s56 offen offset:3072 sc1
    s_add_u32 s56, s56, 4096
    buffer_load_dwordx4 v[40:43], v162, s[44:47], s56 offen offset:0 sc1
    buffer_load_dwordx4 v[44:47], v162, s[44:47], s56 offen offset:1024 sc1
    buffer_load_dwordx4 v[48:51], v162, s[44:47], s56 offen offset:2048 sc1
    s_mov_b32 exec_lo, 1
    s_mov_b32 exec_hi, 1
    buffer_load_dwordx4 v[52:55], v150, s[92:95], 0 offen offset:704
    buffer_load_dwordx4 v[56:59], v150, s[92:95], 0 offen offset:736
    buffer_load_dwordx4 v[60:63], v150, s[92:95], 0 offen offset:768
    buffer_load_dwordx4 v[64:67], v150, s[92:95], 0 offen offset:800
    buffer_load_dwordx4 v[68:71], v150, s[92:95], 0 offen offset:832
    buffer_load_dwordx4 v[72:75], v150, s[92:95], 0 offen offset:864
    buffer_load_dwordx4 v[76:79], v150, s[92:95], 0 offen offset:896
    buffer_load_dwordx4 v[80:83], v150, s[92:95], 0 offen offset:928
    buffer_load_dwordx4 v[84:87], v150, s[92:95], 0 offen offset:960
    buffer_load_dwordx4 v[88:91], v150, s[92:95], 0 offen offset:992
    buffer_load_dwordx4 v[92:95], v150, s[92:95], 0 offen offset:1024
    s_mov_b64 exec, -1
    s_waitcnt vmcnt(0)
    s_setprio 2
    v_mfma_f32_32x32x16_bf16 v[120:135], v[8:11], v[52:55], v[120:135]
    v_mfma_f32_32x32x16_bf16 v[120:135], v[12:15], v[56:59], v[120:135]
    v_mfma_f32_32x32x16_bf16 v[120:135], v[16:19], v[60:63], v[120:135]
    v_mfma_f32_32x32x16_bf16 v[120:135], v[20:23], v[64:67], v[120:135]
    v_mfma_f32_32x32x16_bf16 v[120:135], v[24:27], v[68:71], v[120:135]
    v_mfma_f32_32x32x16_bf16 v[120:135], v[28:31], v[72:75], v[120:135]
    v_mfma_f32_32x32x16_bf16 v[120:135], v[32:35], v[76:79], v[120:135]
    v_mfma_f32_32x32x16_bf16 v[120:135], v[36:39], v[80:83], v[120:135]
    v_mfma_f32_32x32x16_bf16 v[120:135], v[40:43], v[84:87], v[120:135]
    v_mfma_f32_32x32x16_bf16 v[120:135], v[44:47], v[88:91], v[120:135]
    v_mfma_f32_32x32x16_bf16 v[120:135], v[48:51], v[92:95], v[120:135]
    s_setprio 3
    s_branch Lh2st
Lproducer:
    s_mov_b64 exec, 1
    v_mov_b32 v164, 1
    ds_add_u32 v3, v164 offset:152
    s_mov_b64 exec, -1
    s_getreg_b32 s12, hwreg(HW_REG_XCC_ID, 0, 4)
    s_xor_b32 s12, s12, s7
    v_mov_b32 v8, s6
    v_mov_b32 v9, s12
    s_lshl_b32 s13, s4, 3
    s_add_u32 s13, s13, s5
    s_add_u32 s13, s13, 512
    s_lshl_b32 s14, s13, 7
    s_add_u32 s14, s14, 4096
    s_mov_b64 exec, 1
    buffer_store_dwordx2 v[8:9], off, s[44:47], s14 sc1
    s_mov_b64 exec, -1
    s_cmp_lt_u32 s61, 2
    s_cselect_b32 s92, s22, s24
    s_cselect_b32 s93, s23, s25
    s_mov_b32 s94, 663552
    s_mov_b32 s95, 0x20000
    s_lshl_b32 s12, s52, 5
    v_add_u32 v164, s12, v142
    v_mul_u32_u24 v164, 1152, v164
    v_add_u32 v150, v164, v140
    v_add_u32 v151, v164, v141
    v_add_u32 v151, 9216, v151
    s_mov_b32 s52, 18432
    s_mov_b32 m0, 119808
    s_mov_b32 s12, 0
    buffer_load_dwordx4 v150, s[92:95], s12 offen lds
    s_mov_b32 m0, 120832
    s_nop 0
    buffer_load_dwordx4 v151, s[92:95], s12 offen lds
    s_mov_b32 m0, 121856
    s_add_u32 s12, s52, 0
    buffer_load_dwordx4 v150, s[92:95], s12 offen lds
    s_mov_b32 m0, 122880
    s_nop 0
    buffer_load_dwordx4 v151, s[92:95], s12 offen lds
    s_mov_b32 m0, 123904
    s_mov_b32 s12, 128
    buffer_load_dwordx4 v150, s[92:95], s12 offen lds
    s_mov_b32 m0, 124928
    s_nop 0
    buffer_load_dwordx4 v151, s[92:95], s12 offen lds
    s_mov_b32 m0, 125952
    s_add_u32 s12, s52, 128
    buffer_load_dwordx4 v150, s[92:95], s12 offen lds
    s_mov_b32 m0, 126976
    s_nop 0
    buffer_load_dwordx4 v151, s[92:95], s12 offen lds
    s_mov_b32 m0, 128000
    s_mov_b32 s12, 256
    buffer_load_dwordx4 v150, s[92:95], s12 offen lds
    s_mov_b32 m0, 129024
    s_nop 0
    buffer_load_dwordx4 v151, s[92:95], s12 offen lds
    s_mov_b32 m0, 130048
    s_add_u32 s12, s52, 256
    buffer_load_dwordx4 v150, s[92:95], s12 offen lds
    s_mov_b32 m0, 131072
    s_nop 0
    buffer_load_dwordx4 v151, s[92:95], s12 offen lds
    s_mov_b32 m0, 132096
    s_mov_b32 s12, 384
    buffer_load_dwordx4 v150, s[92:95], s12 offen lds
    s_mov_b32 m0, 133120
    s_nop 0
    buffer_load_dwordx4 v151, s[92:95], s12 offen lds
    s_mov_b32 m0, 134144
    s_add_u32 s12, s52, 384
    buffer_load_dwordx4 v150, s[92:95], s12 offen lds
    s_mov_b32 m0, 135168
    s_nop 0
    buffer_load_dwordx4 v151, s[92:95], s12 offen lds
    s_mov_b32 m0, 136192
    s_mov_b32 s12, 512
    buffer_load_dwordx4 v150, s[92:95], s12 offen lds
    s_mov_b32 m0, 137216
    s_nop 0
    buffer_load_dwordx4 v151, s[92:95], s12 offen lds
    s_mov_b32 m0, 138240
    s_add_u32 s12, s52, 512
    buffer_load_dwordx4 v150, s[92:95], s12 offen lds
    s_mov_b32 m0, 139264
    s_nop 0
    buffer_load_dwordx4 v151, s[92:95], s12 offen lds
    s_cmp_lt_u32 s61, 2
    s_cselect_b32 s92, s18, s20
    s_cselect_b32 s93, s19, s21
    s_mov_b32 s94, 8388608
    s_mov_b32 s95, 0x20000
    s_lshl_b32 s12, s55, 6
    s_and_b32 s13, s61, 1
    s_add_u32 s12, s12, s13
    v_lshl_add_u32 v164, v142, 1, s12
    v_lshl_add_u32 v150, v164, 12, v140
    v_lshl_add_u32 v151, v164, 12, v141
    v_add_u32 v151, 65536, v151
    s_mov_b32 s52, 131072
    s_waitcnt vmcnt(16)
    s_mov_b64 exec, 1
    v_mov_b32 v164, 1
    ds_write_b32 v3, v164 offset:104
    s_mov_b64 exec, -1
    s_waitcnt vmcnt(12)
    s_mov_b64 exec, 1
    v_mov_b32 v164, 2
    ds_write_b32 v3, v164 offset:104
    s_mov_b64 exec, -1
    s_waitcnt vmcnt(8)
    s_mov_b64 exec, 1
    v_mov_b32 v164, 3
    ds_write_b32 v3, v164 offset:104
    s_mov_b64 exec, -1
    s_waitcnt vmcnt(4)
    s_mov_b64 exec, 1
    v_mov_b32 v164, 4
    ds_write_b32 v3, v164 offset:104
    s_mov_b64 exec, -1
    s_waitcnt vmcnt(0)
    s_mov_b64 exec, 1
    v_mov_b32 v164, 5
    ds_write_b32 v3, v164 offset:104
    s_mov_b64 exec, -1
    s_mov_b32 s15, 20000
    s_mov_b64 exec, s[90:91]
Lpoll_55:
    buffer_load_dwordx2 v[164:165], v143, s[44:47], 0 offen sc1
    s_waitcnt vmcnt(0)
    v_cmp_ne_u64 vcc, s[6:7], v[164:165]
    s_cbranch_vccz Lpd_56
    s_sleep 2
    s_sub_u32 s15, s15, 1
    s_cbranch_scc0 Lpoll_55
Lpd_56:
    s_mov_b64 exec, -1
    s_mov_b32 s60, 101376
    s_mul_i32 s12, s16, 9216
    s_add_u32 s12, s12, 458752
    s_mov_b32 s13, s60
    s_mov_b32 m0, s13
    s_nop 0
    buffer_load_dwordx4 v162, s[44:47], s12 offen offset:0 sc1 lds
    buffer_load_dwordx4 v162, s[44:47], s12 offen offset:1024 sc1 lds
    buffer_load_dwordx4 v162, s[44:47], s12 offen offset:2048 sc1 lds
    buffer_load_dwordx4 v162, s[44:47], s12 offen offset:3072 sc1 lds
    s_add_u32 s12, s12, 4096
    s_add_u32 s13, s13, 4096
    s_mov_b32 m0, s13
    s_nop 0
    buffer_load_dwordx4 v162, s[44:47], s12 offen offset:0 sc1 lds
    buffer_load_dwordx4 v162, s[44:47], s12 offen offset:1024 sc1 lds
    buffer_load_dwordx4 v162, s[44:47], s12 offen offset:2048 sc1 lds
    buffer_load_dwordx4 v162, s[44:47], s12 offen offset:3072 sc1 lds
    s_add_u32 s12, s12, 4096
    s_add_u32 s13, s13, 4096
    s_mov_b32 m0, s13
    s_nop 0
    buffer_load_dwordx4 v162, s[44:47], s12 offen offset:0 sc1 lds
    s_lshl_b32 s12, s4, 10
    s_add_u32 s12, s12, 69632
    v_lshl_add_u32 v40, v1, 7, s12
    s_getreg_b32 s14, hwreg(HW_REG_XCC_ID, 0, 4)
    s_mov_b32 s15, 20000
    s_mov_b64 exec, 0xff
Lfx_57:
    buffer_load_dwordx2 v[42:43], v40, s[44:47], 0 offen sc1
    s_waitcnt vmcnt(0)
    v_xor_b32 v43, s7, v43
    v_cmp_ne_u32 vcc, s6, v42
    v_cmp_lt_u32 s[12:13], 15, v43
    s_nop 0
    s_or_b64 vcc, vcc, s[12:13]
    s_cbranch_vccz Lfxd_58
    s_sleep 4
    s_sub_u32 s15, s15, 1
    s_cbranch_scc0 Lfx_57
Lfxd_58:
    v_cmp_ne_u32 s[12:13], s14, v43
    s_nop 0
    s_or_b64 vcc, vcc, s[12:13]
    s_cselect_b32 s12, 0, 1
    s_mov_b64 exec, -1
    s_mov_b64 exec, 1
    v_mov_b32 v42, s12
    ds_write_b32 v3, v42 offset:172
    s_mov_b64 exec, -1
    s_mov_b64 exec, 1
    v_mov_b32 v164, 1
    ds_add_u32 v3, v164 offset:156
    s_mov_b64 exec, -1
    s_cmp_eq_u32 s12, 0
    s_cbranch_scc1 Lnopre
    s_mul_i32 s12, s4, 73728
    s_add_u32 s12, s12, 2031616
    s_lshl_b32 s13, s5, 11
    s_add_u32 s13, s13, s12
    buffer_load_dwordx4 v[44:47], v162, s[44:47], s13 offen offset:0 sc1
    buffer_load_dwordx4 v[44:47], v162, s[44:47], s13 offen offset:1024 sc1
    s_add_u32 s13, s13, 18432
    buffer_load_dwordx4 v[44:47], v162, s[44:47], s13 offen offset:0 sc1
    buffer_load_dwordx4 v[44:47], v162, s[44:47], s13 offen offset:1024 sc1
    s_add_u32 s13, s13, 18432
    buffer_load_dwordx4 v[44:47], v162, s[44:47], s13 offen offset:0 sc1
    buffer_load_dwordx4 v[44:47], v162, s[44:47], s13 offen offset:1024 sc1
    s_add_u32 s13, s13, 18432
    buffer_load_dwordx4 v[44:47], v162, s[44:47], s13 offen offset:0 sc1
    buffer_load_dwordx4 v[44:47], v162, s[44:47], s13 offen offset:1024 sc1
    s_lshl_b32 s13, s5, 8
    s_add_u32 s13, s13, s12
    s_add_u32 s13, s13, 16384
    v_mul_u32_u24 v48, 18432, v5
    v_lshl_add_u32 v48, v4, 4, v48
    buffer_load_dwordx4 v[44:47], v48, s[44:47], s13 offen sc1
Lnopre:
    s_mov_b32 s48, s34
    s_mov_b32 s49, s35
    s_mov_b32 s50, 663552
    s_mov_b32 s51, 0x20000
    v_lshrrev_b32 v32, 2, v162
    v_add_u32 v32, 160512, v32
    ds_read_u16 v8, v32 offset:0
    ds_read_u16 v20, v32 offset:2
    ds_read_u16 v9, v32 offset:256
    ds_read_u16 v21, v32 offset:258
    ds_read_u16 v10, v32 offset:512
    ds_read_u16 v22, v32 offset:514
    ds_read_u16 v11, v32 offset:768
    ds_read_u16 v23, v32 offset:770
    ds_read_u16 v12, v32 offset:1024
    ds_read_u16 v24, v32 offset:1026
    ds_read_u16 v13, v32 offset:1280
    ds_read_u16 v25, v32 offset:1282
    ds_read_u16 v14, v32 offset:1536
    ds_read_u16 v26, v32 offset:1538
    s_waitcnt lgkmcnt(6)
    ds_read_u16 v15, v32 offset:1792
    ds_read_u16 v27, v32 offset:1794
    ds_read_u16 v16, v32 offset:2048
    ds_read_u16 v28, v32 offset:2050
    v_and_b32 v119, 7, v1
    v_lshl_add_u32 v119, v5, 3, v119
    v_lshlrev_b32 v119, 4, v119
    v_add_u32 v120, 27648, v162
    v_add_u32 v116, 31744, v119
    v_add_u32 v121, 73728, v162
    v_add_u32 v117, 77824, v119
    v_add_u32 v122, 147456, v162
    v_add_u32 v118, 151552, v119
    v_add_u32 v36, 27648, v157
    v_add_u32 v37, 73728, v157
    v_add_u32 v38, 147456, v157
    s_mov_b32 s15, 200000
Lspin_59:
    ds_read_b32 v164, v3 offset:24
    s_waitcnt lgkmcnt(0)
    v_readfirstlane_b32 s14, v164
    s_nop 0
    s_cmp_ge_u32 s14, 4
    s_cbranch_scc1 Lsd_60
    s_sleep 8
    s_sub_u32 s15, s15, 1
    s_cbranch_scc0 Lspin_59
Lsd_60:
    v_lshlrev_b32 v8, 4, v8
    v_lshlrev_b32 v20, 4, v20
    v_lshlrev_b32 v9, 4, v9
    v_lshlrev_b32 v21, 4, v21
    v_lshlrev_b32 v10, 4, v10
    v_lshlrev_b32 v22, 4, v22
    v_lshlrev_b32 v11, 4, v11
    v_lshlrev_b32 v23, 4, v23
    v_lshlrev_b32 v12, 4, v12
    v_lshlrev_b32 v24, 4, v24
    v_lshlrev_b32 v13, 4, v13
    v_lshlrev_b32 v25, 4, v25
    v_lshlrev_b32 v14, 4, v14
    v_lshlrev_b32 v26, 4, v26
    v_lshlrev_b32 v15, 4, v15
    v_lshlrev_b32 v27, 4, v27
    v_lshlrev_b32 v16, 4, v16
    v_lshlrev_b32 v28, 4, v28
    s_mov_b32 m0, 0
    s_mov_b32 s12, 0
    buffer_load_dwordx4 v150, s[92:95], s12 offen lds
    s_mov_b32 m0, 1024
    s_nop 0
    buffer_load_dwordx4 v151, s[92:95], s12 offen lds
    s_mov_b32 m0, 2048
    s_add_u32 s12, s52, 0
    buffer_load_dwordx4 v150, s[92:95], s12 offen lds
    s_mov_b32 m0, 3072
    s_nop 0
    buffer_load_dwordx4 v151, s[92:95], s12 offen lds
    s_mov_b32 m0, 4096
    s_mov_b32 s12, 128
    buffer_load_dwordx4 v150, s[92:95], s12 offen lds
    s_mov_b32 m0, 5120
    s_nop 0
    buffer_load_dwordx4 v151, s[92:95], s12 offen lds
    s_mov_b32 m0, 6144
    s_add_u32 s12, s52, 128
    buffer_load_dwordx4 v150, s[92:95], s12 offen lds
    s_mov_b32 m0, 7168
    s_nop 0
    buffer_load_dwordx4 v151, s[92:95], s12 offen lds
    s_mov_b32 m0, 8192
    s_mov_b32 s12, 256
    buffer_load_dwordx4 v150, s[92:95], s12 offen lds
    s_mov_b32 m0, 9216
    s_nop 0
    buffer_load_dwordx4 v151, s[92:95], s12 offen lds
    s_mov_b32 m0, 10240
    s_add_u32 s12, s52, 256
    buffer_load_dwordx4 v150, s[92:95], s12 offen lds
    s_mov_b32 m0, 11264
    s_nop 0
    buffer_load_dwordx4 v151, s[92:95], s12 offen lds
    s_mov_b32 m0, 12288
    s_mov_b32 s12, 384
    buffer_load_dwordx4 v150, s[92:95], s12 offen lds
    s_mov_b32 m0, 13312
    s_nop 0
    buffer_load_dwordx4 v151, s[92:95], s12 offen lds
    s_mov_b32 m0, 14336
    s_add_u32 s12, s52, 384
    buffer_load_dwordx4 v150, s[92:95], s12 offen lds
    s_mov_b32 m0, 15360
    s_nop 0
    buffer_load_dwordx4 v151, s[92:95], s12 offen lds
    s_mov_b32 m0, 16384
    s_mov_b32 s12, 512
    buffer_load_dwordx4 v150, s[92:95], s12 offen lds
    s_mov_b32 m0, 17408
    s_nop 0
    buffer_load_dwordx4 v151, s[92:95], s12 offen lds
    s_mov_b32 m0, 18432
    s_add_u32 s12, s52, 512
    buffer_load_dwordx4 v150, s[92:95], s12 offen lds
    s_mov_b32 m0, 19456
    s_nop 0
    buffer_load_dwordx4 v151, s[92:95], s12 offen lds
    s_mov_b32 m0, 20480
    s_mov_b32 s12, 640
    buffer_load_dwordx4 v150, s[92:95], s12 offen lds
    s_mov_b32 m0, 21504
    s_nop 0
    buffer_load_dwordx4 v151, s[92:95], s12 offen lds
    s_mov_b32 m0, 22528
    s_add_u32 s12, s52, 640
    buffer_load_dwordx4 v150, s[92:95], s12 offen lds
    s_mov_b32 m0, 23552
    s_nop 0
    buffer_load_dwordx4 v151, s[92:95], s12 offen lds
    s_waitcnt vmcnt(20)
    s_mov_b64 exec, 1
    v_mov_b32 v164, 6
    ds_write_b32 v3, v164 offset:104
    s_mov_b64 exec, -1
    s_waitcnt vmcnt(16)
    s_mov_b64 exec, 1
    v_mov_b32 v164, 7
    ds_write_b32 v3, v164 offset:104
    s_mov_b64 exec, -1
    s_waitcnt vmcnt(12)
    s_mov_b64 exec, 1
    v_mov_b32 v164, 8
    ds_write_b32 v3, v164 offset:104
    s_mov_b64 exec, -1
    s_waitcnt vmcnt(8)
    s_mov_b64 exec, 1
    v_mov_b32 v164, 9
    ds_write_b32 v3, v164 offset:104
    s_mov_b64 exec, -1
    s_waitcnt vmcnt(4)
    s_mov_b64 exec, 1
    v_mov_b32 v164, 10
    ds_write_b32 v3, v164 offset:104
    s_mov_b64 exec, -1
    s_waitcnt vmcnt(0)
    s_mov_b64 exec, 1
    v_mov_b32 v164, 11
    ds_write_b32 v3, v164 offset:104
    s_mov_b64 exec, -1
    s_mov_b32 s58, 0
    s_cmp_ge_u32 s58, 5
    s_cbranch_scc1 Lpg_61
    s_mov_b32 s15, 200000
Lpl_62:
    ds_read_b128 v[164:167], v3 offset:112
    s_waitcnt lgkmcnt(0)
    v_min3_u32 v164, v164, v165, v166
    s_nop 0
    v_readfirstlane_b32 s58, v164
    s_nop 0
    s_cmp_ge_u32 s58, 5
    s_cbranch_scc1 Lpg_61
    s_sleep 6
    s_sub_u32 s15, s15, 1
    s_cbranch_scc0 Lpl_62
Lpg_61:
    s_mov_b32 s60, 119808
    s_mul_i32 s12, s17, 9216
    s_add_u32 s12, s12, 458752
    s_mov_b32 s13, s60
    s_mov_b32 m0, s13
    s_nop 0
    buffer_load_dwordx4 v162, s[44:47], s12 offen offset:0 sc1 lds
    buffer_load_dwordx4 v162, s[44:47], s12 offen offset:1024 sc1 lds
    buffer_load_dwordx4 v162, s[44:47], s12 offen offset:2048 sc1 lds
    buffer_load_dwordx4 v162, s[44:47], s12 offen offset:3072 sc1 lds
    s_add_u32 s12, s12, 4096
    s_add_u32 s13, s13, 4096
    s_mov_b32 m0, s13
    s_nop 0
    buffer_load_dwordx4 v162, s[44:47], s12 offen offset:0 sc1 lds
    buffer_load_dwordx4 v162, s[44:47], s12 offen offset:1024 sc1 lds
    buffer_load_dwordx4 v162, s[44:47], s12 offen offset:2048 sc1 lds
    buffer_load_dwordx4 v162, s[44:47], s12 offen offset:3072 sc1 lds
    s_add_u32 s12, s12, 4096
    s_add_u32 s13, s13, 4096
    s_mov_b32 m0, s13
    s_nop 0
    buffer_load_dwordx4 v162, s[44:47], s12 offen offset:0 sc1 lds
    s_mov_b32 s60, 129024
    s_mul_i32 s12, s36, 9216
    s_add_u32 s12, s12, 458752
    s_mov_b32 s13, s60
    s_mov_b32 m0, s13
    s_nop 0
    buffer_load_dwordx4 v162, s[44:47], s12 offen offset:0 sc1 lds
    buffer_load_dwordx4 v162, s[44:47], s12 offen offset:1024 sc1 lds
    buffer_load_dwordx4 v162, s[44:47], s12 offen offset:2048 sc1 lds
    buffer_load_dwordx4 v162, s[44:47], s12 offen offset:3072 sc1 lds
    s_add_u32 s12, s12, 4096
    s_add_u32 s13, s13, 4096
    s_mov_b32 m0, s13
    s_nop 0
    buffer_load_dwordx4 v162, s[44:47], s12 offen offset:0 sc1 lds
    buffer_load_dwordx4 v162, s[44:47], s12 offen offset:1024 sc1 lds
    buffer_load_dwordx4 v162, s[44:47], s12 offen offset:2048 sc1 lds
    buffer_load_dwordx4 v162, s[44:47], s12 offen offset:3072 sc1 lds
    s_add_u32 s12, s12, 4096
    s_add_u32 s13, s13, 4096
    s_mov_b32 m0, s13
    s_nop 0
    buffer_load_dwordx4 v162, s[44:47], s12 offen offset:0 sc1 lds
    s_mov_b32 s60, 138240
    s_mul_i32 s12, s37, 9216
    s_add_u32 s12, s12, 458752
    s_mov_b32 s13, s60
    s_mov_b32 m0, s13
    s_nop 0
    buffer_load_dwordx4 v162, s[44:47], s12 offen offset:0 sc1 lds
    buffer_load_dwordx4 v162, s[44:47], s12 offen offset:1024 sc1 lds
    buffer_load_dwordx4 v162, s[44:47], s12 offen offset:2048 sc1 lds
    buffer_load_dwordx4 v162, s[44:47], s12 offen offset:3072 sc1 lds
    s_add_u32 s12, s12, 4096
    s_add_u32 s13, s13, 4096
    s_mov_b32 m0, s13
    s_nop 0
    buffer_load_dwordx4 v162, s[44:47], s12 offen offset:0 sc1 lds
    buffer_load_dwordx4 v162, s[44:47], s12 offen offset:1024 sc1 lds
    buffer_load_dwordx4 v162, s[44:47], s12 offen offset:2048 sc1 lds
    buffer_load_dwordx4 v162, s[44:47], s12 offen offset:3072 sc1 lds
    s_add_u32 s12, s12, 4096
    s_add_u32 s13, s13, 4096
    s_mov_b32 m0, s13
    s_nop 0
    buffer_load_dwordx4 v162, s[44:47], s12 offen offset:0 sc1 lds
    s_waitcnt vmcnt(0)
    s_mov_b64 exec, 1
    v_mov_b32 v164, 4
    ds_write_b32 v3, v164 offset:160
    s_mov_b64 exec, -1
    s_cmp_eq_u32 s2, 0
    s_cbranch_scc0 Lnoep
    v_lshlrev_b32 v40, 7, v1
    v_add_u32 v40, 69632, v40
    s_mov_b32 s15, 20000
Lep_63:
    s_mov_b32 s12, 0
    buffer_load_dwordx2 v[42:43], v40, s[44:47], s12 offen sc1
    s_mov_b32 s12, 8192
    buffer_load_dwordx2 v[44:45], v40, s[44:47], s12 offen sc1
    s_mov_b32 s12, 16384
    buffer_load_dwordx2 v[46:47], v40, s[44:47], s12 offen sc1
    s_mov_b32 s12, 24576
    buffer_load_dwordx2 v[48:49], v40, s[44:47], s12 offen sc1
    s_waitcnt vmcnt(0)
    s_mov_b64 s[90:91], 0
    v_xor_b32 v43, s7, v43
    v_cmp_ne_u32 vcc, s6, v42
    v_cmp_lt_u32 s[12:13], 15, v43
    s_or_b64 s[90:91], s[90:91], vcc
    s_or_b64 s[90:91], s[90:91], s[12:13]
    v_xor_b32 v45, s7, v45
    v_cmp_ne_u32 vcc, s6, v44
    v_cmp_lt_u32 s[12:13], 15, v45
    s_or_b64 s[90:91], s[90:91], vcc
    s_or_b64 s[90:91], s[90:91], s[12:13]
    v_xor_b32 v47, s7, v47
    v_cmp_ne_u32 vcc, s6, v46
    v_cmp_lt_u32 s[12:13], 15, v47
    s_or_b64 s[90:91], s[90:91], vcc
    s_or_b64 s[90:91], s[90:91], s[12:13]
    v_xor_b32 v49, s7, v49
    v_cmp_ne_u32 vcc, s6, v48
    v_cmp_lt_u32 s[12:13], 15, v49
    s_or_b64 s[90:91], s[90:91], vcc
    s_or_b64 s[90:91], s[90:91], s[12:13]
    s_cbranch_scc0 Lepok
    s_sleep 8
    s_sub_u32 s15, s15, 1
    s_cbranch_scc0 Lep_63
Lepok:
    s_mov_b64 exec, 1
    v_mov_b32 v164, s6
    buffer_store_dword v164, off, s[44:47], 0 sc1
    s_mov_b64 exec, -1
Lnoep:
    s_mov_b32 s15, 200000
Lspin_64:
    ds_read_b32 v164, v3 offset:168
    s_waitcnt lgkmcnt(0)
    v_readfirstlane_b32 s14, v164
    s_nop 0
    s_cmp_ge_u32 s14, 8
    s_cbranch_scc1 Lsd_65
    s_sleep 8
    s_sub_u32 s15, s15, 1
    s_cbranch_scc0 Lspin_64
Lsd_65:
    s_mov_b32 s15, 200000
Lspin_66:
    ds_read_b32 v164, v3 offset:32
    s_waitcnt lgkmcnt(0)
    v_readfirstlane_b32 s14, v164
    s_nop 0
    s_cmp_ge_u32 s14, 4
    s_cbranch_scc1 Lsd_67
    s_sleep 8
    s_sub_u32 s15, s15, 1
    s_cbranch_scc0 Lspin_66
Lsd_67:
    s_mov_b32 s55, 0
    s_mov_b32 m0, 147456
    s_nop 0
    buffer_load_dwordx4 v20, s[48:51], s55 offen lds
    s_mov_b32 m0, 148480
    s_nop 0
    buffer_load_dwordx4 v21, s[48:51], s55 offen lds
    s_mov_b32 m0, 149504
    s_nop 0
    buffer_load_dwordx4 v22, s[48:51], s55 offen lds
    s_mov_b32 m0, 150528
    s_nop 0
    buffer_load_dwordx4 v23, s[48:51], s55 offen lds
    s_mov_b32 m0, 151552
    s_nop 0
    buffer_load_dwordx4 v24, s[48:51], s55 offen lds
    s_mov_b32 m0, 152576
    s_nop 0
    buffer_load_dwordx4 v25, s[48:51], s55 offen lds
    s_mov_b32 m0, 153600
    s_nop 0
    buffer_load_dwordx4 v26, s[48:51], s55 offen lds
    s_mov_b32 m0, 154624
    s_nop 0
    buffer_load_dwordx4 v27, s[48:51], s55 offen lds
    s_mov_b32 m0, 155648
    s_nop 0
    buffer_load_dwordx4 v28, s[48:51], s55 offen lds
    s_mov_b32 s55, 0
    s_mov_b32 m0, 27648
    s_nop 0
    buffer_load_dwordx4 v8, s[48:51], s55 offen lds
    s_mov_b32 m0, 28672
    s_nop 0
    buffer_load_dwordx4 v9, s[48:51], s55 offen lds
    s_mov_b32 m0, 29696
    s_nop 0
    buffer_load_dwordx4 v10, s[48:51], s55 offen lds
    s_mov_b32 m0, 30720
    s_nop 0
    buffer_load_dwordx4 v11, s[48:51], s55 offen lds
    s_mov_b32 m0, 31744
    s_nop 0
    buffer_load_dwordx4 v12, s[48:51], s55 offen lds
    s_mov_b32 m0, 32768
    s_nop 0
    buffer_load_dwordx4 v13, s[48:51], s55 offen lds
    s_mov_b32 m0, 33792
    s_nop 0
    buffer_load_dwordx4 v14, s[48:51], s55 offen lds
    s_mov_b32 m0, 34816
    s_nop 0
    buffer_load_dwordx4 v15, s[48:51], s55 offen lds
    s_mov_b32 m0, 35840
    s_nop 0
    buffer_load_dwordx4 v16, s[48:51], s55 offen lds
    s_mov_b32 s55, 82944
    s_mov_b32 m0, 36864
    s_nop 0
    buffer_load_dwordx4 v8, s[48:51], s55 offen lds
    s_mov_b32 m0, 37888
    s_nop 0
    buffer_load_dwordx4 v9, s[48:51], s55 offen lds
    s_mov_b32 m0, 38912
    s_nop 0
    buffer_load_dwordx4 v10, s[48:51], s55 offen lds
    s_mov_b32 m0, 39936
    s_nop 0
    buffer_load_dwordx4 v11, s[48:51], s55 offen lds
    s_mov_b32 m0, 40960
    s_nop 0
    buffer_load_dwordx4 v12, s[48:51], s55 offen lds
    s_mov_b32 m0, 41984
    s_nop 0
    buffer_load_dwordx4 v13, s[48:51], s55 offen lds
    s_mov_b32 m0, 43008
    s_nop 0
    buffer_load_dwordx4 v14, s[48:51], s55 offen lds
    s_mov_b32 m0, 44032
    s_nop 0
    buffer_load_dwordx4 v15, s[48:51], s55 offen lds
    s_mov_b32 m0, 45056
    s_nop 0
    buffer_load_dwordx4 v16, s[48:51], s55 offen lds
    s_mov_b32 s15, 200000
Lspin_68:
    ds_read_b32 v164, v3 offset:176
    s_waitcnt lgkmcnt(0)
    v_readfirstlane_b32 s14, v164
    s_nop 0
    s_cmp_ge_u32 s14, 4
    s_cbranch_scc1 Lsd_69
    s_sleep 8
    s_sub_u32 s15, s15, 1
    s_cbranch_scc0 Lspin_68
Lsd_69:
    s_mov_b32 s55, 165888
    s_mov_b32 m0, 46080
    s_nop 0
    buffer_load_dwordx4 v8, s[48:51], s55 offen lds
    s_mov_b32 m0, 47104
    s_nop 0
    buffer_load_dwordx4 v9, s[48:51], s55 offen lds
    s_mov_b32 m0, 48128
    s_nop 0
    buffer_load_dwordx4 v10, s[48:51], s55 offen lds
    s_mov_b32 m0, 49152
    s_nop 0
    buffer_load_dwordx4 v11, s[48:51], s55 offen lds
    s_mov_b32 m0, 50176
    s_nop 0
    buffer_load_dwordx4 v12, s[48:51], s55 offen lds
    s_mov_b32 m0, 51200
    s_nop 0
    buffer_load_dwordx4 v13, s[48:51], s55 offen lds
    s_mov_b32 m0, 52224
    s_nop 0
    buffer_load_dwordx4 v14, s[48:51], s55 offen lds
    s_mov_b32 m0, 53248
    s_nop 0
    buffer_load_dwordx4 v15, s[48:51], s55 offen lds
    s_mov_b32 m0, 54272
    s_nop 0
    buffer_load_dwordx4 v16, s[48:51], s55 offen lds
    s_cmp_ge_u32 s58, 6
    s_cbranch_scc1 Lpg_70
    s_mov_b32 s15, 200000
Lpl_71:
    ds_read_b128 v[164:167], v3 offset:112
    s_waitcnt lgkmcnt(0)
    v_min3_u32 v164, v164, v165, v166
    s_nop 0
    v_readfirstlane_b32 s58, v164
    s_nop 0
    s_cmp_ge_u32 s58, 6
    s_cbranch_scc1 Lpg_70
    s_sleep 6
    s_sub_u32 s15, s15, 1
    s_cbranch_scc0 Lpl_71
Lpg_70:
    s_mov_b32 m0, 0
    s_mov_b32 s12, 768
    buffer_load_dwordx4 v150, s[92:95], s12 offen lds
    s_mov_b32 m0, 1024
    s_nop 0
    buffer_load_dwordx4 v151, s[92:95], s12 offen lds
    s_mov_b32 m0, 2048
    s_add_u32 s12, s52, 768
    buffer_load_dwordx4 v150, s[92:95], s12 offen lds
    s_mov_b32 m0, 3072
    s_nop 0
    buffer_load_dwordx4 v151, s[92:95], s12 offen lds
    s_cmp_ge_u32 s58, 7
    s_cbranch_scc1 Lpg_72
    s_mov_b32 s15, 200000
Lpl_73:
    ds_read_b128 v[164:167], v3 offset:112
    s_waitcnt lgkmcnt(0)
    v_min3_u32 v164, v164, v165, v166
    s_nop 0
    v_readfirstlane_b32 s58, v164
    s_nop 0
    s_cmp_ge_u32 s58, 7
    s_cbranch_scc1 Lpg_72
    s_sleep 6
    s_sub_u32 s15, s15, 1
    s_cbranch_scc0 Lpl_73
Lpg_72:
    s_mov_b32 m0, 4096
    s_mov_b32 s12, 896
    buffer_load_dwordx4 v150, s[92:95], s12 offen lds
    s_mov_b32 m0, 5120
    s_nop 0
    buffer_load_dwordx4 v151, s[92:95], s12 offen lds
    s_mov_b32 m0, 6144
    s_add_u32 s12, s52, 896
    buffer_load_dwordx4 v150, s[92:95], s12 offen lds
    s_mov_b32 m0, 7168
    s_nop 0
    buffer_load_dwordx4 v151, s[92:95], s12 offen lds
    s_cmp_ge_u32 s58, 8
    s_cbranch_scc1 Lpg_74
    s_mov_b32 s15, 200000
Lpl_75:
    ds_read_b128 v[164:167], v3 offset:112
    s_waitcnt lgkmcnt(0)
    v_min3_u32 v164, v164, v165, v166
    s_nop 0
    v_readfirstlane_b32 s58, v164
    s_nop 0
    s_cmp_ge_u32 s58, 8
    s_cbranch_scc1 Lpg_74
    s_sleep 6
    s_sub_u32 s15, s15, 1
    s_cbranch_scc0 Lpl_75
Lpg_74:
    s_mov_b32 m0, 8192
    s_mov_b32 s12, 1024
    buffer_load_dwordx4 v150, s[92:95], s12 offen lds
    s_mov_b32 m0, 9216
    s_nop 0
    buffer_load_dwordx4 v151, s[92:95], s12 offen lds
    s_mov_b32 m0, 10240
    s_add_u32 s12, s52, 1024
    buffer_load_dwordx4 v150, s[92:95], s12 offen lds
    s_mov_b32 m0, 11264
    s_nop 0
    buffer_load_dwordx4 v151, s[92:95], s12 offen lds
    s_waitcnt vmcnt(8)
    s_mov_b64 exec, 1
    v_mov_b32 v164, 12
    ds_write_b32 v3, v164 offset:104
    s_mov_b64 exec, -1
    s_waitcnt vmcnt(4)
    s_mov_b64 exec, 1
    v_mov_b32 v164, 13
    ds_write_b32 v3, v164 offset:104
    s_mov_b64 exec, -1
    s_waitcnt vmcnt(0)
    s_mov_b64 exec, 1
    v_mov_b32 v164, 14
    ds_write_b32 v3, v164 offset:104
    s_mov_b64 exec, -1
    s_mov_b32 s15, 200000
Lspin_76:
    ds_read_b32 v164, v3 offset:28
    s_waitcnt lgkmcnt(0)
    v_readfirstlane_b32 s14, v164
    s_nop 0
    s_cmp_ge_u32 s14, 4
    s_cbranch_scc1 Lsd_77
    s_sleep 8
    s_sub_u32 s15, s15, 1
    s_cbranch_scc0 Lspin_76
Lsd_77:
    s_mov_b32 s55, 248832
    s_mov_b32 m0, 73728
    s_nop 0
    buffer_load_dwordx4 v8, s[48:51], s55 offen lds
    s_mov_b32 m0, 74752
    s_nop 0
    buffer_load_dwordx4 v9, s[48:51], s55 offen lds
    s_mov_b32 m0, 75776
    s_nop 0
    buffer_load_dwordx4 v10, s[48:51], s55 offen lds
    s_mov_b32 m0, 76800
    s_nop 0
    buffer_load_dwordx4 v11, s[48:51], s55 offen lds
    s_mov_b32 m0, 77824
    s_nop 0
    buffer_load_dwordx4 v12, s[48:51], s55 offen lds
    s_mov_b32 m0, 78848
    s_nop 0
    buffer_load_dwordx4 v13, s[48:51], s55 offen lds
    s_mov_b32 m0, 79872
    s_nop 0
    buffer_load_dwordx4 v14, s[48:51], s55 offen lds
    s_mov_b32 m0, 80896
    s_nop 0
    buffer_load_dwordx4 v15, s[48:51], s55 offen lds
    s_mov_b32 m0, 81920
    s_nop 0
    buffer_load_dwordx4 v16, s[48:51], s55 offen lds
    s_mov_b32 s55, 331776
    s_mov_b32 m0, 82944
    s_nop 0
    buffer_load_dwordx4 v8, s[48:51], s55 offen lds
    s_mov_b32 m0, 83968
    s_nop 0
    buffer_load_dwordx4 v9, s[48:51], s55 offen lds
    s_mov_b32 m0, 84992
    s_nop 0
    buffer_load_dwordx4 v10, s[48:51], s55 offen lds
    s_mov_b32 m0, 86016
    s_nop 0
    buffer_load_dwordx4 v11, s[48:51], s55 offen lds
    s_mov_b32 m0, 87040
    s_nop 0
    buffer_load_dwordx4 v12, s[48:51], s55 offen lds
    s_mov_b32 m0, 88064
    s_nop 0
    buffer_load_dwordx4 v13, s[48:51], s55 offen lds
    s_mov_b32 m0, 89088
    s_nop 0
    buffer_load_dwordx4 v14, s[48:51], s55 offen lds
    s_mov_b32 m0, 90112
    s_nop 0
    buffer_load_dwordx4 v15, s[48:51], s55 offen lds
    s_mov_b32 m0, 91136
    s_nop 0
    buffer_load_dwordx4 v16, s[48:51], s55 offen lds
    s_mov_b32 s55, 414720
    s_mov_b32 m0, 92160
    s_nop 0
    buffer_load_dwordx4 v8, s[48:51], s55 offen lds
    s_mov_b32 m0, 93184
    s_nop 0
    buffer_load_dwordx4 v9, s[48:51], s55 offen lds
    s_mov_b32 m0, 94208
    s_nop 0
    buffer_load_dwordx4 v10, s[48:51], s55 offen lds
    s_mov_b32 m0, 95232
    s_nop 0
    buffer_load_dwordx4 v11, s[48:51], s55 offen lds
    s_mov_b32 m0, 96256
    s_nop 0
    buffer_load_dwordx4 v12, s[48:51], s55 offen lds
    s_mov_b32 m0, 97280
    s_nop 0
    buffer_load_dwordx4 v13, s[48:51], s55 offen lds
    s_mov_b32 m0, 98304
    s_nop 0
    buffer_load_dwordx4 v14, s[48:51], s55 offen lds
    s_mov_b32 m0, 99328
    s_nop 0
    buffer_load_dwordx4 v15, s[48:51], s55 offen lds
    s_mov_b32 m0, 100352
    s_nop 0
    buffer_load_dwordx4 v16, s[48:51], s55 offen lds
    s_setprio 0
    ds_read_b64_tr_b16 v[44:45], v38 offset:0
    ds_read_b64_tr_b16 v[46:47], v38 offset:144
    ds_read_b64_tr_b16 v[48:49], v38 offset:32
    ds_read_b64_tr_b16 v[50:51], v38 offset:176
    ds_read_b64_tr_b16 v[52:53], v38 offset:64
    ds_read_b64_tr_b16 v[54:55], v38 offset:208
    ds_read_b64_tr_b16 v[56:57], v38 offset:96
    ds_read_b64_tr_b16 v[58:59], v38 offset:240
    ds_read_b64_tr_b16 v[60:61], v38 offset:128
    ds_read_b64_tr_b16 v[62:63], v38 offset:272
    ds_read_b64_tr_b16 v[64:65], v38 offset:4608
    ds_read_b64_tr_b16 v[66:67], v38 offset:4752
    ds_read_b64_tr_b16 v[68:69], v38 offset:4640
    ds_read_b64_tr_b16 v[70:71], v38 offset:4784
    ds_read_b64_tr_b16 v[72:73], v38 offset:4672
    ds_read_b64_tr_b16 v[74:75], v38 offset:4816
    ds_read_b64_tr_b16 v[76:77], v38 offset:4704
    ds_read_b64_tr_b16 v[78:79], v38 offset:4848
    ds_read_b64_tr_b16 v[80:81], v38 offset:4736
    ds_read_b64_tr_b16 v[82:83], v38 offset:4880
    ds_read_b64_tr_b16 v[84:85], v36 offset:0
    ds_read_b64_tr_b16 v[86:87], v36 offset:144
    ds_read_b64_tr_b16 v[88:89], v36 offset:32
    ds_read_b64_tr_b16 v[90:91], v36 offset:176
    ds_read_b64_tr_b16 v[92:93], v36 offset:64
    ds_read_b64_tr_b16 v[94:95], v36 offset:208
    ds_read_b64_tr_b16 v[96:97], v36 offset:96
    ds_read_b64_tr_b16 v[98:99], v36 offset:240
    ds_read_b64_tr_b16 v[100:101], v36 offset:128
    ds_read_b64_tr_b16 v[102:103], v36 offset:272
    s_waitcnt lgkmcnt(0)
    ds_write_b128 v122, v[44:47] offset:0
    ds_write_b128 v122, v[48:51] offset:1024
    ds_write_b128 v122, v[52:55] offset:2048
    ds_write_b128 v122, v[56:59] offset:3072
    ds_write_b128 v122, v[64:67] offset:4608
    ds_write_b128 v122, v[68:71] offset:5632
    ds_write_b128 v122, v[72:75] offset:6656
    ds_write_b128 v122, v[76:79] offset:7680
    ds_write_b128 v120, v[84:87] offset:0
    ds_write_b128 v120, v[88:91] offset:1024
    ds_write_b128 v120, v[92:95] offset:2048
    ds_write_b128 v120, v[96:99] offset:3072
    s_mov_b32 exec_lo, 0x00ff00ff
    s_mov_b32 exec_hi, 0x00ff00ff
    ds_write_b128 v118, v[60:63] offset:0
    ds_write_b128 v118, v[80:83] offset:4608
    ds_write_b128 v116, v[100:103] offset:0
    s_mov_b64 exec, -1
    s_waitcnt lgkmcnt(0)
    ds_read_b64_tr_b16 v[44:45], v36 offset:4608
    ds_read_b64_tr_b16 v[46:47], v36 offset:4752
    ds_read_b64_tr_b16 v[48:49], v36 offset:4640
    ds_read_b64_tr_b16 v[50:51], v36 offset:4784
    ds_read_b64_tr_b16 v[52:53], v36 offset:4672
    ds_read_b64_tr_b16 v[54:55], v36 offset:4816
    ds_read_b64_tr_b16 v[56:57], v36 offset:4704
    ds_read_b64_tr_b16 v[58:59], v36 offset:4848
    ds_read_b64_tr_b16 v[60:61], v36 offset:4736
    ds_read_b64_tr_b16 v[62:63], v36 offset:4880
    ds_read_b64_tr_b16 v[64:65], v36 offset:9216
    ds_read_b64_tr_b16 v[66:67], v36 offset:9360
    ds_read_b64_tr_b16 v[68:69], v36 offset:9248
    ds_read_b64_tr_b16 v[70:71], v36 offset:9392
    ds_read_b64_tr_b16 v[72:73], v36 offset:9280
    ds_read_b64_tr_b16 v[74:75], v36 offset:9424
    ds_read_b64_tr_b16 v[76:77], v36 offset:9312
    ds_read_b64_tr_b16 v[78:79], v36 offset:9456
    ds_read_b64_tr_b16 v[80:81], v36 offset:9344
    ds_read_b64_tr_b16 v[82:83], v36 offset:9488
    ds_read_b64_tr_b16 v[84:85], v36 offset:13824
    ds_read_b64_tr_b16 v[86:87], v36 offset:13968
    ds_read_b64_tr_b16 v[88:89], v36 offset:13856
    ds_read_b64_tr_b16 v[90:91], v36 offset:14000
    ds_read_b64_tr_b16 v[92:93], v36 offset:13888
    ds_read_b64_tr_b16 v[94:95], v36 offset:14032
    ds_read_b64_tr_b16 v[96:97], v36 offset:13920
    ds_read_b64_tr_b16 v[98:99], v36 offset:14064
    ds_read_b64_tr_b16 v[100:101], v36 offset:13952
    ds_read_b64_tr_b16 v[102:103], v36 offset:14096
    s_waitcnt lgkmcnt(0)
    ds_write_b128 v120, v[44:47] offset:4608
    ds_write_b128 v120, v[48:51] offset:5632
    ds_write_b128 v120, v[52:55] offset:6656
    ds_write_b128 v120, v[56:59] offset:7680
    ds_write_b128 v120, v[64:67] offset:9216
    ds_write_b128 v120, v[68:71] offset:10240
    ds_write_b128 v120, v[72:75] offset:11264
    ds_write_b128 v120, v[76:79] offset:12288
    ds_write_b128 v120, v[84:87] offset:13824
    ds_write_b128 v120, v[88:91] offset:14848
    ds_write_b128 v120, v[92:95] offset:15872
    ds_write_b128 v120, v[96:99] offset:16896
    s_mov_b32 exec_lo, 0x00ff00ff
    s_mov_b32 exec_hi, 0x00ff00ff
    ds_write_b128 v116, v[60:63] offset:4608
    ds_write_b128 v116, v[80:83] offset:9216
    ds_write_b128 v116, v[100:103] offset:13824
    s_mov_b64 exec, -1
    s_waitcnt lgkmcnt(0)
    ds_read_b64_tr_b16 v[44:45], v36 offset:18432
    ds_read_b64_tr_b16 v[46:47], v36 offset:18576
    ds_read_b64_tr_b16 v[48:49], v36 offset:18464
    ds_read_b64_tr_b16 v[50:51], v36 offset:18608
    ds_read_b64_tr_b16 v[52:53], v36 offset:18496
    ds_read_b64_tr_b16 v[54:55], v36 offset:18640
    ds_read_b64_tr_b16 v[56:57], v36 offset:18528
    ds_read_b64_tr_b16 v[58:59], v36 offset:18672
    ds_read_b64_tr_b16 v[60:61], v36 offset:18560
    ds_read_b64_tr_b16 v[62:63], v36 offset:18704
    ds_read_b64_tr_b16 v[64:65], v36 offset:23040
    ds_read_b64_tr_b16 v[66:67], v36 offset:23184
    ds_read_b64_tr_b16 v[68:69], v36 offset:23072
    ds_read_b64_tr_b16 v[70:71], v36 offset:23216
    ds_read_b64_tr_b16 v[72:73], v36 offset:23104
    ds_read_b64_tr_b16 v[74:75], v36 offset:23248
    ds_read_b64_tr_b16 v[76:77], v36 offset:23136
    ds_read_b64_tr_b16 v[78:79], v36 offset:23280
    ds_read_b64_tr_b16 v[80:81], v36 offset:23168
    ds_read_b64_tr_b16 v[82:83], v36 offset:23312
    s_waitcnt lgkmcnt(0)
    ds_write_b128 v120, v[44:47] offset:18432
    ds_write_b128 v120, v[48:51] offset:19456
    ds_write_b128 v120, v[52:55] offset:20480
    ds_write_b128 v120, v[56:59] offset:21504
    ds_write_b128 v120, v[64:67] offset:23040
    ds_write_b128 v120, v[68:71] offset:24064
    ds_write_b128 v120, v[72:75] offset:25088
    ds_write_b128 v120, v[76:79] offset:26112
    s_mov_b32 exec_lo, 0x00ff00ff
    s_mov_b32 exec_hi, 0x00ff00ff
    ds_write_b128 v116, v[60:63] offset:18432
    ds_write_b128 v116, v[80:83] offset:23040
    s_mov_b64 exec, -1
    s_waitcnt lgkmcnt(0)
    s_setprio 3
    s_mov_b32 s15, 200000
Lspin_78:
    ds_read_b32 v164, v3 offset:36
    s_waitcnt lgkmcnt(0)
    v_readfirstlane_b32 s14, v164
    s_nop 0
    s_cmp_ge_u32 s14, 4
    s_cbranch_scc1 Lsd_79
    s_sleep 8
    s_sub_u32 s15, s15, 1
    s_cbranch_scc0 Lspin_78
Lsd_79:
    s_mov_b32 s55, 497664
    s_mov_b32 m0, 101376
    s_nop 0
    buffer_load_dwordx4 v8, s[48:51], s55 offen lds
    s_mov_b32 m0, 102400
    s_nop 0
    buffer_load_dwordx4 v9, s[48:51], s55 offen lds
    s_mov_b32 m0, 103424
    s_nop 0
    buffer_load_dwordx4 v10, s[48:51], s55 offen lds
    s_mov_b32 m0, 104448
    s_nop 0
    buffer_load_dwordx4 v11, s[48:51], s55 offen lds
    s_mov_b32 m0, 105472
    s_nop 0
    buffer_load_dwordx4 v12, s[48:51], s55 offen lds
    s_mov_b32 m0, 106496
    s_nop 0
    buffer_load_dwordx4 v13, s[48:51], s55 offen lds
    s_mov_b32 m0, 107520
    s_nop 0
    buffer_load_dwordx4 v14, s[48:51], s55 offen lds
    s_mov_b32 m0, 108544
    s_nop 0
    buffer_load_dwordx4 v15, s[48:51], s55 offen lds
    s_mov_b32 m0, 109568
    s_nop 0
    buffer_load_dwordx4 v16, s[48:51], s55 offen lds
    s_mov_b32 s55, 580608
    s_mov_b32 m0, 110592
    s_nop 0
    buffer_load_dwordx4 v8, s[48:51], s55 offen lds
    s_mov_b32 m0, 111616
    s_nop 0
    buffer_load_dwordx4 v9, s[48:51], s55 offen lds
    s_mov_b32 m0, 112640
    s_nop 0
    buffer_load_dwordx4 v10, s[48:51], s55 offen lds
    s_mov_b32 m0, 113664
    s_nop 0
    buffer_load_dwordx4 v11, s[48:51], s55 offen lds
    s_mov_b32 m0, 114688
    s_nop 0
    buffer_load_dwordx4 v12, s[48:51], s55 offen lds
    s_mov_b32 m0, 115712
    s_nop 0
    buffer_load_dwordx4 v13, s[48:51], s55 offen lds
    s_mov_b32 m0, 116736
    s_nop 0
    buffer_load_dwordx4 v14, s[48:51], s55 offen lds
    s_mov_b32 m0, 117760
    s_nop 0
    buffer_load_dwordx4 v15, s[48:51], s55 offen lds
    s_mov_b32 m0, 118784
    s_nop 0
    buffer_load_dwordx4 v16, s[48:51], s55 offen lds
    s_waitcnt vmcnt(18)
    s_setprio 0
    ds_read_b64_tr_b16 v[44:45], v37 offset:0
    ds_read_b64_tr_b16 v[46:47], v37 offset:144
    ds_read_b64_tr_b16 v[48:49], v37 offset:32
    ds_read_b64_tr_b16 v[50:51], v37 offset:176
    ds_read_b64_tr_b16 v[52:53], v37 offset:64
    ds_read_b64_tr_b16 v[54:55], v37 offset:208
    ds_read_b64_tr_b16 v[56:57], v37 offset:96
    ds_read_b64_tr_b16 v[58:59], v37 offset:240
    ds_read_b64_tr_b16 v[60:61], v37 offset:128
    ds_read_b64_tr_b16 v[62:63], v37 offset:272
    ds_read_b64_tr_b16 v[64:65], v37 offset:4608
    ds_read_b64_tr_b16 v[66:67], v37 offset:4752
    ds_read_b64_tr_b16 v[68:69], v37 offset:4640
    ds_read_b64_tr_b16 v[70:71], v37 offset:4784
    ds_read_b64_tr_b16 v[72:73], v37 offset:4672
    ds_read_b64_tr_b16 v[74:75], v37 offset:4816
    ds_read_b64_tr_b16 v[76:77], v37 offset:4704
    ds_read_b64_tr_b16 v[78:79], v37 offset:4848
    ds_read_b64_tr_b16 v[80:81], v37 offset:4736
    ds_read_b64_tr_b16 v[82:83], v37 offset:4880
    ds_read_b64_tr_b16 v[84:85], v37 offset:9216
    ds_read_b64_tr_b16 v[86:87], v37 offset:9360
    ds_read_b64_tr_b16 v[88:89], v37 offset:9248
    ds_read_b64_tr_b16 v[90:91], v37 offset:9392
    ds_read_b64_tr_b16 v[92:93], v37 offset:9280
    ds_read_b64_tr_b16 v[94:95], v37 offset:9424
    ds_read_b64_tr_b16 v[96:97], v37 offset:9312
    ds_read_b64_tr_b16 v[98:99], v37 offset:9456
    ds_read_b64_tr_b16 v[100:101], v37 offset:9344
    ds_read_b64_tr_b16 v[102:103], v37 offset:9488
    s_waitcnt lgkmcnt(0)
    ds_write_b128 v121, v[44:47] offset:0
    ds_write_b128 v121, v[48:51] offset:1024
    ds_write_b128 v121, v[52:55] offset:2048
    ds_write_b128 v121, v[56:59] offset:3072
    ds_write_b128 v121, v[64:67] offset:4608
    ds_write_b128 v121, v[68:71] offset:5632
    ds_write_b128 v121, v[72:75] offset:6656
    ds_write_b128 v121, v[76:79] offset:7680
    ds_write_b128 v121, v[84:87] offset:9216
    ds_write_b128 v121, v[88:91] offset:10240
    ds_write_b128 v121, v[92:95] offset:11264
    ds_write_b128 v121, v[96:99] offset:12288
    s_mov_b32 exec_lo, 0x00ff00ff
    s_mov_b32 exec_hi, 0x00ff00ff
    ds_write_b128 v117, v[60:63] offset:0
    ds_write_b128 v117, v[80:83] offset:4608
    ds_write_b128 v117, v[100:103] offset:9216
    s_mov_b64 exec, -1
    s_waitcnt lgkmcnt(0)
    ds_read_b64_tr_b16 v[44:45], v37 offset:13824
    ds_read_b64_tr_b16 v[46:47], v37 offset:13968
    ds_read_b64_tr_b16 v[48:49], v37 offset:13856
    ds_read_b64_tr_b16 v[50:51], v37 offset:14000
    ds_read_b64_tr_b16 v[52:53], v37 offset:13888
    ds_read_b64_tr_b16 v[54:55], v37 offset:14032
    ds_read_b64_tr_b16 v[56:57], v37 offset:13920
    ds_read_b64_tr_b16 v[58:59], v37 offset:14064
    ds_read_b64_tr_b16 v[60:61], v37 offset:13952
    ds_read_b64_tr_b16 v[62:63], v37 offset:14096
    ds_read_b64_tr_b16 v[64:65], v37 offset:18432
    ds_read_b64_tr_b16 v[66:67], v37 offset:18576
    ds_read_b64_tr_b16 v[68:69], v37 offset:18464
    ds_read_b64_tr_b16 v[70:71], v37 offset:18608
    ds_read_b64_tr_b16 v[72:73], v37 offset:18496
    ds_read_b64_tr_b16 v[74:75], v37 offset:18640
    ds_read_b64_tr_b16 v[76:77], v37 offset:18528
    ds_read_b64_tr_b16 v[78:79], v37 offset:18672
    ds_read_b64_tr_b16 v[80:81], v37 offset:18560
    ds_read_b64_tr_b16 v[82:83], v37 offset:18704
    ds_read_b64_tr_b16 v[84:85], v37 offset:23040
    ds_read_b64_tr_b16 v[86:87], v37 offset:23184
    ds_read_b64_tr_b16 v[88:89], v37 offset:23072
    ds_read_b64_tr_b16 v[90:91], v37 offset:23216
    ds_read_b64_tr_b16 v[92:93], v37 offset:23104
    ds_read_b64_tr_b16 v[94:95], v37 offset:23248
    ds_read_b64_tr_b16 v[96:97], v37 offset:23136
    ds_read_b64_tr_b16 v[98:99], v37 offset:23280
    ds_read_b64_tr_b16 v[100:101], v37 offset:23168
    ds_read_b64_tr_b16 v[102:103], v37 offset:23312
    s_waitcnt lgkmcnt(0)
    ds_write_b128 v121, v[44:47] offset:13824
    ds_write_b128 v121, v[48:51] offset:14848
    ds_write_b128 v121, v[52:55] offset:15872
    ds_write_b128 v121, v[56:59] offset:16896
    ds_write_b128 v121, v[64:67] offset:18432
    ds_write_b128 v121, v[68:71] offset:19456
    ds_write_b128 v121, v[72:75] offset:20480
    ds_write_b128 v121, v[76:79] offset:21504
    ds_write_b128 v121, v[84:87] offset:23040
    ds_write_b128 v121, v[88:91] offset:24064
    ds_write_b128 v121, v[92:95] offset:25088
    ds_write_b128 v121, v[96:99] offset:26112
    s_mov_b32 exec_lo, 0x00ff00ff
    s_mov_b32 exec_hi, 0x00ff00ff
    ds_write_b128 v117, v[60:63] offset:13824
    ds_write_b128 v117, v[80:83] offset:18432
    ds_write_b128 v117, v[100:103] offset:23040
    s_mov_b64 exec, -1
    s_waitcnt lgkmcnt(0)
    s_setprio 3
    s_waitcnt vmcnt(0)
    s_setprio 0
    ds_read_b64_tr_b16 v[44:45], v37 offset:27648
    ds_read_b64_tr_b16 v[46:47], v37 offset:27792
    ds_read_b64_tr_b16 v[48:49], v37 offset:27680
    ds_read_b64_tr_b16 v[50:51], v37 offset:27824
    ds_read_b64_tr_b16 v[52:53], v37 offset:27712
    ds_read_b64_tr_b16 v[54:55], v37 offset:27856
    ds_read_b64_tr_b16 v[56:57], v37 offset:27744
    ds_read_b64_tr_b16 v[58:59], v37 offset:27888
    ds_read_b64_tr_b16 v[60:61], v37 offset:27776
    ds_read_b64_tr_b16 v[62:63], v37 offset:27920
    ds_read_b64_tr_b16 v[64:65], v37 offset:32256
    ds_read_b64_tr_b16 v[66:67], v37 offset:32400
    ds_read_b64_tr_b16 v[68:69], v37 offset:32288
    ds_read_b64_tr_b16 v[70:71], v37 offset:32432
    ds_read_b64_tr_b16 v[72:73], v37 offset:32320
    ds_read_b64_tr_b16 v[74:75], v37 offset:32464
    ds_read_b64_tr_b16 v[76:77], v37 offset:32352
    ds_read_b64_tr_b16 v[78:79], v37 offset:32496
    ds_read_b64_tr_b16 v[80:81], v37 offset:32384
    ds_read_b64_tr_b16 v[82:83], v37 offset:32528
    ds_read_b64_tr_b16 v[84:85], v37 offset:36864
    ds_read_b64_tr_b16 v[86:87], v37 offset:37008
    ds_read_b64_tr_b16 v[88:89], v37 offset:36896
    ds_read_b64_tr_b16 v[90:91], v37 offset:37040
    ds_read_b64_tr_b16 v[92:93], v37 offset:36928
    ds_read_b64_tr_b16 v[94:95], v37 offset:37072
    ds_read_b64_tr_b16 v[96:97], v37 offset:36960
    ds_read_b64_tr_b16 v[98:99], v37 offset:37104
    ds_read_b64_tr_b16 v[100:101], v37 offset:36992
    ds_read_b64_tr_b16 v[102:103], v37 offset:37136
    s_waitcnt lgkmcnt(0)
    ds_write_b128 v121, v[44:47] offset:27648
    ds_write_b128 v121, v[48:51] offset:28672
    ds_write_b128 v121, v[52:55] offset:29696
    ds_write_b128 v121, v[56:59] offset:30720
    ds_write_b128 v121, v[64:67] offset:32256
    ds_write_b128 v121, v[68:71] offset:33280
    ds_write_b128 v121, v[72:75] offset:34304
    ds_write_b128 v121, v[76:79] offset:35328
    ds_write_b128 v121, v[84:87] offset:36864
    ds_write_b128 v121, v[88:91] offset:37888
    ds_write_b128 v121, v[92:95] offset:38912
    ds_write_b128 v121, v[96:99] offset:39936
    s_mov_b32 exec_lo, 0x00ff00ff
    s_mov_b32 exec_hi, 0x00ff00ff
    ds_write_b128 v117, v[60:63] offset:27648
    ds_write_b128 v117, v[80:83] offset:32256
    ds_write_b128 v117, v[100:103] offset:36864
    s_mov_b64 exec, -1
    s_waitcnt lgkmcnt(0)
    ds_read_b64_tr_b16 v[44:45], v37 offset:41472
    ds_read_b64_tr_b16 v[46:47], v37 offset:41616
    ds_read_b64_tr_b16 v[48:49], v37 offset:41504
    ds_read_b64_tr_b16 v[50:51], v37 offset:41648
    ds_read_b64_tr_b16 v[52:53], v37 offset:41536
    ds_read_b64_tr_b16 v[54:55], v37 offset:41680
    ds_read_b64_tr_b16 v[56:57], v37 offset:41568
    ds_read_b64_tr_b16 v[58:59], v37 offset:41712
    ds_read_b64_tr_b16 v[60:61], v37 offset:41600
    ds_read_b64_tr_b16 v[62:63], v37 offset:41744
    s_waitcnt lgkmcnt(0)
    ds_write_b128 v121, v[44:47] offset:41472
    ds_write_b128 v121, v[48:51] offset:42496
    ds_write_b128 v121, v[52:55] offset:43520
    ds_write_b128 v121, v[56:59] offset:44544
    s_mov_b32 exec_lo, 0x00ff00ff
    s_mov_b32 exec_hi, 0x00ff00ff
    ds_write_b128 v117, v[60:63] offset:41472
    s_mov_b64 exec, -1
    s_waitcnt lgkmcnt(0)
    s_setprio 3
    s_mov_b64 exec, 1
    v_mov_b32 v164, 4
    ds_write_b32 v3, v164 offset:144
    s_mov_b64 exec, -1
Lh2done:
    v_sub_u32 v164, 2048, v156
    v_min_u32 v143, v164, v156
    s_mul_i32 s54, s5, 72
    s_sub_u32 s12, 505, s54
    s_cmp_lt_u32 s5, 4
    s_cselect_b32 s12, s54, s12
    s_add_u32 s13, s12, 71
    s_lshr_b32 s12, s12, 5
    s_lshr_b32 s13, s13, 5
    v_add_u32 v8, s12, v5
    v_min_u32 v8, s13, v8
    v_and_b32 v9, 1, v143
    v_mad_u32_u24 v8, v9, 10, v8
    v_mul_u32_u24 v8, 17, v8
    v_lshrrev_b32 v9, 6, v143
    v_add_lshl_u32 v8, v8, v9, 7
    v_add_u32 v8, 200704, v8
    v_add_u32 v9, 43520, v8
    s_mul_i32 s12, s5, 18
    s_sub_u32 s13, 143, s12
    s_cmp_lt_u32 s5, 4
    s_cselect_b32 s12, s12, s13
    s_cselect_b32 s13, 1, -1
    s_mul_i32 s12, s12, 8704
    s_add_u32 s56, s12, 5832704
    s_mul_i32 s57, s13, 8704
    s_lshl_b32 s58, s57, 2
    v_mul_i32_i24 v10, s57, v5
    v_lshl_add_u32 v10, v143, 3, v10
    v_add_u32 v10, s56, v10
    v_add_u32 v11, 696320, v10
    s_mov_b32 s59, 8704
    s_mov_b32 s15, 20000
Lpoll_80:
    buffer_load_dwordx2 v[164:165], v8, s[44:47], 0 offen sc1
    buffer_load_dwordx2 v[166:167], v9, s[44:47], 0 offen sc1
    s_waitcnt vmcnt(0)
    v_cmp_ne_u64 vcc, s[6:7], v[164:165]
    v_cmp_ne_u64 s[12:13], s[6:7], v[166:167]
    s_nop 0
    s_or_b64 vcc, vcc, s[12:13]
    s_cbranch_vccz Lpd_81
    s_sleep 6
    s_sub_u32 s15, s15, 1
    s_cbranch_scc0 Lpoll_80
Lpd_81:
    buffer_load_dwordx2 v[84:85], v10, s[44:47], 0 offen sc1
    buffer_load_dwordx2 v[94:95], v11, s[44:47], 0 offen sc1
    s_cmp_lt_u32 s5, 4
    s_cbranch_scc1 Lyx_82
    buffer_load_ushort v104, v10, s[44:47], s59 offen sc1
    buffer_load_ushort v109, v11, s[44:47], s59 offen sc1
Lyx_82:
    v_add_u32 v10, s58, v10
    v_add_u32 v11, s58, v11
    buffer_load_dwordx2 v[86:87], v10, s[44:47], 0 offen sc1
    buffer_load_dwordx2 v[96:97], v11, s[44:47], 0 offen sc1
    s_cmp_lt_u32 s5, 4
    s_cbranch_scc1 Lyx_83
    buffer_load_ushort v105, v10, s[44:47], s59 offen sc1
    buffer_load_ushort v110, v11, s[44:47], s59 offen sc1
Lyx_83:
    v_add_u32 v10, s58, v10
    v_add_u32 v11, s58, v11
    buffer_load_dwordx2 v[88:89], v10, s[44:47], 0 offen sc1
    buffer_load_dwordx2 v[98:99], v11, s[44:47], 0 offen sc1
    s_cmp_lt_u32 s5, 4
    s_cbranch_scc1 Lyx_84
    buffer_load_ushort v106, v10, s[44:47], s59 offen sc1
    buffer_load_ushort v111, v11, s[44:47], s59 offen sc1
Lyx_84:
    v_add_u32 v10, s58, v10
    v_add_u32 v11, s58, v11
    buffer_load_dwordx2 v[90:91], v10, s[44:47], 0 offen sc1
    buffer_load_dwordx2 v[100:101], v11, s[44:47], 0 offen sc1
    s_cmp_lt_u32 s5, 4
    s_cbranch_scc1 Lyx_85
    buffer_load_ushort v107, v10, s[44:47], s59 offen sc1
    buffer_load_ushort v112, v11, s[44:47], s59 offen sc1
Lyx_85:
    v_add_u32 v10, s58, v10
    v_add_u32 v11, s58, v11
    buffer_load_dwordx2 v[92:93], v10, s[44:47], 0 offen sc1
    buffer_load_dwordx2 v[102:103], v11, s[44:47], 0 offen sc1
    s_cmp_lt_u32 s5, 4
    s_cbranch_scc1 Lyx_86
    buffer_load_ushort v108, v10, s[44:47], s59 offen sc1
    buffer_load_ushort v113, v11, s[44:47], s59 offen sc1
Lyx_86:
    s_cmp_eq_u32 s10, 3
    s_cbranch_scc1 Lhaveb
    v_and_b32 v119, 7, v1
    v_lshl_add_u32 v119, v5, 3, v119
    v_lshlrev_b32 v119, 4, v119
    v_add_u32 v120, 27648, v162
    v_add_u32 v116, 31744, v119
    v_add_u32 v121, 73728, v162
    v_add_u32 v117, 77824, v119
    v_add_u32 v122, 147456, v162
    v_add_u32 v118, 151552, v119
Lhaveb:
    s_waitcnt vmcnt(0)
    s_lshl_b32 s12, s4, 10
    s_add_u32 s12, s12, 299008
    v_lshrrev_b32 v114, 2, v1
    v_lshl_add_u32 v114, v114, 7, s12
    v_and_b32 v115, 3, v1
    v_lshl_add_u32 v114, v115, 3, v114
    s_mov_b32 s48, s38
    s_mov_b32 s49, s39
    s_mov_b32 s50, 2359296
    s_mov_b32 s51, 0x20000
    s_lshl_b32 s56, s4, 2
    s_add_u32 s56, s56, s10
    s_mul_i32 s56, s56, 18432
    s_add_u32 s56, s56, 2031616
    s_mov_b32 s15, 200000
Lspin_87:
    ds_read_b32 v70, v3 offset:144
    s_waitcnt lgkmcnt(0)
    v_readfirstlane_b32 s14, v70
    s_nop 0
    s_cmp_ge_u32 s14, 4
    s_cbranch_scc1 Lsd_88
    s_sleep 1
    s_sub_u32 s15, s15, 1
    s_cbranch_scc0 Lspin_87
Lsd_88:
    s_setprio 0
    s_mul_i32 s58, s10, 2816
    s_add_u32 s58, s58, 55296
    v_mul_u32_u24 v7, 176, v4
    v_lshl_add_u32 v7, v5, 3, v7
    v_add_u32 v7, s58, v7
    v_lshrrev_b32 v0, 18, v144
    v_lshl_add_u32 v0, v0, 4, s58
    v_bfe_u32 v6, v144, 0, 18
    v_lshlrev_b32 v6, 4, v6
    v_lshrrev_b32 v2, 18, v145
    v_lshl_add_u32 v2, v2, 4, s58
    v_bfe_u32 v119, v145, 0, 18
    v_lshlrev_b32 v119, 4, v119
    v_lshrrev_b32 v5, 18, v146
    v_lshl_add_u32 v5, v5, 4, s58
    v_bfe_u32 v1, v146, 0, 18
    v_lshlrev_b32 v1, 4, v1
    v_mul_f32 v152, 0xbfb8aa3b, v152
    v_exp_f32 v152, v152
    s_nop 0
    v_add_f32 v153, 1.0, v152
    v_rcp_f32 v152, v153
    s_nop 0
    v_sub_f32 v153, 1.0, v152
    v_mov_b32 v164, 1024
    v_cmp_gt_u32 vcc, v156, v164
    s_cmp_lt_u32 s5, 4
    s_cselect_b32 s12, 0, -1
    s_mov_b32 s13, s12
    s_xor_b64 vcc, vcc, s[12:13]
    v_cndmask_b32 v154, -1.0, 1.0, vcc
    s_cmp_lt_u32 s5, 4
    s_cbranch_scc0 Lgyrev
    v_lshlrev_b32 v124, 16, v84
    v_and_b32 v125, 0xffff0000, v84
    v_lshlrev_b32 v164, 16, v94
    v_and_b32 v165, 0xffff0000, v94
    v_pk_fma_f32 v[124:125], v[164:165], v[154:155], v[124:125] op_sel_hi:[1,0,1]
    v_pk_mul_f32 v[124:125], v[124:125], v[152:153] op_sel_hi:[1,0]
    v_lshlrev_b32 v126, 16, v85
    v_and_b32 v127, 0xffff0000, v85
    v_lshlrev_b32 v164, 16, v95
    v_and_b32 v165, 0xffff0000, v95
    v_pk_fma_f32 v[126:127], v[164:165], v[154:155], v[126:127] op_sel_hi:[1,0,1]
    v_pk_mul_f32 v[126:127], v[126:127], v[152:153] op_sel_hi:[1,0]
    v_lshlrev_b32 v128, 16, v86
    v_and_b32 v129, 0xffff0000, v86
    v_lshlrev_b32 v164, 16, v96
    v_and_b32 v165, 0xffff0000, v96
    v_pk_fma_f32 v[128:129], v[164:165], v[154:155], v[128:129] op_sel_hi:[1,0,1]
    v_pk_mul_f32 v[128:129], v[128:129], v[152:153] op_sel_hi:[1,0]
    v_lshlrev_b32 v130, 16, v87
    v_and_b32 v131, 0xffff0000, v87
    v_lshlrev_b32 v164, 16, v97
    v_and_b32 v165, 0xffff0000, v97
    v_pk_fma_f32 v[130:131], v[164:165], v[154:155], v[130:131] op_sel_hi:[1,0,1]
    v_pk_mul_f32 v[130:131], v[130:131], v[152:153] op_sel_hi:[1,0]
    v_lshlrev_b32 v132, 16, v88
    v_and_b32 v133, 0xffff0000, v88
    v_lshlrev_b32 v164, 16, v98
    v_and_b32 v165, 0xffff0000, v98
    v_pk_fma_f32 v[132:133], v[164:165], v[154:155], v[132:133] op_sel_hi:[1,0,1]
    v_pk_mul_f32 v[132:133], v[132:133], v[152:153] op_sel_hi:[1,0]
    v_lshlrev_b32 v134, 16, v89
    v_and_b32 v135, 0xffff0000, v89
    v_lshlrev_b32 v164, 16, v99
    v_and_b32 v165, 0xffff0000, v99
    v_pk_fma_f32 v[134:135], v[164:165], v[154:155], v[134:135] op_sel_hi:[1,0,1]
    v_pk_mul_f32 v[134:135], v[134:135], v[152:153] op_sel_hi:[1,0]
    v_lshlrev_b32 v136, 16, v90
    v_and_b32 v137, 0xffff0000, v90
    v_lshlrev_b32 v164, 16, v100
    v_and_b32 v165, 0xffff0000, v100
    v_pk_fma_f32 v[136:137], v[164:165], v[154:155], v[136:137] op_sel_hi:[1,0,1]
    v_pk_mul_f32 v[136:137], v[136:137], v[152:153] op_sel_hi:[1,0]
    v_lshlrev_b32 v138, 16, v91
    v_and_b32 v139, 0xffff0000, v91
    v_lshlrev_b32 v164, 16, v101
    v_and_b32 v165, 0xffff0000, v101
    v_pk_fma_f32 v[138:139], v[164:165], v[154:155], v[138:139] op_sel_hi:[1,0,1]
    v_pk_mul_f32 v[138:139], v[138:139], v[152:153] op_sel_hi:[1,0]
    v_lshlrev_b32 v140, 16, v92
    v_and_b32 v141, 0xffff0000, v92
    v_lshlrev_b32 v164, 16, v102
    v_and_b32 v165, 0xffff0000, v102
    v_pk_fma_f32 v[140:141], v[164:165], v[154:155], v[140:141] op_sel_hi:[1,0,1]
    v_pk_mul_f32 v[140:141], v[140:141], v[152:153] op_sel_hi:[1,0]
    v_lshlrev_b32 v142, 16, v93
    v_and_b32 v143, 0xffff0000, v93
    v_lshlrev_b32 v164, 16, v103
    v_and_b32 v165, 0xffff0000, v103
    v_pk_fma_f32 v[142:143], v[164:165], v[154:155], v[142:143] op_sel_hi:[1,0,1]
    v_pk_mul_f32 v[142:143], v[142:143], v[152:153] op_sel_hi:[1,0]
    s_branch Lgydone
Lgyrev:
    v_lshlrev_b32 v124, 16, v104
    v_and_b32 v125, 0xffff0000, v85
    v_lshlrev_b32 v164, 16, v109
    v_and_b32 v165, 0xffff0000, v95
    v_pk_fma_f32 v[124:125], v[164:165], v[154:155], v[124:125] op_sel_hi:[1,0,1]
    v_pk_mul_f32 v[124:125], v[124:125], v[152:153] op_sel_hi:[1,0]
    v_lshlrev_b32 v126, 16, v85
    v_and_b32 v127, 0xffff0000, v84
    v_lshlrev_b32 v164, 16, v95
    v_and_b32 v165, 0xffff0000, v94
    v_pk_fma_f32 v[126:127], v[164:165], v[154:155], v[126:127] op_sel_hi:[1,0,1]
    v_pk_mul_f32 v[126:127], v[126:127], v[152:153] op_sel_hi:[1,0]
    v_lshlrev_b32 v128, 16, v105
    v_and_b32 v129, 0xffff0000, v87
    v_lshlrev_b32 v164, 16, v110
    v_and_b32 v165, 0xffff0000, v97
    v_pk_fma_f32 v[128:129], v[164:165], v[154:155], v[128:129] op_sel_hi:[1,0,1]
    v_pk_mul_f32 v[128:129], v[128:129], v[152:153] op_sel_hi:[1,0]
    v_lshlrev_b32 v130, 16, v87
    v_and_b32 v131, 0xffff0000, v86
    v_lshlrev_b32 v164, 16, v97
    v_and_b32 v165, 0xffff0000, v96
    v_pk_fma_f32 v[130:131], v[164:165], v[154:155], v[130:131] op_sel_hi:[1,0,1]
    v_pk_mul_f32 v[130:131], v[130:131], v[152:153] op_sel_hi:[1,0]
    v_lshlrev_b32 v132, 16, v106
    v_and_b32 v133, 0xffff0000, v89
    v_lshlrev_b32 v164, 16, v111
    v_and_b32 v165, 0xffff0000, v99
    v_pk_fma_f32 v[132:133], v[164:165], v[154:155], v[132:133] op_sel_hi:[1,0,1]
    v_pk_mul_f32 v[132:133], v[132:133], v[152:153] op_sel_hi:[1,0]
    v_lshlrev_b32 v134, 16, v89
    v_and_b32 v135, 0xffff0000, v88
    v_lshlrev_b32 v164, 16, v99
    v_and_b32 v165, 0xffff0000, v98
    v_pk_fma_f32 v[134:135], v[164:165], v[154:155], v[134:135] op_sel_hi:[1,0,1]
    v_pk_mul_f32 v[134:135], v[134:135], v[152:153] op_sel_hi:[1,0]
    v_lshlrev_b32 v136, 16, v107
    v_and_b32 v137, 0xffff0000, v91
    v_lshlrev_b32 v164, 16, v112
    v_and_b32 v165, 0xffff0000, v101
    v_pk_fma_f32 v[136:137], v[164:165], v[154:155], v[136:137] op_sel_hi:[1,0,1]
    v_pk_mul_f32 v[136:137], v[136:137], v[152:153] op_sel_hi:[1,0]
    v_lshlrev_b32 v138, 16, v91
    v_and_b32 v139, 0xffff0000, v90
    v_lshlrev_b32 v164, 16, v101
    v_and_b32 v165, 0xffff0000, v100
    v_pk_fma_f32 v[138:139], v[164:165], v[154:155], v[138:139] op_sel_hi:[1,0,1]
    v_pk_mul_f32 v[138:139], v[138:139], v[152:153] op_sel_hi:[1,0]
    v_lshlrev_b32 v140, 16, v108
    v_and_b32 v141, 0xffff0000, v93
    v_lshlrev_b32 v164, 16, v113
    v_and_b32 v165, 0xffff0000, v103
    v_pk_fma_f32 v[140:141], v[164:165], v[154:155], v[140:141] op_sel_hi:[1,0,1]
    v_pk_mul_f32 v[140:141], v[140:141], v[152:153] op_sel_hi:[1,0]
    v_lshlrev_b32 v142, 16, v93
    v_and_b32 v143, 0xffff0000, v92
    v_lshlrev_b32 v164, 16, v103
    v_and_b32 v165, 0xffff0000, v102
    v_pk_fma_f32 v[142:143], v[164:165], v[154:155], v[142:143] op_sel_hi:[1,0,1]
    v_pk_mul_f32 v[142:143], v[142:143], v[152:153] op_sel_hi:[1,0]
Lgydone:
    v_mov_b32 v123, v153
    s_branch Lfin
    .p2alignl 12, 0xbf810000
Lfin:
    s_mov_b32 s15, 200000
Lspin_89:
    ds_read_b32 v70, v3 offset:44
    s_waitcnt lgkmcnt(0)
    v_readfirstlane_b32 s14, v70
    s_nop 0
    s_cmp_ge_u32 s14, 4
    s_cbranch_scc1 Lsd_90
    s_sleep 1
    s_sub_u32 s15, s15, 1
    s_cbranch_scc0 Lspin_89
Lsd_90:
    s_setprio 3
    v_mov_b32 v4, v162
    v_mov_b32 v166, v114
    s_mov_b32 s15, 200000
Lspin_91:
    ds_read_b32 v70, v3 offset:48
    s_waitcnt lgkmcnt(0)
    v_readfirstlane_b32 s14, v70
    s_nop 0
    s_cmp_ge_u32 s14, 4
    s_cbranch_scc1 Lsd_92
    s_sleep 0
    s_sub_u32 s15, s15, 1
    s_cbranch_scc0 Lspin_91
Lsd_92:
    ds_read_b128 v[80:83], v120 offset:0
    ds_read_b128 v[84:87], v120 offset:1024
    ds_read_b128 v[88:91], v120 offset:2048
    ds_read_b128 v[92:95], v120 offset:3072
    ds_read_b128 v[112:115], v116 offset:0
    s_mov_b32 exec_hi, 0
    s_mov_b32 s15, 20000
Lpoll_93:
    buffer_load_dwordx2 v[72:73], v166, s[44:47], 0 offen sc1
    s_waitcnt vmcnt(0)
    v_cmp_ne_u64 vcc, s[6:7], v[72:73]
    s_cbranch_vccz Lpd_94
    s_sleep 0
    s_sub_u32 s15, s15, 1
    s_cbranch_scc0 Lpoll_93
Lpd_94:
    s_mov_b64 exec, -1
    buffer_load_dwordx4 v[8:11], v4, s[44:47], s56 offen offset:0 sc1
    buffer_load_dwordx4 v[12:15], v4, s[44:47], s56 offen offset:1024 sc1
    buffer_load_dwordx4 v[16:19], v4, s[44:47], s56 offen offset:2048 sc1
    buffer_load_dwordx4 v[20:23], v4, s[44:47], s56 offen offset:3072 sc1
    s_waitcnt vmcnt(3)
    s_waitcnt lgkmcnt(4)
    v_mfma_f32_16x16x32_bf16 v[144:147], v[80:83], v[8:11], 0
    ds_read_b128 v[96:99], v120 offset:4608
    s_waitcnt lgkmcnt(4)
    v_mfma_f32_16x16x32_bf16 v[148:151], v[84:87], v[8:11], 0
    ds_read_b128 v[100:103], v120 offset:5632
    s_add_u32 s56, s56, 4096
    buffer_load_dwordx4 v[24:27], v4, s[44:47], s56 offen offset:0 sc1
    s_waitcnt lgkmcnt(4)
    v_mfma_f32_16x16x32_bf16 v[152:155], v[88:91], v[8:11], 0
    ds_read_b128 v[104:107], v120 offset:6656
    s_waitcnt lgkmcnt(4)
    v_mfma_f32_16x16x32_bf16 v[156:159], v[92:95], v[8:11], 0
    ds_read_b128 v[108:111], v120 offset:7680
    s_waitcnt lgkmcnt(4)
    v_mfma_f32_16x16x32_bf16 v[160:163], v[112:115], v[8:11], 0
    ds_read_b128 v[164:167], v116 offset:4608
    s_waitcnt vmcnt(3)
    s_waitcnt lgkmcnt(4)
    v_mfma_f32_16x16x32_bf16 v[144:147], v[96:99], v[12:15], v[144:147]
    ds_read_b128 v[80:83], v120 offset:9216
    s_waitcnt lgkmcnt(4)
    v_mfma_f32_16x16x32_bf16 v[148:151], v[100:103], v[12:15], v[148:151]
    ds_read_b128 v[84:87], v120 offset:10240
    buffer_load_dwordx4 v[28:31], v4, s[44:47], s56 offen offset:1024 sc1
    s_waitcnt lgkmcnt(4)
    v_mfma_f32_16x16x32_bf16 v[152:155], v[104:107], v[12:15], v[152:155]
    ds_read_b128 v[88:91], v120 offset:11264
    s_waitcnt lgkmcnt(4)
    v_mfma_f32_16x16x32_bf16 v[156:159], v[108:111], v[12:15], v[156:159]
    ds_read_b128 v[92:95], v120 offset:12288
    s_waitcnt lgkmcnt(4)
    v_mfma_f32_16x16x32_bf16 v[160:163], v[164:167], v[12:15], v[160:163]
    ds_read_b128 v[112:115], v116 offset:9216
    s_waitcnt vmcnt(3)
    s_waitcnt lgkmcnt(4)
    v_mfma_f32_16x16x32_bf16 v[144:147], v[80:83], v[16:19], v[144:147]
    ds_read_b128 v[96:99], v120 offset:13824
    s_waitcnt lgkmcnt(4)
    v_mfma_f32_16x16x32_bf16 v[148:151], v[84:87], v[16:19], v[148:151]
    ds_read_b128 v[100:103], v120 offset:14848
    buffer_load_dwordx4 v[32:35], v4, s[44:47], s56 offen offset:2048 sc1
    s_waitcnt lgkmcnt(4)
    v_mfma_f32_16x16x32_bf16 v[152:155], v[88:91], v[16:19], v[152:155]
    ds_read_b128 v[104:107], v120 offset:15872
    s_waitcnt lgkmcnt(4)
    v_mfma_f32_16x16x32_bf16 v[156:159], v[92:95], v[16:19], v[156:159]
    ds_read_b128 v[108:111], v120 offset:16896
    s_waitcnt lgkmcnt(4)
    v_mfma_f32_16x16x32_bf16 v[160:163], v[112:115], v[16:19], v[160:163]
    ds_read_b128 v[164:167], v116 offset:13824
    s_waitcnt vmcnt(3)
    s_waitcnt lgkmcnt(4)
    v_mfma_f32_16x16x32_bf16 v[144:147], v[96:99], v[20:23], v[144:147]
    ds_read_b128 v[80:83], v120 offset:18432
    s_waitcnt lgkmcnt(4)
    v_mfma_f32_16x16x32_bf16 v[148:151], v[100:103], v[20:23], v[148:151]
    ds_read_b128 v[84:87], v120 offset:19456
    buffer_load_dwordx4 v[36:39], v4, s[44:47], s56 offen offset:3072 sc1
    s_waitcnt lgkmcnt(4)
    v_mfma_f32_16x16x32_bf16 v[152:155], v[104:107], v[20:23], v[152:155]
    ds_read_b128 v[88:91], v120 offset:20480
    s_waitcnt lgkmcnt(4)
    v_mfma_f32_16x16x32_bf16 v[156:159], v[108:111], v[20:23], v[156:159]
    ds_read_b128 v[92:95], v120 offset:21504
    s_waitcnt lgkmcnt(4)
    v_mfma_f32_16x16x32_bf16 v[160:163], v[164:167], v[20:23], v[160:163]
    ds_read_b128 v[112:115], v116 offset:18432
    s_waitcnt vmcnt(3)
    s_waitcnt lgkmcnt(4)
    v_mfma_f32_16x16x32_bf16 v[144:147], v[80:83], v[24:27], v[144:147]
    ds_read_b128 v[96:99], v120 offset:23040
    s_waitcnt lgkmcnt(4)
    v_mfma_f32_16x16x32_bf16 v[148:151], v[84:87], v[24:27], v[148:151]
    ds_read_b128 v[100:103], v120 offset:24064
    s_add_u32 s56, s56, 4096
    buffer_load_dwordx4 v[40:43], v4, s[44:47], s56 offen offset:0 sc1
    s_waitcnt lgkmcnt(4)
    v_mfma_f32_16x16x32_bf16 v[152:155], v[88:91], v[24:27], v[152:155]
    ds_read_b128 v[104:107], v120 offset:25088
    s_waitcnt lgkmcnt(4)
    v_mfma_f32_16x16x32_bf16 v[156:159], v[92:95], v[24:27], v[156:159]
    ds_read_b128 v[108:111], v120 offset:26112
    s_waitcnt lgkmcnt(4)
    v_mfma_f32_16x16x32_bf16 v[160:163], v[112:115], v[24:27], v[160:163]
    ds_read_b128 v[164:167], v116 offset:23040
    s_waitcnt vmcnt(3)
    s_waitcnt lgkmcnt(4)
    v_mfma_f32_16x16x32_bf16 v[144:147], v[96:99], v[28:31], v[144:147]
    ds_read_b128 v[80:83], v121 offset:0
    s_waitcnt lgkmcnt(4)
    v_mfma_f32_16x16x32_bf16 v[148:151], v[100:103], v[28:31], v[148:151]
    ds_read_b128 v[84:87], v121 offset:1024
    buffer_load_dwordx4 v[44:47], v4, s[44:47], s56 offen offset:1024 sc1
    s_waitcnt lgkmcnt(4)
    v_mfma_f32_16x16x32_bf16 v[152:155], v[104:107], v[28:31], v[152:155]
    ds_read_b128 v[88:91], v121 offset:2048
    s_waitcnt lgkmcnt(4)
    v_mfma_f32_16x16x32_bf16 v[156:159], v[108:111], v[28:31], v[156:159]
    ds_read_b128 v[92:95], v121 offset:3072
    s_waitcnt lgkmcnt(4)
    v_mfma_f32_16x16x32_bf16 v[160:163], v[164:167], v[28:31], v[160:163]
    ds_read_b128 v[112:115], v117 offset:0
    s_waitcnt vmcnt(3)
    s_waitcnt lgkmcnt(4)
    v_mfma_f32_16x16x32_bf16 v[144:147], v[80:83], v[32:35], v[144:147]
    ds_read_b128 v[96:99], v121 offset:4608
    s_waitcnt lgkmcnt(4)
    v_mfma_f32_16x16x32_bf16 v[148:151], v[84:87], v[32:35], v[148:151]
    ds_read_b128 v[100:103], v121 offset:5632
    buffer_load_dwordx4 v[48:51], v4, s[44:47], s56 offen offset:2048 sc1
    s_waitcnt lgkmcnt(4)
    v_mfma_f32_16x16x32_bf16 v[152:155], v[88:91], v[32:35], v[152:155]
    ds_read_b128 v[104:107], v121 offset:6656
    s_waitcnt lgkmcnt(4)
    v_mfma_f32_16x16x32_bf16 v[156:159], v[92:95], v[32:35], v[156:159]
    ds_read_b128 v[108:111], v121 offset:7680
    s_waitcnt lgkmcnt(4)
    v_mfma_f32_16x16x32_bf16 v[160:163], v[112:115], v[32:35], v[160:163]
    ds_read_b128 v[164:167], v117 offset:4608
    s_waitcnt vmcnt(3)
    s_waitcnt lgkmcnt(4)
    v_mfma_f32_16x16x32_bf16 v[144:147], v[96:99], v[36:39], v[144:147]
    ds_read_b128 v[80:83], v121 offset:9216
    s_waitcnt lgkmcnt(4)
    v_mfma_f32_16x16x32_bf16 v[148:151], v[100:103], v[36:39], v[148:151]
    ds_read_b128 v[84:87], v121 offset:10240
    buffer_load_dwordx4 v[52:55], v4, s[44:47], s56 offen offset:3072 sc1
    s_waitcnt lgkmcnt(4)
    v_mfma_f32_16x16x32_bf16 v[152:155], v[104:107], v[36:39], v[152:155]
    ds_read_b128 v[88:91], v121 offset:11264
    s_waitcnt lgkmcnt(4)
    v_mfma_f32_16x16x32_bf16 v[156:159], v[108:111], v[36:39], v[156:159]
    ds_read_b128 v[92:95], v121 offset:12288
    s_waitcnt lgkmcnt(4)
    v_mfma_f32_16x16x32_bf16 v[160:163], v[164:167], v[36:39], v[160:163]
    ds_read_b128 v[112:115], v117 offset:9216
    s_waitcnt vmcnt(3)
    s_waitcnt lgkmcnt(4)
    v_mfma_f32_16x16x32_bf16 v[144:147], v[80:83], v[40:43], v[144:147]
    ds_read_b128 v[96:99], v121 offset:13824
    s_waitcnt lgkmcnt(4)
    v_mfma_f32_16x16x32_bf16 v[148:151], v[84:87], v[40:43], v[148:151]
    ds_read_b128 v[100:103], v121 offset:14848
    s_add_u32 s56, s56, 4096
    buffer_load_dwordx4 v[56:59], v4, s[44:47], s56 offen offset:0 sc1
    s_waitcnt lgkmcnt(4)
    v_mfma_f32_16x16x32_bf16 v[152:155], v[88:91], v[40:43], v[152:155]
    ds_read_b128 v[104:107], v121 offset:15872
    s_waitcnt lgkmcnt(4)
    v_mfma_f32_16x16x32_bf16 v[156:159], v[92:95], v[40:43], v[156:159]
    ds_read_b128 v[108:111], v121 offset:16896
    s_waitcnt lgkmcnt(4)
    v_mfma_f32_16x16x32_bf16 v[160:163], v[112:115], v[40:43], v[160:163]
    ds_read_b128 v[164:167], v117 offset:13824
    s_waitcnt vmcnt(3)
    s_waitcnt lgkmcnt(4)
    v_mfma_f32_16x16x32_bf16 v[144:147], v[96:99], v[44:47], v[144:147]
    ds_read_b128 v[80:83], v121 offset:18432
    s_waitcnt lgkmcnt(4)
    v_mfma_f32_16x16x32_bf16 v[148:151], v[100:103], v[44:47], v[148:151]
    ds_read_b128 v[84:87], v121 offset:19456
    buffer_load_dwordx4 v[60:63], v4, s[44:47], s56 offen offset:1024 sc1
    s_waitcnt lgkmcnt(4)
    v_mfma_f32_16x16x32_bf16 v[152:155], v[104:107], v[44:47], v[152:155]
    ds_read_b128 v[88:91], v121 offset:20480
    s_waitcnt lgkmcnt(4)
    v_mfma_f32_16x16x32_bf16 v[156:159], v[108:111], v[44:47], v[156:159]
    ds_read_b128 v[92:95], v121 offset:21504
    s_waitcnt lgkmcnt(4)
    v_mfma_f32_16x16x32_bf16 v[160:163], v[164:167], v[44:47], v[160:163]
    ds_read_b128 v[112:115], v117 offset:18432
    s_waitcnt vmcnt(3)
    s_waitcnt lgkmcnt(4)
    v_mfma_f32_16x16x32_bf16 v[144:147], v[80:83], v[48:51], v[144:147]
    ds_read_b128 v[96:99], v121 offset:23040
    s_waitcnt lgkmcnt(4)
    v_mfma_f32_16x16x32_bf16 v[148:151], v[84:87], v[48:51], v[148:151]
    ds_read_b128 v[100:103], v121 offset:24064
    buffer_load_dwordx4 v[64:67], v4, s[44:47], s56 offen offset:2048 sc1
    s_waitcnt lgkmcnt(4)
    v_mfma_f32_16x16x32_bf16 v[152:155], v[88:91], v[48:51], v[152:155]
    ds_read_b128 v[104:107], v121 offset:25088
    s_waitcnt lgkmcnt(4)
    v_mfma_f32_16x16x32_bf16 v[156:159], v[92:95], v[48:51], v[156:159]
    ds_read_b128 v[108:111], v121 offset:26112
    s_waitcnt lgkmcnt(4)
    v_mfma_f32_16x16x32_bf16 v[160:163], v[112:115], v[48:51], v[160:163]
    ds_read_b128 v[164:167], v117 offset:23040
    s_waitcnt vmcnt(3)
    s_waitcnt lgkmcnt(4)
    v_mfma_f32_16x16x32_bf16 v[144:147], v[96:99], v[52:55], v[144:147]
    ds_read_b128 v[80:83], v121 offset:27648
    s_waitcnt lgkmcnt(4)
    v_mfma_f32_16x16x32_bf16 v[148:151], v[100:103], v[52:55], v[148:151]
    ds_read_b128 v[84:87], v121 offset:28672
    buffer_load_dwordx4 v[68:71], v4, s[44:47], s56 offen offset:3072 sc1
    s_waitcnt lgkmcnt(4)
    v_mfma_f32_16x16x32_bf16 v[152:155], v[104:107], v[52:55], v[152:155]
    ds_read_b128 v[88:91], v121 offset:29696
    s_waitcnt lgkmcnt(4)
    v_mfma_f32_16x16x32_bf16 v[156:159], v[108:111], v[52:55], v[156:159]
    ds_read_b128 v[92:95], v121 offset:30720
    s_waitcnt lgkmcnt(4)
    v_mfma_f32_16x16x32_bf16 v[160:163], v[164:167], v[52:55], v[160:163]
    ds_read_b128 v[112:115], v117 offset:27648
    s_waitcnt vmcnt(3)
    s_waitcnt lgkmcnt(4)
    v_mfma_f32_16x16x32_bf16 v[144:147], v[80:83], v[56:59], v[144:147]
    ds_read_b128 v[96:99], v121 offset:32256
    s_waitcnt lgkmcnt(4)
    v_mfma_f32_16x16x32_bf16 v[148:151], v[84:87], v[56:59], v[148:151]
    ds_read_b128 v[100:103], v121 offset:33280
    s_add_u32 s56, s56, 4096
    buffer_load_dwordx4 v[72:75], v4, s[44:47], s56 offen offset:0 sc1
    s_waitcnt lgkmcnt(4)
    v_mfma_f32_16x16x32_bf16 v[152:155], v[88:91], v[56:59], v[152:155]
    ds_read_b128 v[104:107], v121 offset:34304
    s_waitcnt lgkmcnt(4)
    v_mfma_f32_16x16x32_bf16 v[156:159], v[92:95], v[56:59], v[156:159]
    ds_read_b128 v[108:111], v121 offset:35328
    s_waitcnt lgkmcnt(4)
    v_mfma_f32_16x16x32_bf16 v[160:163], v[112:115], v[56:59], v[160:163]
    ds_read_b128 v[164:167], v117 offset:32256
    s_waitcnt vmcnt(3)
    s_waitcnt lgkmcnt(4)
    v_mfma_f32_16x16x32_bf16 v[144:147], v[96:99], v[60:63], v[144:147]
    ds_read_b128 v[80:83], v121 offset:36864
    s_waitcnt lgkmcnt(4)
    v_mfma_f32_16x16x32_bf16 v[148:151], v[100:103], v[60:63], v[148:151]
    ds_read_b128 v[84:87], v121 offset:37888
    buffer_load_dwordx4 v[76:79], v4, s[44:47], s56 offen offset:1024 sc1
    s_waitcnt lgkmcnt(4)
    v_mfma_f32_16x16x32_bf16 v[152:155], v[104:107], v[60:63], v[152:155]
    ds_read_b128 v[88:91], v121 offset:38912
    s_waitcnt lgkmcnt(4)
    v_mfma_f32_16x16x32_bf16 v[156:159], v[108:111], v[60:63], v[156:159]
    ds_read_b128 v[92:95], v121 offset:39936
    s_waitcnt lgkmcnt(4)
    v_mfma_f32_16x16x32_bf16 v[160:163], v[164:167], v[60:63], v[160:163]
    ds_read_b128 v[112:115], v117 offset:36864
    s_waitcnt vmcnt(3)
    s_waitcnt lgkmcnt(4)
    v_mfma_f32_16x16x32_bf16 v[144:147], v[80:83], v[64:67], v[144:147]
    ds_read_b128 v[96:99], v121 offset:41472
    s_waitcnt lgkmcnt(4)
    v_mfma_f32_16x16x32_bf16 v[148:151], v[84:87], v[64:67], v[148:151]
    ds_read_b128 v[100:103], v121 offset:42496
    s_waitcnt lgkmcnt(4)
    v_mfma_f32_16x16x32_bf16 v[152:155], v[88:91], v[64:67], v[152:155]
    ds_read_b128 v[104:107], v121 offset:43520
    s_waitcnt lgkmcnt(4)
    v_mfma_f32_16x16x32_bf16 v[156:159], v[92:95], v[64:67], v[156:159]
    ds_read_b128 v[108:111], v121 offset:44544
    s_waitcnt lgkmcnt(4)
    v_mfma_f32_16x16x32_bf16 v[160:163], v[112:115], v[64:67], v[160:163]
    ds_read_b128 v[164:167], v117 offset:41472
    s_waitcnt vmcnt(2)
    s_waitcnt lgkmcnt(4)
    v_mfma_f32_16x16x32_bf16 v[144:147], v[96:99], v[68:71], v[144:147]
    ds_read_b128 v[80:83], v122 offset:0
    s_waitcnt lgkmcnt(4)
    v_mfma_f32_16x16x32_bf16 v[148:151], v[100:103], v[68:71], v[148:151]
    ds_read_b128 v[84:87], v122 offset:1024
    s_waitcnt lgkmcnt(4)
    v_mfma_f32_16x16x32_bf16 v[152:155], v[104:107], v[68:71], v[152:155]
    ds_read_b128 v[88:91], v122 offset:2048
    s_waitcnt lgkmcnt(4)
    v_mfma_f32_16x16x32_bf16 v[156:159], v[108:111], v[68:71], v[156:159]
    ds_read_b128 v[92:95], v122 offset:3072
    s_waitcnt lgkmcnt(4)
    v_mfma_f32_16x16x32_bf16 v[160:163], v[164:167], v[68:71], v[160:163]
    ds_read_b128 v[112:115], v118 offset:0
    s_waitcnt vmcnt(1)
    s_waitcnt lgkmcnt(4)
    v_mfma_f32_16x16x32_bf16 v[144:147], v[80:83], v[72:75], v[144:147]
    ds_read_b128 v[96:99], v122 offset:4608
    s_waitcnt lgkmcnt(4)
    v_mfma_f32_16x16x32_bf16 v[148:151], v[84:87], v[72:75], v[148:151]
    ds_read_b128 v[100:103], v122 offset:5632
    s_waitcnt lgkmcnt(4)
    v_mfma_f32_16x16x32_bf16 v[152:155], v[88:91], v[72:75], v[152:155]
    ds_read_b128 v[104:107], v122 offset:6656
    s_waitcnt lgkmcnt(4)
    v_mfma_f32_16x16x32_bf16 v[156:159], v[92:95], v[72:75], v[156:159]
    ds_read_b128 v[108:111], v122 offset:7680
    s_waitcnt lgkmcnt(4)
    v_mfma_f32_16x16x32_bf16 v[160:163], v[112:115], v[72:75], v[160:163]
    ds_read_b128 v[164:167], v118 offset:4608
    s_waitcnt vmcnt(0)
    s_waitcnt lgkmcnt(4)
    v_mfma_f32_16x16x32_bf16 v[144:147], v[96:99], v[76:79], v[144:147]
    s_waitcnt lgkmcnt(3)
    v_mfma_f32_16x16x32_bf16 v[148:151], v[100:103], v[76:79], v[148:151]
    s_waitcnt lgkmcnt(2)
    v_mfma_f32_16x16x32_bf16 v[152:155], v[104:107], v[76:79], v[152:155]
    s_waitcnt lgkmcnt(1)
    v_mfma_f32_16x16x32_bf16 v[156:159], v[108:111], v[76:79], v[156:159]
    s_waitcnt lgkmcnt(0)
    v_mfma_f32_16x16x32_bf16 v[160:163], v[164:167], v[76:79], v[160:163]
    v_pk_fma_f32 v[144:145], v[144:145], v[122:123], v[124:125] op_sel:[0,1,0] op_sel_hi:[1,1,1]
    v_pk_fma_f32 v[146:147], v[146:147], v[122:123], v[126:127] op_sel:[0,1,0] op_sel_hi:[1,1,1]
    v_cvt_pk_bf16_f32 v144, v144, v145
    v_cvt_pk_bf16_f32 v145, v146, v147
    ds_write_b64 v7, v[144:145] offset:0
    v_pk_fma_f32 v[148:149], v[148:149], v[122:123], v[128:129] op_sel:[0,1,0] op_sel_hi:[1,1,1]
    v_pk_fma_f32 v[150:151], v[150:151], v[122:123], v[130:131] op_sel:[0,1,0] op_sel_hi:[1,1,1]
    v_cvt_pk_bf16_f32 v148, v148, v149
    v_cvt_pk_bf16_f32 v149, v150, v151
    ds_write_b64 v7, v[148:149] offset:32
    v_pk_fma_f32 v[152:153], v[152:153], v[122:123], v[132:133] op_sel:[0,1,0] op_sel_hi:[1,1,1]
    v_pk_fma_f32 v[154:155], v[154:155], v[122:123], v[134:135] op_sel:[0,1,0] op_sel_hi:[1,1,1]
    v_cvt_pk_bf16_f32 v152, v152, v153
    v_cvt_pk_bf16_f32 v153, v154, v155
    ds_write_b64 v7, v[152:153] offset:64
    v_pk_fma_f32 v[156:157], v[156:157], v[122:123], v[136:137] op_sel:[0,1,0] op_sel_hi:[1,1,1]
    v_pk_fma_f32 v[158:159], v[158:159], v[122:123], v[138:139] op_sel:[0,1,0] op_sel_hi:[1,1,1]
    v_cvt_pk_bf16_f32 v156, v156, v157
    v_cvt_pk_bf16_f32 v157, v158, v159
    ds_write_b64 v7, v[156:157] offset:96
    v_pk_fma_f32 v[160:161], v[160:161], v[122:123], v[140:141] op_sel:[0,1,0] op_sel_hi:[1,1,1]
    v_pk_fma_f32 v[162:163], v[162:163], v[122:123], v[142:143] op_sel:[0,1,0] op_sel_hi:[1,1,1]
    v_cvt_pk_bf16_f32 v160, v160, v161
    v_cvt_pk_bf16_f32 v161, v162, v163
    ds_write_b64 v7, v[160:161] offset:128
    ds_read_b128 v[80:83], v0
    ds_read_b128 v[84:87], v2
    s_mov_b64 exec, 0xffff
    ds_read_b128 v[88:91], v5
    s_mov_b64 exec, -1
    s_waitcnt lgkmcnt(2)
    buffer_store_dwordx4 v[80:83], v6, s[48:51], 0 offen
    s_waitcnt lgkmcnt(1)
    buffer_store_dwordx4 v[84:87], v119, s[48:51], 0 offen
    s_mov_b64 exec, 0xffff
    s_waitcnt lgkmcnt(0)
    buffer_store_dwordx4 v[88:91], v1, s[48:51], 0 offen
    s_mov_b64 exec, -1
    s_endpgm
Lroles:
    s_waitcnt lgkmcnt(0)
    s_mov_b32 s44, s42
    s_mov_b32 s45, s43
    s_mov_b32 s46, 7471104
    s_mov_b32 s47, 0x20000
    s_mov_b32 s92, s36
    s_mov_b32 s93, s37
    s_mov_b32 s94, 1152
    s_mov_b32 s95, 0x20000
    s_and_b32 s10, s3, 3
    s_lshr_b32 s11, s3, 2
    s_mov_b32 s97, 0
    s_cmp_eq_u32 s10, 0
    s_cbranch_scc1 Lrole0
    s_cmp_ge_u32 s3, 6
    s_cbranch_scc1 Lrole1
    s_sub_u32 s60, s3, 1
    s_min_u32 s60, s60, 3
    s_mov_b32 s48, s28
    s_mov_b32 s49, s29
    s_mov_b32 s50, 663552
    s_mov_b32 s51, 0x20000
    s_add_u32 s61, s60, 4
    s_mul_i32 s12, s5, 144
    v_lshl_add_u32 v12, s60, 6, v1
    v_mul_u32_u24 v10, 7282, v12
    v_lshrrev_b32 v10, 16, v10
    v_mul_u32_u24 v11, 9, v10
    v_sub_u32 v11, v12, v11
    v_bfe_u32 v12, v10, 1, 2
    v_and_or_b32 v12, v10, 56, v12
    v_and_b32 v10, 1, v10
    v_lshl_or_b32 v10, v10, 2, v12
    v_mul_u32_u24 v10, 1152, v10
    v_lshl_add_u32 v10, v11, 4, v10
    v_add_u32 v5, s12, v10
    v_lshl_add_u32 v12, s61, 6, v1
    v_mul_u32_u24 v10, 7282, v12
    v_lshrrev_b32 v10, 16, v10
    v_mul_u32_u24 v11, 9, v10
    v_sub_u32 v11, v12, v11
    v_bfe_u32 v12, v10, 1, 2
    v_and_or_b32 v12, v10, 56, v12
    v_and_b32 v10, 1, v10
    v_lshl_or_b32 v10, v10, 2, v12
    v_mul_u32_u24 v10, 1152, v10
    v_lshl_add_u32 v10, v11, 4, v10
    v_add_u32 v6, s12, v10
    v_lshl_add_u32 v12, 8, 6, v1
    v_mul_u32_u24 v10, 7282, v12
    v_lshrrev_b32 v10, 16, v10
    v_mul_u32_u24 v11, 9, v10
    v_sub_u32 v11, v12, v11
    v_bfe_u32 v12, v10, 1, 2
    v_and_or_b32 v12, v10, 56, v12
    v_and_b32 v10, 1, v10
    v_lshl_or_b32 v10, v10, 2, v12
    v_mul_u32_u24 v10, 1152, v10
    v_lshl_add_u32 v10, v11, 4, v10
    v_add_u32 v7, s12, v10
    s_lshl_b32 s12, s60, 2
    v_add_u32 v8, s12, v3
    s_lshl_b32 s58, s60, 10
    s_lshl_b32 s59, s61, 10
    s_mov_b32 s57, s8
    s_mul_i32 s31, s11, 73728
    v_and_b32 v142, 31, v1
    v_lshrrev_b32 v143, 5, v1
    v_lshl_add_u32 v131, v1, 4, s31
    v_mul_u32_u24 v4, 288, v143
    v_lshl_add_u32 v4, v142, 4, v4
    v_add_u32 v132, s31, v4
    v_lshl_add_u32 v133, v142, 4, s31
    s_lshl_b32 s12, s11, 2
    v_add_u32 v134, s12, v3
    v_mov_b32 v130, 0xdddddddd
    v_cmp_eq_u32 vcc, 18, v142
    v_cmp_eq_u32 s[12:13], 20, v142
    s_nop 0
    s_or_b64 vcc, vcc, s[12:13]
    v_mov_b32 v4, 0x3f803f80
    v_cndmask_b32 v4, 0, v4, vcc
    v_mov_b32 v112, v4
    v_mov_b32 v113, v4
    v_mov_b32 v114, v4
    v_mov_b32 v115, v4
    v_mov_b32 v116, v4
    v_mov_b32 v117, v4
    v_mov_b32 v118, v4
    v_mov_b32 v119, v4
    v_mov_b32 v104, 0x3f80
    v_mov_b32 v105, 0x3f80
    v_mov_b32 v106, 0x3f80
    v_mov_b32 v107, 0x3f80
    v_mov_b32 v120, v4
    v_mov_b32 v121, v4
    v_mov_b32 v122, v4
    v_mov_b32 v123, v4
    v_mov_b32 v124, v4
    v_mov_b32 v125, v4
    v_mov_b32 v126, v4
    v_mov_b32 v127, v4
    v_mov_b32 v108, 0x3f80
    v_mov_b32 v109, 0x3f80
    v_mov_b32 v110, 0x3f80
    v_mov_b32 v111, 0x3f80
    v_cmp_gt_u32 s[36:37], 18, v142
    v_mov_b32 v48, 0
    v_mov_b32 v49, 0
    v_mov_b32 v50, 0
    v_mov_b32 v51, 0
    v_mov_b32 v52, 0
    v_mov_b32 v53, 0
    v_mov_b32 v54, 0
    v_mov_b32 v55, 0
    v_mov_b32 v56, 0
    v_mov_b32 v57, 0
    v_mov_b32 v58, 0
    v_mov_b32 v59, 0
    v_mov_b32 v60, 0
    v_mov_b32 v61, 0
    v_mov_b32 v62, 0
    v_mov_b32 v63, 0
    v_mov_b32 v88, 0
    v_mov_b32 v89, 0
    v_mov_b32 v90, 0
    v_mov_b32 v91, 0
    v_mov_b32 v64, 0
    v_mov_b32 v65, 0
    v_mov_b32 v66, 0
    v_mov_b32 v67, 0
    v_mov_b32 v68, 0
    v_mov_b32 v69, 0
    v_mov_b32 v70, 0
    v_mov_b32 v71, 0
    v_mov_b32 v72, 0
    v_mov_b32 v73, 0
    v_mov_b32 v74, 0
    v_mov_b32 v75, 0
    v_mov_b32 v76, 0
    v_mov_b32 v77, 0
    v_mov_b32 v78, 0
    v_mov_b32 v79, 0
    v_mov_b32 v92, 0
    v_mov_b32 v93, 0
    v_mov_b32 v94, 0
    v_mov_b32 v95, 0
    s_mul_i32 s12, s10, 36
    s_add_u32 s12, s12, 147456
    v_mul_u32_u24 v4, 168, v142
    v_add_u32 v135, s12, v4
    v_lshl_add_u32 v136, v143, 4, v135
    v_add_u32 v15, 5376, v136
    s_lshl_b32 s12, s10, 7
    s_add_u32 s12, s12, 162816
    v_and_b32 v14, 31, v1
    v_lshl_add_u32 v14, v14, 2, s12
    s_mul_i32 s12, s10, 6144
    s_add_u32 s12, s12, 0
    v_lshl_add_u32 v137, v1, 4, s12
    s_lshl_b32 s12, s10, 2
    v_add_u32 v138, s12, v3
    s_add_u32 s12, s12, 158272
    s_cmp_eq_u32 s11, 0
    s_cselect_b32 s12, 158360, s12
    v_mov_b32 v141, s12
    v_and_b32 v142, 15, v1
    v_bfe_u32 v4, v1, 4, 1
    v_mul_u32_u24 v4, 18432, v4
    v_lshl_add_u32 v139, v142, 4, v4
    v_lshl_add_u32 v140, v143, 8, v139
    s_mul_i32 s12, s4, 73728
    s_add_u32 s12, s12, 2031616
    s_lshl_b32 s13, s5, 11
    s_lshl_b32 s14, s10, 9
    s_add_u32 s13, s13, s14
    s_add_u32 s38, s12, s13
    s_lshl_b32 s13, s5, 8
    s_lshl_b32 s14, s10, 2
    s_add_u32 s13, s13, s14
    s_add_u32 s13, s13, 16384
    s_add_u32 s39, s12, s13
    v_mul_u32_u24 v4, 36864, v143
    v_add_u32 v139, v139, v4
    s_lshl_b32 s12, s11, 3
    v_add_u32 v4, s12, v3
    s_barrier
    s_setprio 2
    s_mul_i32 s55, s57, 73728
    s_add_u32 m0, s58, 27648
    s_nop 0
    buffer_load_dwordx4 v5, s[48:51], s55 offen lds
    s_add_u32 m0, s59, 27648
    s_nop 0
    buffer_load_dwordx4 v6, s[48:51], s55 offen lds
    s_cmp_eq_u32 s60, 0
    s_cbranch_scc0 Lc8_95
    s_mov_b32 m0, 35840
    s_nop 0
    buffer_load_dwordx4 v7, s[48:51], s55 offen lds
Lc8_95:
    s_add_u32 s57, s57, 1
    s_cmp_eq_u32 s57, 9
    s_cselect_b32 s57, 0, s57
    s_mul_i32 s55, s57, 73728
    s_add_u32 m0, s58, 36864
    s_nop 0
    buffer_load_dwordx4 v5, s[48:51], s55 offen lds
    s_add_u32 m0, s59, 36864
    s_nop 0
    buffer_load_dwordx4 v6, s[48:51], s55 offen lds
    s_cmp_eq_u32 s60, 1
    s_cbranch_scc0 Lc8_96
    s_mov_b32 m0, 45056
    s_nop 0
    buffer_load_dwordx4 v7, s[48:51], s55 offen lds
Lc8_96:
    s_add_u32 s57, s57, 1
    s_cmp_eq_u32 s57, 9
    s_cselect_b32 s57, 0, s57
    s_mul_i32 s55, s57, 73728
    s_add_u32 m0, s58, 46080
    s_nop 0
    buffer_load_dwordx4 v5, s[48:51], s55 offen lds
    s_add_u32 m0, s59, 46080
    s_nop 0
    buffer_load_dwordx4 v6, s[48:51], s55 offen lds
    s_cmp_eq_u32 s60, 2
    s_cbranch_scc0 Lc8_97
    s_mov_b32 m0, 54272
    s_nop 0
    buffer_load_dwordx4 v7, s[48:51], s55 offen lds
Lc8_97:
    s_add_u32 s57, s57, 1
    s_cmp_eq_u32 s57, 9
    s_cselect_b32 s57, 0, s57
    s_mov_b64 exec, 1
    v_mov_b32 v9, 1
    s_waitcnt vmcnt(4)
    ds_write_b32 v8, v9 offset:80
    s_mov_b64 exec, -1
    s_mul_i32 s55, s57, 73728
    s_add_u32 m0, s58, 55296
    s_nop 0
    buffer_load_dwordx4 v5, s[48:51], s55 offen lds
    s_add_u32 m0, s59, 55296
    s_nop 0
    buffer_load_dwordx4 v6, s[48:51], s55 offen lds
    s_cmp_eq_u32 s60, 3
    s_cbranch_scc0 Lc8_98
    s_mov_b32 m0, 63488
    s_nop 0
    buffer_load_dwordx4 v7, s[48:51], s55 offen lds
Lc8_98:
    s_add_u32 s57, s57, 1
    s_cmp_eq_u32 s57, 9
    s_cselect_b32 s57, 0, s57
    s_mov_b64 exec, 1
    v_mov_b32 v9, 2
    s_waitcnt vmcnt(4)
    ds_write_b32 v8, v9 offset:80
    s_mov_b64 exec, -1
    s_mul_i32 s55, s57, 73728
    s_add_u32 m0, s58, 64512
    s_nop 0
    buffer_load_dwordx4 v5, s[48:51], s55 offen lds
    s_add_u32 m0, s59, 64512
    s_nop 0
    buffer_load_dwordx4 v6, s[48:51], s55 offen lds
    s_cmp_eq_u32 s60, 0
    s_cbranch_scc0 Lc8_99
    s_mov_b32 m0, 72704
    s_nop 0
    buffer_load_dwordx4 v7, s[48:51], s55 offen lds
Lc8_99:
    s_add_u32 s57, s57, 1
    s_cmp_eq_u32 s57, 9
    s_cselect_b32 s57, 0, s57
    s_mov_b64 exec, 1
    v_mov_b32 v9, 3
    s_waitcnt vmcnt(4)
    ds_write_b32 v8, v9 offset:80
    s_mov_b64 exec, -1
    s_mul_i32 s55, s57, 73728
    s_add_u32 m0, s58, 101376
    s_nop 0
    buffer_load_dwordx4 v5, s[48:51], s55 offen lds
    s_add_u32 m0, s59, 101376
    s_nop 0
    buffer_load_dwordx4 v6, s[48:51], s55 offen lds
    s_cmp_eq_u32 s60, 1
    s_cbranch_scc0 Lc8_100
    s_mov_b32 m0, 109568
    s_nop 0
    buffer_load_dwordx4 v7, s[48:51], s55 offen lds
Lc8_100:
    s_add_u32 s57, s57, 1
    s_cmp_eq_u32 s57, 9
    s_cselect_b32 s57, 0, s57
    s_mov_b64 exec, 1
    v_mov_b32 v9, 4
    s_waitcnt vmcnt(4)
    ds_write_b32 v8, v9 offset:80
    s_mov_b64 exec, -1
    s_mul_i32 s55, s57, 73728
    s_add_u32 m0, s58, 110592
    s_nop 0
    buffer_load_dwordx4 v5, s[48:51], s55 offen lds
    s_add_u32 m0, s59, 110592
    s_nop 0
    buffer_load_dwordx4 v6, s[48:51], s55 offen lds
    s_cmp_eq_u32 s60, 2
    s_cbranch_scc0 Lc8_101
    s_mov_b32 m0, 118784
    s_nop 0
    buffer_load_dwordx4 v7, s[48:51], s55 offen lds
Lc8_101:
    s_add_u32 s57, s57, 1
    s_cmp_eq_u32 s57, 9
    s_cselect_b32 s57, 0, s57
    s_mov_b64 exec, 1
    v_mov_b32 v9, 5
    s_waitcnt vmcnt(4)
    ds_write_b32 v8, v9 offset:80
    s_mov_b64 exec, -1
    s_mov_b32 s15, 200000
Lspin_102:
    ds_read_b32 v9, v3 offset:60
    s_waitcnt lgkmcnt(0)
    v_readfirstlane_b32 s14, v9
    s_nop 0
    s_cmp_ge_u32 s14, 6
    s_cbranch_scc1 Lsd_103
    s_sleep 0
    s_sub_u32 s15, s15, 1
    s_cbranch_scc0 Lspin_102
Lsd_103:
    s_mul_i32 s55, s57, 73728
    s_add_u32 m0, s58, 119808
    s_nop 0
    buffer_load_dwordx4 v5, s[48:51], s55 offen lds
    s_add_u32 m0, s59, 119808
    s_nop 0
    buffer_load_dwordx4 v6, s[48:51], s55 offen lds
    s_cmp_eq_u32 s60, 3
    s_cbranch_scc0 Lc8_104
    s_mov_b32 m0, 128000
    s_nop 0
    buffer_load_dwordx4 v7, s[48:51], s55 offen lds
Lc8_104:
    s_add_u32 s57, s57, 1
    s_cmp_eq_u32 s57, 9
    s_cselect_b32 s57, 0, s57
    s_mov_b64 exec, 1
    v_mov_b32 v9, 6
    s_waitcnt vmcnt(4)
    ds_write_b32 v8, v9 offset:80
    s_mov_b64 exec, -1
    s_mul_i32 s55, s57, 73728
    s_add_u32 m0, s58, 129024
    s_nop 0
    buffer_load_dwordx4 v5, s[48:51], s55 offen lds
    s_add_u32 m0, s59, 129024
    s_nop 0
    buffer_load_dwordx4 v6, s[48:51], s55 offen lds
    s_cmp_eq_u32 s60, 0
    s_cbranch_scc0 Lc8_105
    s_mov_b32 m0, 137216
    s_nop 0
    buffer_load_dwordx4 v7, s[48:51], s55 offen lds
Lc8_105:
    s_mov_b64 exec, 1
    v_mov_b32 v9, 7
    s_waitcnt vmcnt(4)
    ds_write_b32 v8, v9 offset:80
    s_mov_b64 exec, -1
    s_mov_b64 exec, 1
    v_mov_b32 v9, 8
    s_waitcnt vmcnt(2)
    ds_write_b32 v8, v9 offset:80
    s_mov_b64 exec, -1
    s_mov_b64 exec, 1
    v_mov_b32 v9, 9
    s_waitcnt vmcnt(0)
    ds_write_b32 v8, v9 offset:80
    s_mov_b64 exec, -1
    s_branch Lattn
Lrole0:
    v_lshlrev_b32 v5, 4, v1
    s_lshl_b32 s12, s11, 8
    s_add_u32 s12, s12, 162816
    v_lshl_add_u32 v6, v1, 2, s12
    v_mov_b32 v7, -1
    ds_write_b32 v6, v7
    ds_write_b32 v6, v7 offset:512
    s_barrier
    buffer_load_dword v2, off, s[44:47], 0
    s_cmp_eq_u32 s11, 0
    s_cbranch_scc1 Lnogw
    s_lshl_b32 s12, s8, 3
    v_add_u32 v6, s12, v1
    v_subrev_u32 v7, 72, v6
    v_min_u32 v7, v6, v7
    v_lshlrev_b32 v7, 4, v7
    s_mov_b32 m0, 158464
    s_nop 0
    buffer_load_dwordx4 v7, s[92:95], 0 offen lds
    v_add_u32 v6, 64, v6
    v_subrev_u32 v7, 72, v6
    v_min_u32 v7, v6, v7
    v_lshlrev_b32 v7, 4, v7
    s_mov_b32 m0, 159488
    s_nop 0
    buffer_load_dwordx4 v7, s[92:95], 0 offen lds
Lnogw:
    s_waitcnt vmcnt(0)
    s_mov_b64 exec, 1
    v_mov_b32 v7, 1
    ds_add_u32 v3, v7 offset:108
    s_mov_b64 exec, -1
    v_readfirstlane_b32 s6, v2
    s_nop 0
    s_mul_i32 s6, s6, 1664525
    s_add_u32 s6, s6, 1013904223
    s_not_b32 s7, s6
    s_mov_b64 exec, 1
    v_mov_b32 v6, s6
    v_mov_b32 v7, s7
    ds_write_b64 v3, v[6:7] offset:136
    s_mov_b64 exec, -1
    s_mul_i32 s56, s11, 5
    s_mul_i32 s60, s5, 9
    s_lshl_b32 s12, s56, 8
    s_add_u32 s12, s12, 160512
    v_lshl_add_u32 v12, v1, 2, s12
    v_lshl_add_u32 v8, s56, 6, v1
    v_mul_u32_u24 v6, 7282, v8
    v_lshrrev_b32 v6, 16, v6
    v_mul_u32_u24 v7, 9, v6
    v_sub_u32 v7, v8, v7
    v_bfe_u32 v8, v6, 1, 2
    v_and_or_b32 v8, v6, 56, v8
    v_and_b32 v6, 1, v6
    v_lshl_or_b32 v6, v6, 2, v8
    v_add_u32 v7, s60, v7
    v_lshrrev_b32 v8, 4, v6
    v_mul_u32_u24 v8, 18, v8
    v_and_b32 v9, 3, v6
    v_add_u32 v8, v8, v9
    v_bfe_u32 v9, v6, 2, 1
    v_lshl_add_u32 v8, v9, 3, v8
    v_bfe_u32 v9, v6, 3, 1
    v_lshl_add_u32 v8, v9, 2, v8
    v_mul_u32_u24 v8, 72, v8
    v_add_u32 v10, v8, v7
    v_lshrrev_b32 v8, 1, v6
    v_mul_u32_u24 v8, 18, v8
    v_and_b32 v9, 1, v6
    v_add3_u32 v8, v8, v9, 16
    v_mul_u32_u24 v8, 72, v8
    v_add_u32 v8, v8, v7
    v_lshl_or_b32 v10, v8, 16, v10
    ds_write_b32 v12, v10 offset:0
    s_add_u32 s56, s56, 1
    v_lshl_add_u32 v8, s56, 6, v1
    v_mul_u32_u24 v6, 7282, v8
    v_lshrrev_b32 v6, 16, v6
    v_mul_u32_u24 v7, 9, v6
    v_sub_u32 v7, v8, v7
    v_bfe_u32 v8, v6, 1, 2
    v_and_or_b32 v8, v6, 56, v8
    v_and_b32 v6, 1, v6
    v_lshl_or_b32 v6, v6, 2, v8
    v_add_u32 v7, s60, v7
    v_lshrrev_b32 v8, 4, v6
    v_mul_u32_u24 v8, 18, v8
    v_and_b32 v9, 3, v6
    v_add_u32 v8, v8, v9
    v_bfe_u32 v9, v6, 2, 1
    v_lshl_add_u32 v8, v9, 3, v8
    v_bfe_u32 v9, v6, 3, 1
    v_lshl_add_u32 v8, v9, 2, v8
    v_mul_u32_u24 v8, 72, v8
    v_add_u32 v10, v8, v7
    v_lshrrev_b32 v8, 1, v6
    v_mul_u32_u24 v8, 18, v8
    v_and_b32 v9, 1, v6
    v_add3_u32 v8, v8, v9, 16
    v_mul_u32_u24 v8, 72, v8
    v_add_u32 v8, v8, v7
    v_lshl_or_b32 v10, v8, 16, v10
    ds_write_b32 v12, v10 offset:256
    s_add_u32 s56, s56, 1
    v_lshl_add_u32 v8, s56, 6, v1
    v_mul_u32_u24 v6, 7282, v8
    v_lshrrev_b32 v6, 16, v6
    v_mul_u32_u24 v7, 9, v6
    v_sub_u32 v7, v8, v7
    v_bfe_u32 v8, v6, 1, 2
    v_and_or_b32 v8, v6, 56, v8
    v_and_b32 v6, 1, v6
    v_lshl_or_b32 v6, v6, 2, v8
    v_add_u32 v7, s60, v7
    v_lshrrev_b32 v8, 4, v6
    v_mul_u32_u24 v8, 18, v8
    v_and_b32 v9, 3, v6
    v_add_u32 v8, v8, v9
    v_bfe_u32 v9, v6, 2, 1
    v_lshl_add_u32 v8, v9, 3, v8
    v_bfe_u32 v9, v6, 3, 1
    v_lshl_add_u32 v8, v9, 2, v8
    v_mul_u32_u24 v8, 72, v8
    v_add_u32 v10, v8, v7
    v_lshrrev_b32 v8, 1, v6
    v_mul_u32_u24 v8, 18, v8
    v_and_b32 v9, 1, v6
    v_add3_u32 v8, v8, v9, 16
    v_mul_u32_u24 v8, 72, v8
    v_add_u32 v8, v8, v7
    v_lshl_or_b32 v10, v8, 16, v10
    ds_write_b32 v12, v10 offset:512
    s_add_u32 s56, s56, 1
    v_lshl_add_u32 v8, s56, 6, v1
    v_mul_u32_u24 v6, 7282, v8
    v_lshrrev_b32 v6, 16, v6
    v_mul_u32_u24 v7, 9, v6
    v_sub_u32 v7, v8, v7
    v_bfe_u32 v8, v6, 1, 2
    v_and_or_b32 v8, v6, 56, v8
    v_and_b32 v6, 1, v6
    v_lshl_or_b32 v6, v6, 2, v8
    v_add_u32 v7, s60, v7
    v_lshrrev_b32 v8, 4, v6
    v_mul_u32_u24 v8, 18, v8
    v_and_b32 v9, 3, v6
    v_add_u32 v8, v8, v9
    v_bfe_u32 v9, v6, 2, 1
    v_lshl_add_u32 v8, v9, 3, v8
    v_bfe_u32 v9, v6, 3, 1
    v_lshl_add_u32 v8, v9, 2, v8
    v_mul_u32_u24 v8, 72, v8
    v_add_u32 v10, v8, v7
    v_lshrrev_b32 v8, 1, v6
    v_mul_u32_u24 v8, 18, v8
    v_and_b32 v9, 1, v6
    v_add3_u32 v8, v8, v9, 16
    v_mul_u32_u24 v8, 72, v8
    v_add_u32 v8, v8, v7
    v_lshl_or_b32 v10, v8, 16, v10
    ds_write_b32 v12, v10 offset:768
    s_add_u32 s56, s56, 1
    s_cmp_eq_u32 s11, 1
    s_cbranch_scc1 Lnotab
    v_lshl_add_u32 v8, s56, 6, v1
    v_mul_u32_u24 v6, 7282, v8
    v_lshrrev_b32 v6, 16, v6
    v_mul_u32_u24 v7, 9, v6
    v_sub_u32 v7, v8, v7
    v_bfe_u32 v8, v6, 1, 2
    v_and_or_b32 v8, v6, 56, v8
    v_and_b32 v6, 1, v6
    v_lshl_or_b32 v6, v6, 2, v8
    v_add_u32 v7, s60, v7
    v_lshrrev_b32 v8, 4, v6
    v_mul_u32_u24 v8, 18, v8
    v_and_b32 v9, 3, v6
    v_add_u32 v8, v8, v9
    v_bfe_u32 v9, v6, 2, 1
    v_lshl_add_u32 v8, v9, 3, v8
    v_bfe_u32 v9, v6, 3, 1
    v_lshl_add_u32 v8, v9, 2, v8
    v_mul_u32_u24 v8, 72, v8
    v_add_u32 v10, v8, v7
    v_lshrrev_b32 v8, 1, v6
    v_mul_u32_u24 v8, 18, v8
    v_and_b32 v9, 1, v6
    v_add3_u32 v8, v8, v9, 16
    v_mul_u32_u24 v8, 72, v8
    v_add_u32 v8, v8, v7
    v_lshl_or_b32 v10, v8, 16, v10
    ds_write_b32 v12, v10 offset:1024
    s_add_u32 s56, s56, 1
Lnotab:
    s_mul_i32 s31, s11, 73728
    v_and_b32 v142, 31, v1
    v_lshrrev_b32 v143, 5, v1
    v_lshl_add_u32 v131, v1, 4, s31
    v_mul_u32_u24 v4, 288, v143
    v_lshl_add_u32 v4, v142, 4, v4
    v_add_u32 v132, s31, v4
    v_lshl_add_u32 v133, v142, 4, s31
    s_lshl_b32 s12, s11, 2
    v_add_u32 v134, s12, v3
    v_mov_b32 v130, 0xdddddddd
    v_cmp_eq_u32 vcc, 18, v142
    v_cmp_eq_u32 s[12:13], 20, v142
    s_nop 0
    s_or_b64 vcc, vcc, s[12:13]
    v_mov_b32 v4, 0x3f803f80
    v_cndmask_b32 v4, 0, v4, vcc
    v_mov_b32 v112, v4
    v_mov_b32 v113, v4
    v_mov_b32 v114, v4
    v_mov_b32 v115, v4
    v_mov_b32 v116, v4
    v_mov_b32 v117, v4
    v_mov_b32 v118, v4
    v_mov_b32 v119, v4
    v_mov_b32 v104, 0x3f80
    v_mov_b32 v105, 0x3f80
    v_mov_b32 v106, 0x3f80
    v_mov_b32 v107, 0x3f80
    v_mov_b32 v120, v4
    v_mov_b32 v121, v4
    v_mov_b32 v122, v4
    v_mov_b32 v123, v4
    v_mov_b32 v124, v4
    v_mov_b32 v125, v4
    v_mov_b32 v126, v4
    v_mov_b32 v127, v4
    v_mov_b32 v108, 0x3f80
    v_mov_b32 v109, 0x3f80
    v_mov_b32 v110, 0x3f80
    v_mov_b32 v111, 0x3f80
    v_cmp_gt_u32 s[36:37], 18, v142
    v_mov_b32 v48, 0
    v_mov_b32 v49, 0
    v_mov_b32 v50, 0
    v_mov_b32 v51, 0
    v_mov_b32 v52, 0
    v_mov_b32 v53, 0
    v_mov_b32 v54, 0
    v_mov_b32 v55, 0
    v_mov_b32 v56, 0
    v_mov_b32 v57, 0
    v_mov_b32 v58, 0
    v_mov_b32 v59, 0
    v_mov_b32 v60, 0
    v_mov_b32 v61, 0
    v_mov_b32 v62, 0
    v_mov_b32 v63, 0
    v_mov_b32 v88, 0
    v_mov_b32 v89, 0
    v_mov_b32 v90, 0
    v_mov_b32 v91, 0
    v_mov_b32 v64, 0
    v_mov_b32 v65, 0
    v_mov_b32 v66, 0
    v_mov_b32 v67, 0
    v_mov_b32 v68, 0
    v_mov_b32 v69, 0
    v_mov_b32 v70, 0
    v_mov_b32 v71, 0
    v_mov_b32 v72, 0
    v_mov_b32 v73, 0
    v_mov_b32 v74, 0
    v_mov_b32 v75, 0
    v_mov_b32 v76, 0
    v_mov_b32 v77, 0
    v_mov_b32 v78, 0
    v_mov_b32 v79, 0
    v_mov_b32 v92, 0
    v_mov_b32 v93, 0
    v_mov_b32 v94, 0
    v_mov_b32 v95, 0
    s_mul_i32 s12, s10, 36
    s_add_u32 s12, s12, 147456
    v_mul_u32_u24 v4, 168, v142
    v_add_u32 v135, s12, v4
    v_lshl_add_u32 v136, v143, 4, v135
    v_add_u32 v15, 5376, v136
    s_lshl_b32 s12, s10, 7
    s_add_u32 s12, s12, 162816
    v_and_b32 v14, 31, v1
    v_lshl_add_u32 v14, v14, 2, s12
    s_mul_i32 s12, s10, 6144
    s_add_u32 s12, s12, 0
    v_lshl_add_u32 v137, v1, 4, s12
    s_lshl_b32 s12, s10, 2
    v_add_u32 v138, s12, v3
    s_add_u32 s12, s12, 158272
    s_cmp_eq_u32 s11, 0
    s_cselect_b32 s12, 158360, s12
    v_mov_b32 v141, s12
    v_and_b32 v142, 15, v1
    v_bfe_u32 v4, v1, 4, 1
    v_mul_u32_u24 v4, 18432, v4
    v_lshl_add_u32 v139, v142, 4, v4
    v_lshl_add_u32 v140, v143, 8, v139
    s_mul_i32 s12, s4, 73728
    s_add_u32 s12, s12, 2031616
    s_lshl_b32 s13, s5, 11
    s_lshl_b32 s14, s10, 9
    s_add_u32 s13, s13, s14
    s_add_u32 s38, s12, s13
    s_lshl_b32 s13, s5, 8
    s_lshl_b32 s14, s10, 2
    s_add_u32 s13, s13, s14
    s_add_u32 s13, s13, 16384
    s_add_u32 s39, s12, s13
    v_mul_u32_u24 v4, 36864, v143
    v_add_u32 v139, v139, v4
    s_lshl_b32 s12, s11, 3
    v_add_u32 v4, s12, v3
    s_lshl_b32 s60, s11, 3
    s_lshl_b32 s61, s9, 1
    s_add_u32 s61, s61, s11
    s_mul_i32 s12, s61, 1536
    s_add_u32 s12, s12, 4096
    v_lshlrev_b32 v6, 7, v1
    v_add_u32 v6, s12, v6
    s_mov_b32 s53, 0
    s_cmp_ge_u32 s53, 6
    s_cbranch_scc1 Lpg_106
    s_mov_b32 s15, 200000
Lpl_107:
    ds_read_b128 v[8:11], v3 offset:80
    s_waitcnt lgkmcnt(0)
    v_min3_u32 v8, v8, v9, v10
    v_min_u32 v8, v8, v11
    s_nop 0
    v_readfirstlane_b32 s53, v8
    s_nop 0
    s_cmp_ge_u32 s53, 6
    s_cbranch_scc1 Lpg_106
    s_sleep 2
    s_sub_u32 s15, s15, 1
    s_cbranch_scc0 Lpl_107
Lpg_106:
    s_mov_b32 s15, 200000
Lspin_108:
    ds_read_b32 v7, v3 offset:60
    s_waitcnt lgkmcnt(0)
    v_readfirstlane_b32 s14, v7
    s_nop 0
    s_cmp_ge_u32 s14, 6
    s_cbranch_scc1 Lsd_109
    s_sleep 1
    s_sub_u32 s15, s15, 1
    s_cbranch_scc0 Lspin_108
Lsd_109:
    s_mov_b32 s15, 20000
    s_mov_b64 exec, 0xfff
Lpoll_110:
    buffer_load_dwordx2 v[8:9], v6, s[44:47], 0 offen sc1
    s_waitcnt vmcnt(0)
    v_cmp_ne_u64 vcc, s[6:7], v[8:9]
    s_cbranch_vccz Lpd_111
    s_sleep 2
    s_sub_u32 s15, s15, 1
    s_cbranch_scc0 Lpoll_110
Lpd_111:
    s_mov_b64 exec, -1
    s_mul_i32 s60, s60, 9216
    s_mul_i32 s12, s61, 9216
    s_add_u32 s12, s12, 458752
    s_mov_b32 s13, s60
    s_mov_b32 m0, s13
    s_nop 0
    buffer_load_dwordx4 v5, s[44:47], s12 offen offset:0 sc1 lds
    buffer_load_dwordx4 v5, s[44:47], s12 offen offset:1024 sc1 lds
    buffer_load_dwordx4 v5, s[44:47], s12 offen offset:2048 sc1 lds
    buffer_load_dwordx4 v5, s[44:47], s12 offen offset:3072 sc1 lds
    s_add_u32 s12, s12, 4096
    s_add_u32 s13, s13, 4096
    s_mov_b32 m0, s13
    s_nop 0
    buffer_load_dwordx4 v5, s[44:47], s12 offen offset:0 sc1 lds
    buffer_load_dwordx4 v5, s[44:47], s12 offen offset:1024 sc1 lds
    buffer_load_dwordx4 v5, s[44:47], s12 offen offset:2048 sc1 lds
    buffer_load_dwordx4 v5, s[44:47], s12 offen offset:3072 sc1 lds
    s_add_u32 s12, s12, 4096
    s_add_u32 s13, s13, 4096
    s_mov_b32 m0, s13
    s_nop 0
    buffer_load_dwordx4 v5, s[44:47], s12 offen offset:0 sc1 lds
    s_mov_b64 exec, 1
    v_mov_b32 v7, 1
    ds_add_u32 v3, v7 offset:208
    s_mov_b64 exec, -1
    s_waitcnt vmcnt(0) lgkmcnt(0)
    s_branch Lattn
Lrole1:
    s_mov_b32 s97, 1
    s_sub_u32 s96, 7, s3
    s_lshl_b32 s12, s96, 6
    v_add_u32 v5, s12, v1
    v_cmp_le_u32 vcc, 80, v5
    s_nop 0
    s_mov_b64 s[58:59], vcc
    v_and_b32 v6, 15, v5
    v_lshrrev_b32 v7, 4, v5
    v_subrev_u32 v8, 80, v5
    v_cndmask_b32 v7, v7, v8, s[58:59]
    s_mul_i32 s12, s5, 5
    v_add_u32 v7, s12, v7
    v_cndmask_b32 v6, v6, 0, s[58:59]
    s_cmp_eq_u32 s4, 0
    s_cselect_b32 s12, 5, 0
    s_add_u32 s12, s12, 80
    v_cmp_gt_u32 s[60:61], s12, v5
    v_cmp_gt_u32 vcc, 38, v7
    s_nop 0
    s_and_b64 s[60:61], s[60:61], vcc
    v_min_u32 v7, 37, v7
    s_cmp_eq_u32 s4, 0
    s_cselect_b64 s[12:13], -1, 0
    v_cmp_eq_u32 vcc, 0, v6
    s_nop 0
    s_and_b64 s[56:57], vcc, s[12:13]
    s_andn2_b64 s[54:55], s[56:57], s[58:59]
    v_lshrrev_b32 v9, 1, v6
    v_lshlrev_b32 v10, 7, v6
    v_sub_u32 v11, 71, v7
    v_sub_u32 v12, 72, v7
    v_min_u32 v12, 71, v12
    s_sub_u32 s12, 9, s8
    v_lshrrev_b32 v16, 3, v7
    v_add_u32 v16, s12, v16
    v_subrev_u32 v17, 9, v16
    v_min_u32 v16, v16, v17
    v_lshlrev_b32 v17, 13, v16
    v_mul_u32_u24 v18, 9216, v16
    v_add_u32 v18, 119808, v18
    v_subrev_u32 v19, 16384, v17
    v_cmp_gt_u32 vcc, 2, v16
    s_nop 1
    v_cndmask_b32 v18, v19, v18, vcc
    v_add_u32 v19, 32768, v17
    v_cmp_gt_u32 vcc, 5, v16
    s_nop 1
    v_cndmask_b32 v18, v19, v18, vcc
    v_mov_b32 v19, 147456
    v_cmp_gt_u32 vcc, 8, v16
    s_nop 1
    v_cndmask_b32 v18, v19, v18, vcc
    v_xor_b32 v17, v7, v9
    v_and_b32 v17, 7, v17
    v_lshl_add_u32 v17, v17, 4, v10
    v_add_u32 v13, v17, v18
    v_lshrrev_b32 v16, 3, v11
    v_add_u32 v16, s12, v16
    v_subrev_u32 v17, 9, v16
    v_min_u32 v16, v16, v17
    v_lshlrev_b32 v17, 13, v16
    v_mul_u32_u24 v18, 9216, v16
    v_add_u32 v18, 119808, v18
    v_subrev_u32 v19, 16384, v17
    v_cmp_gt_u32 vcc, 2, v16
    s_nop 1
    v_cndmask_b32 v18, v19, v18, vcc
    v_add_u32 v19, 32768, v17
    v_cmp_gt_u32 vcc, 5, v16
    s_nop 1
    v_cndmask_b32 v18, v19, v18, vcc
    v_mov_b32 v19, 147456
    v_cmp_gt_u32 vcc, 8, v16
    s_nop 1
    v_cndmask_b32 v18, v19, v18, vcc
    v_xor_b32 v17, v11, v9
    v_and_b32 v17, 7, v17
    v_lshl_add_u32 v17, v17, 4, v10
    v_add_u32 v14, v17, v18
    v_lshrrev_b32 v16, 3, v12
    v_add_u32 v16, s12, v16
    v_subrev_u32 v17, 9, v16
    v_min_u32 v16, v16, v17
    v_lshlrev_b32 v17, 13, v16
    v_mul_u32_u24 v18, 9216, v16
    v_add_u32 v18, 119808, v18
    v_subrev_u32 v19, 16384, v17
    v_cmp_gt_u32 vcc, 2, v16
    s_nop 1
    v_cndmask_b32 v18, v19, v18, vcc
    v_add_u32 v19, 32768, v17
    v_cmp_gt_u32 vcc, 5, v16
    s_nop 1
    v_cndmask_b32 v18, v19, v18, vcc
    v_mov_b32 v19, 147456
    v_cmp_gt_u32 vcc, 8, v16
    s_nop 1
    v_cndmask_b32 v18, v19, v18, vcc
    v_xor_b32 v17, v12, v9
    v_and_b32 v17, 7, v17
    v_lshl_add_u32 v17, v17, 4, v10
    v_add_u32 v15, v17, v18
    v_mov_b32 v16, 6144
    v_cndmask_b32 v16, 0, v16, s[58:59]
    v_add_u32 v10, v13, v16
    v_add_u32 v11, v14, v16
    v_add_u32 v12, v15, v16
    s_barrier
    buffer_load_dword v2, off, s[44:47], 0
    s_setprio 0
    s_mov_b32 s15, 200000
Lspin_112:
    ds_read_b32 v16, v3 offset:56
    s_waitcnt lgkmcnt(0)
    v_readfirstlane_b32 s14, v16
    s_nop 0
    s_cmp_ge_u32 s14, 4
    s_cbranch_scc1 Lsd_113
    s_sleep 0
    s_sub_u32 s15, s15, 1
    s_cbranch_scc0 Lspin_112
Lsd_113:
    ds_read_b128 v[20:23], v10 offset:0
    ds_read_b128 v[24:27], v11 offset:0
    ds_read_u16 v52, v12 offset:0
    ds_read_b128 v[28:31], v13 offset:2048
    ds_read_b128 v[32:35], v14 offset:2048
    ds_read_u16 v53, v15 offset:2048
    ds_read_b128 v[36:39], v13 offset:4096
    ds_read_b128 v[40:43], v14 offset:4096
    ds_read_u16 v54, v15 offset:4096
    ds_read_b128 v[44:47], v13 offset:6144
    ds_read_b128 v[48:51], v14 offset:6144
    ds_read_u16 v55, v15 offset:6144
    v_cmp_gt_u32 vcc, 36, v7
    s_nop 1
    v_cndmask_b32 v17, 0, -1, vcc
    v_cmp_eq_u32 vcc, 36, v7
    v_mov_b32 v16, 0xffff
    s_nop 0
    v_cndmask_b32 v16, v17, v16, vcc
    v_cmp_eq_u32 s[12:13], 0, v7
    s_nop 0
    s_or_b64 vcc, vcc, s[12:13]
    v_cndmask_b32 v18, -1, 0, vcc
    s_lshr_b32 s12, s4, 1
    v_mov_b32 v9, s12
    v_cndmask_b32 v9, v9, 16, s[58:59]
    v_mul_u32_u24 v9, 19, v9
    v_lshrrev_b32 v10, 1, v7
    v_add_lshl_u32 v9, v9, v10, 10
    s_and_b32 s12, s4, 1
    s_lshl_b32 s12, s12, 4
    v_add_u32 v10, s12, v6
    v_and_b32 v11, 1, v7
    v_lshl_add_u32 v10, v11, 5, v10
    v_lshl_add_u32 v19, v10, 4, v9
    s_waitcnt vmcnt(0) lgkmcnt(0)
    s_mov_b64 exec, 1
    v_mov_b32 v8, 1
    ds_add_u32 v3, v8 offset:60
    s_mov_b64 exec, -1
    v_readfirstlane_b32 s6, v2
    s_nop 0
    s_mul_i32 s6, s6, 1664525
    s_add_u32 s6, s6, 1013904223
    s_not_b32 s7, s6
    s_mov_b64 exec, s[54:55]
    v_mov_b32 v28, 0
    v_mov_b32 v29, 0
    v_mov_b32 v30, 0
    v_mov_b32 v31, 0
    v_mov_b32 v32, 0
    v_mov_b32 v33, 0
    v_mov_b32 v34, 0
    v_mov_b32 v35, 0
    v_mov_b32 v53, 0
    s_mov_b64 exec, s[58:59]
    v_mov_b32 v36, 0
    v_mov_b32 v37, 0
    v_mov_b32 v38, 0
    v_mov_b32 v39, 0
    v_mov_b32 v40, 0
    v_mov_b32 v41, 0
    v_mov_b32 v42, 0
    v_mov_b32 v43, 0
    v_mov_b32 v54, 0
    s_mov_b64 exec, s[56:57]
    v_mov_b32 v44, 0
    v_mov_b32 v45, 0
    v_mov_b32 v46, 0
    v_mov_b32 v47, 0
    v_mov_b32 v48, 0
    v_mov_b32 v49, 0
    v_mov_b32 v50, 0
    v_mov_b32 v51, 0
    v_mov_b32 v55, 0
    s_mov_b64 exec, -1
    v_lshlrev_b32 v56, 16, v20
    v_and_b32 v57, 0xffff0000, v20
    v_lshlrev_b32 v58, 16, v21
    v_and_b32 v59, 0xffff0000, v21
    v_lshlrev_b32 v60, 16, v22
    v_and_b32 v61, 0xffff0000, v22
    v_lshlrev_b32 v62, 16, v23
    v_and_b32 v63, 0xffff0000, v23
    v_and_b32 v52, v18, v52
    v_lshlrev_b32 v88, 16, v52
    v_and_b32 v89, 0xffff0000, v27
    v_lshlrev_b32 v90, 16, v27
    v_and_b32 v91, 0xffff0000, v26
    v_lshlrev_b32 v92, 16, v26
    v_and_b32 v93, 0xffff0000, v25
    v_lshlrev_b32 v94, 16, v25
    v_and_b32 v95, 0xffff0000, v24
    v_lshlrev_b32 v64, 16, v28
    v_and_b32 v65, 0xffff0000, v28
    v_lshlrev_b32 v66, 16, v29
    v_and_b32 v67, 0xffff0000, v29
    v_lshlrev_b32 v68, 16, v30
    v_and_b32 v69, 0xffff0000, v30
    v_lshlrev_b32 v70, 16, v31
    v_and_b32 v71, 0xffff0000, v31
    v_and_b32 v53, v18, v53
    v_lshlrev_b32 v96, 16, v53
    v_and_b32 v97, 0xffff0000, v35
    v_lshlrev_b32 v98, 16, v35
    v_and_b32 v99, 0xffff0000, v34
    v_lshlrev_b32 v100, 16, v34
    v_and_b32 v101, 0xffff0000, v33
    v_lshlrev_b32 v102, 16, v33
    v_and_b32 v103, 0xffff0000, v32
    v_lshlrev_b32 v72, 16, v36
    v_and_b32 v73, 0xffff0000, v36
    v_lshlrev_b32 v74, 16, v37
    v_and_b32 v75, 0xffff0000, v37
    v_lshlrev_b32 v76, 16, v38
    v_and_b32 v77, 0xffff0000, v38
    v_lshlrev_b32 v78, 16, v39
    v_and_b32 v79, 0xffff0000, v39
    v_and_b32 v54, v18, v54
    v_lshlrev_b32 v104, 16, v54
    v_and_b32 v105, 0xffff0000, v43
    v_lshlrev_b32 v106, 16, v43
    v_and_b32 v107, 0xffff0000, v42
    v_lshlrev_b32 v108, 16, v42
    v_and_b32 v109, 0xffff0000, v41
    v_lshlrev_b32 v110, 16, v41
    v_and_b32 v111, 0xffff0000, v40
    v_lshlrev_b32 v80, 16, v44
    v_and_b32 v81, 0xffff0000, v44
    v_lshlrev_b32 v82, 16, v45
    v_and_b32 v83, 0xffff0000, v45
    v_lshlrev_b32 v84, 16, v46
    v_and_b32 v85, 0xffff0000, v46
    v_lshlrev_b32 v86, 16, v47
    v_and_b32 v87, 0xffff0000, v47
    v_and_b32 v55, v18, v55
    v_lshlrev_b32 v112, 16, v55
    v_and_b32 v113, 0xffff0000, v51
    v_lshlrev_b32 v114, 16, v51
    v_and_b32 v115, 0xffff0000, v50
    v_lshlrev_b32 v116, 16, v50
    v_and_b32 v117, 0xffff0000, v49
    v_lshlrev_b32 v118, 16, v49
    v_and_b32 v119, 0xffff0000, v48
    v_pk_add_f32 v[120:121], v[56:57], v[88:89]
    v_pk_add_f32 v[88:89], v[56:57], v[88:89] neg_lo:[0,1] neg_hi:[0,1]
    v_pk_add_f32 v[122:123], v[58:59], v[90:91]
    v_pk_add_f32 v[90:91], v[58:59], v[90:91] neg_lo:[0,1] neg_hi:[0,1]
    v_pk_add_f32 v[124:125], v[60:61], v[92:93]
    v_pk_add_f32 v[92:93], v[60:61], v[92:93] neg_lo:[0,1] neg_hi:[0,1]
    v_pk_add_f32 v[126:127], v[62:63], v[94:95]
    v_pk_add_f32 v[94:95], v[62:63], v[94:95] neg_lo:[0,1] neg_hi:[0,1]
    v_pk_add_f32 v[128:129], v[64:65], v[96:97]
    v_pk_add_f32 v[96:97], v[64:65], v[96:97] neg_lo:[0,1] neg_hi:[0,1]
    v_pk_add_f32 v[130:131], v[66:67], v[98:99]
    v_pk_add_f32 v[98:99], v[66:67], v[98:99] neg_lo:[0,1] neg_hi:[0,1]
    v_pk_add_f32 v[132:133], v[68:69], v[100:101]
    v_pk_add_f32 v[100:101], v[68:69], v[100:101] neg_lo:[0,1] neg_hi:[0,1]
    v_pk_add_f32 v[134:135], v[70:71], v[102:103]
    v_pk_add_f32 v[102:103], v[70:71], v[102:103] neg_lo:[0,1] neg_hi:[0,1]
    v_pk_add_f32 v[136:137], v[72:73], v[104:105]
    v_pk_add_f32 v[104:105], v[72:73], v[104:105] neg_lo:[0,1] neg_hi:[0,1]
    v_pk_add_f32 v[138:139], v[74:75], v[106:107]
    v_pk_add_f32 v[106:107], v[74:75], v[106:107] neg_lo:[0,1] neg_hi:[0,1]
    v_pk_add_f32 v[140:141], v[76:77], v[108:109]
    v_pk_add_f32 v[108:109], v[76:77], v[108:109] neg_lo:[0,1] neg_hi:[0,1]
    v_pk_add_f32 v[142:143], v[78:79], v[110:111]
    v_pk_add_f32 v[110:111], v[78:79], v[110:111] neg_lo:[0,1] neg_hi:[0,1]
    v_pk_add_f32 v[144:145], v[80:81], v[112:113]
    v_pk_add_f32 v[112:113], v[80:81], v[112:113] neg_lo:[0,1] neg_hi:[0,1]
    v_pk_add_f32 v[146:147], v[82:83], v[114:115]
    v_pk_add_f32 v[114:115], v[82:83], v[114:115] neg_lo:[0,1] neg_hi:[0,1]
    v_pk_add_f32 v[148:149], v[84:85], v[116:117]
    v_pk_add_f32 v[116:117], v[84:85], v[116:117] neg_lo:[0,1] neg_hi:[0,1]
    v_pk_add_f32 v[150:151], v[86:87], v[118:119]
    v_pk_add_f32 v[118:119], v[86:87], v[118:119] neg_lo:[0,1] neg_hi:[0,1]
    v_pk_add_f32 v[56:57], v[120:121], v[128:129]
    v_pk_add_f32 v[64:65], v[136:137], v[144:145]
    v_pk_add_f32 v[72:73], v[88:89], v[96:97] neg_lo:[0,1] neg_hi:[0,1]
    v_pk_add_f32 v[80:81], v[104:105], v[112:113] neg_lo:[0,1] neg_hi:[0,1]
    v_pk_add_f32 v[120:121], v[56:57], v[64:65]
    v_pk_add_f32 v[128:129], v[56:57], v[64:65] neg_lo:[0,1] neg_hi:[0,1]
    v_pk_add_f32 v[136:137], v[72:73], v[80:81] neg_lo:[0,1] neg_hi:[0,1]
    v_pk_add_f32 v[144:145], v[72:73], v[80:81]
    v_pk_add_f32 v[58:59], v[122:123], v[130:131]
    v_pk_add_f32 v[66:67], v[138:139], v[146:147]
    v_pk_add_f32 v[74:75], v[90:91], v[98:99] neg_lo:[0,1] neg_hi:[0,1]
    v_pk_add_f32 v[82:83], v[106:107], v[114:115] neg_lo:[0,1] neg_hi:[0,1]
    v_pk_add_f32 v[122:123], v[58:59], v[66:67]
    v_pk_add_f32 v[130:131], v[58:59], v[66:67] neg_lo:[0,1] neg_hi:[0,1]
    v_pk_add_f32 v[138:139], v[74:75], v[82:83] neg_lo:[0,1] neg_hi:[0,1]
    v_pk_add_f32 v[146:147], v[74:75], v[82:83]
    v_pk_add_f32 v[60:61], v[124:125], v[132:133]
    v_pk_add_f32 v[68:69], v[140:141], v[148:149]
    v_pk_add_f32 v[76:77], v[92:93], v[100:101] neg_lo:[0,1] neg_hi:[0,1]
    v_pk_add_f32 v[84:85], v[108:109], v[116:117] neg_lo:[0,1] neg_hi:[0,1]
    v_pk_add_f32 v[124:125], v[60:61], v[68:69]
    v_pk_add_f32 v[132:133], v[60:61], v[68:69] neg_lo:[0,1] neg_hi:[0,1]
    v_pk_add_f32 v[140:141], v[76:77], v[84:85] neg_lo:[0,1] neg_hi:[0,1]
    v_pk_add_f32 v[148:149], v[76:77], v[84:85]
    v_pk_add_f32 v[62:63], v[126:127], v[134:135]
    v_pk_add_f32 v[70:71], v[142:143], v[150:151]
    v_pk_add_f32 v[78:79], v[94:95], v[102:103] neg_lo:[0,1] neg_hi:[0,1]
    v_pk_add_f32 v[86:87], v[110:111], v[118:119] neg_lo:[0,1] neg_hi:[0,1]
    v_pk_add_f32 v[126:127], v[62:63], v[70:71]
    v_pk_add_f32 v[134:135], v[62:63], v[70:71] neg_lo:[0,1] neg_hi:[0,1]
    v_pk_add_f32 v[142:143], v[78:79], v[86:87] neg_lo:[0,1] neg_hi:[0,1]
    v_pk_add_f32 v[150:151], v[78:79], v[86:87]
    v_cvt_pk_bf16_f32 v20, v120, v121
    v_cvt_pk_bf16_f32 v21, v122, v123
    v_cvt_pk_bf16_f32 v22, v124, v125
    v_cvt_pk_bf16_f32 v23, v126, v127
    v_cvt_pk_bf16_f32 v24, v128, v129
    v_cvt_pk_bf16_f32 v25, v130, v131
    v_cvt_pk_bf16_f32 v26, v132, v133
    v_cvt_pk_bf16_f32 v27, v134, v135
    v_cvt_pk_bf16_f32 v28, v136, v137
    v_cvt_pk_bf16_f32 v29, v138, v139
    v_cvt_pk_bf16_f32 v30, v140, v141
    v_cvt_pk_bf16_f32 v31, v142, v143
    v_cvt_pk_bf16_f32 v32, v144, v145
    v_cvt_pk_bf16_f32 v33, v146, v147
    v_cvt_pk_bf16_f32 v34, v148, v149
    v_cvt_pk_bf16_f32 v35, v150, v151
    v_and_b32 v144, v16, v20
    v_and_b32 v145, v17, v21
    v_and_b32 v146, v17, v22
    v_and_b32 v147, v17, v23
    v_and_b32 v148, v16, v24
    v_and_b32 v149, v17, v25
    v_and_b32 v150, v17, v26
    v_and_b32 v151, v17, v27
    v_and_b32 v152, v16, v28
    v_and_b32 v153, v17, v29
    v_and_b32 v154, v17, v30
    v_and_b32 v155, v17, v31
    v_and_b32 v156, v16, v32
    v_and_b32 v157, v17, v33
    v_and_b32 v158, v17, v34
    v_and_b32 v159, v17, v35
    v_mov_b32 v160, v19
    s_setprio 0
    s_mul_i32 s31, s11, 73728
    v_and_b32 v142, 31, v1
    v_lshrrev_b32 v143, 5, v1
    v_lshl_add_u32 v131, v1, 4, s31
    v_mul_u32_u24 v4, 288, v143
    v_lshl_add_u32 v4, v142, 4, v4
    v_add_u32 v132, s31, v4
    v_lshl_add_u32 v133, v142, 4, s31
    s_lshl_b32 s12, s11, 2
    v_add_u32 v134, s12, v3
    v_mov_b32 v130, 0xdddddddd
    v_cmp_eq_u32 vcc, 18, v142
    v_cmp_eq_u32 s[12:13], 20, v142
    s_nop 0
    s_or_b64 vcc, vcc, s[12:13]
    v_mov_b32 v4, 0x3f803f80
    v_cndmask_b32 v4, 0, v4, vcc
    v_mov_b32 v112, v4
    v_mov_b32 v113, v4
    v_mov_b32 v114, v4
    v_mov_b32 v115, v4
    v_mov_b32 v116, v4
    v_mov_b32 v117, v4
    v_mov_b32 v118, v4
    v_mov_b32 v119, v4
    v_mov_b32 v104, 0x3f80
    v_mov_b32 v105, 0x3f80
    v_mov_b32 v106, 0x3f80
    v_mov_b32 v107, 0x3f80
    v_mov_b32 v120, v4
    v_mov_b32 v121, v4
    v_mov_b32 v122, v4
    v_mov_b32 v123, v4
    v_mov_b32 v124, v4
    v_mov_b32 v125, v4
    v_mov_b32 v126, v4
    v_mov_b32 v127, v4
    v_mov_b32 v108, 0x3f80
    v_mov_b32 v109, 0x3f80
    v_mov_b32 v110, 0x3f80
    v_mov_b32 v111, 0x3f80
    v_cmp_gt_u32 s[36:37], 18, v142
    v_mov_b32 v48, 0
    v_mov_b32 v49, 0
    v_mov_b32 v50, 0
    v_mov_b32 v51, 0
    v_mov_b32 v52, 0
    v_mov_b32 v53, 0
    v_mov_b32 v54, 0
    v_mov_b32 v55, 0
    v_mov_b32 v56, 0
    v_mov_b32 v57, 0
    v_mov_b32 v58, 0
    v_mov_b32 v59, 0
    v_mov_b32 v60, 0
    v_mov_b32 v61, 0
    v_mov_b32 v62, 0
    v_mov_b32 v63, 0
    v_mov_b32 v88, 0
    v_mov_b32 v89, 0
    v_mov_b32 v90, 0
    v_mov_b32 v91, 0
    v_mov_b32 v64, 0
    v_mov_b32 v65, 0
    v_mov_b32 v66, 0
    v_mov_b32 v67, 0
    v_mov_b32 v68, 0
    v_mov_b32 v69, 0
    v_mov_b32 v70, 0
    v_mov_b32 v71, 0
    v_mov_b32 v72, 0
    v_mov_b32 v73, 0
    v_mov_b32 v74, 0
    v_mov_b32 v75, 0
    v_mov_b32 v76, 0
    v_mov_b32 v77, 0
    v_mov_b32 v78, 0
    v_mov_b32 v79, 0
    v_mov_b32 v92, 0
    v_mov_b32 v93, 0
    v_mov_b32 v94, 0
    v_mov_b32 v95, 0
    s_mul_i32 s12, s10, 36
    s_add_u32 s12, s12, 147456
    v_mul_u32_u24 v4, 168, v142
    v_add_u32 v135, s12, v4
    v_lshl_add_u32 v136, v143, 4, v135
    v_add_u32 v15, 5376, v136
    s_lshl_b32 s12, s10, 7
    s_add_u32 s12, s12, 162816
    v_and_b32 v14, 31, v1
    v_lshl_add_u32 v14, v14, 2, s12
    s_mul_i32 s12, s10, 6144
    s_add_u32 s12, s12, 0
    v_lshl_add_u32 v137, v1, 4, s12
    s_lshl_b32 s12, s10, 2
    v_add_u32 v138, s12, v3
    s_add_u32 s12, s12, 158272
    s_cmp_eq_u32 s11, 0
    s_cselect_b32 s12, 158360, s12
    v_mov_b32 v141, s12
    v_and_b32 v142, 15, v1
    v_bfe_u32 v4, v1, 4, 1
    v_mul_u32_u24 v4, 18432, v4
    v_lshl_add_u32 v139, v142, 4, v4
    v_lshl_add_u32 v140, v143, 8, v139
    s_mul_i32 s12, s4, 73728
    s_add_u32 s12, s12, 2031616
    s_lshl_b32 s13, s5, 11
    s_lshl_b32 s14, s10, 9
    s_add_u32 s13, s13, s14
    s_add_u32 s38, s12, s13
    s_lshl_b32 s13, s5, 8
    s_lshl_b32 s14, s10, 2
    s_add_u32 s13, s13, s14
    s_add_u32 s13, s13, 16384
    s_add_u32 s39, s12, s13
    v_mul_u32_u24 v4, 36864, v143
    v_add_u32 v139, v139, v4
    s_lshl_b32 s12, s11, 3
    v_add_u32 v4, s12, v3
    s_lshl_b32 s57, s96, 3
    s_add_u32 s58, s9, 1
    s_and_b32 s58, s58, 7
    s_lshl_b32 s58, s58, 1
    s_add_u32 s58, s58, s96
    s_add_u32 s59, s9, 2
    s_and_b32 s59, s59, 7
    s_lshl_b32 s59, s59, 1
    s_add_u32 s59, s59, s96
    s_mul_i32 s12, s58, 1536
    s_mul_i32 s13, s59, 1536
    s_sub_u32 s13, s13, 1536
    v_mov_b32 v12, s12
    v_mov_b32 v7, s13
    v_cmp_gt_u32 vcc, 12, v1
    s_nop 1
    v_cndmask_b32 v12, v7, v12, vcc
    v_lshl_add_u32 v12, v1, 7, v12
    v_add_u32 v12, 4096, v12
    s_mov_b32 s53, 0
    s_cmp_ge_u32 s53, 8
    s_cbranch_scc1 Lpg_114
    s_mov_b32 s15, 200000
Lpl_115:
    ds_read_b128 v[8:11], v3 offset:80
    s_waitcnt lgkmcnt(0)
    v_min3_u32 v8, v8, v9, v10
    v_min_u32 v8, v8, v11
    s_nop 0
    v_readfirstlane_b32 s53, v8
    s_nop 0
    s_cmp_ge_u32 s53, 8
    s_cbranch_scc1 Lpg_114
    s_sleep 2
    s_sub_u32 s15, s15, 1
    s_cbranch_scc0 Lpl_115
Lpg_114:
    s_mov_b32 s15, 20000
    s_mov_b64 exec, 0xffffff
Lpoll_116:
    buffer_load_dwordx2 v[8:9], v12, s[44:47], 0 offen sc1
    s_waitcnt vmcnt(0)
    v_cmp_ne_u64 vcc, s[6:7], v[8:9]
    s_cbranch_vccz Lpd_117
    s_sleep 2
    s_sub_u32 s15, s15, 1
    s_cbranch_scc0 Lpoll_116
Lpd_117:
    s_mov_b64 exec, -1
    s_mov_b32 s15, 200000
Lspin_118:
    ds_read_b32 v8, v3 offset:208
    s_waitcnt lgkmcnt(0)
    v_readfirstlane_b32 s14, v8
    s_nop 0
    s_cmp_ge_u32 s14, 2
    s_cbranch_scc1 Lsd_119
    s_sleep 0
    s_sub_u32 s15, s15, 1
    s_cbranch_scc0 Lspin_118
Lsd_119:
    s_add_u32 s12, s57, 1
    s_mul_i32 s57, s12, 9216
    v_lshlrev_b32 v5, 4, v1
    s_mul_i32 s12, s58, 9216
    s_add_u32 s12, s12, 458752
    s_mov_b32 s13, s57
    s_mov_b32 m0, s13
    s_nop 0
    buffer_load_dwordx4 v5, s[44:47], s12 offen offset:0 sc1 lds
    buffer_load_dwordx4 v5, s[44:47], s12 offen offset:1024 sc1 lds
    buffer_load_dwordx4 v5, s[44:47], s12 offen offset:2048 sc1 lds
    buffer_load_dwordx4 v5, s[44:47], s12 offen offset:3072 sc1 lds
    s_add_u32 s12, s12, 4096
    s_add_u32 s13, s13, 4096
    s_mov_b32 m0, s13
    s_nop 0
    buffer_load_dwordx4 v5, s[44:47], s12 offen offset:0 sc1 lds
    buffer_load_dwordx4 v5, s[44:47], s12 offen offset:1024 sc1 lds
    buffer_load_dwordx4 v5, s[44:47], s12 offen offset:2048 sc1 lds
    buffer_load_dwordx4 v5, s[44:47], s12 offen offset:3072 sc1 lds
    s_add_u32 s12, s12, 4096
    s_add_u32 s13, s13, 4096
    s_mov_b32 m0, s13
    s_nop 0
    buffer_load_dwordx4 v5, s[44:47], s12 offen offset:0 sc1 lds
    s_mov_b64 exec, s[60:61]
    s_cbranch_execz Lnofold
    s_mov_b32 s97, 2
    s_mov_b32 s12, 655360
    buffer_store_dwordx4 v[144:147], v160, s[44:47], s12 offen sc1
    s_mov_b32 s12, 986112
    buffer_store_dwordx4 v[148:151], v160, s[44:47], s12 offen sc1
    s_mov_b32 s12, 1316864
    buffer_store_dwordx4 v[152:155], v160, s[44:47], s12 offen sc1
    s_mov_b32 s12, 1647616
    buffer_store_dwordx4 v[156:159], v160, s[44:47], s12 offen sc1
Lnofold:
    s_mov_b64 exec, -1
Lattn:
    s_setprio 2
    s_barrier
    s_cmp_eq_u32 s11, 0
    s_cbranch_scc0 Lmget
    ds_read_b128 v[96:99], v131 offset:0
    s_mov_b32 exec_hi, 0
    ds_read_b128 v[104:107], v133 offset:8704
    ds_read_b32 v88, v135 offset:32
    ds_read_b32 v92, v135 offset:5408
    s_mov_b64 exec, -1
    ds_read2_b32 v[80:81], v136 offset0:0 offset1:1
    ds_read2_b32 v[82:83], v136 offset0:2 offset1:3
    ds_read2_b32 v[84:85], v15 offset0:0 offset1:1
    ds_read2_b32 v[86:87], v15 offset0:2 offset1:3
    s_mov_b64 exec, s[36:37]
    ds_read_b128 v[112:115], v132 offset:4096
    ds_read_b128 v[116:119], v132 offset:4672
    s_mov_b64 exec, -1
    ds_read_b128 v[100:103], v131 offset:1024
    ds_read_b64 v[10:11], v3 offset:136
    v_cmp_gt_u32 vcc, 32, v1
    s_waitcnt lgkmcnt(6)
    v_mfma_f32_32x32x16_bf16 v[16:31], v[96:99], v[80:83], 0
    v_mfma_f32_32x32x8_bf16 v[16:31], v[104:105], v[88:89], v[16:31]
    s_waitcnt lgkmcnt(4)
    v_mfma_f32_32x32x16_bf16 v[32:47], v[96:99], v[84:87], 0
    v_mfma_f32_32x32x8_bf16 v[32:47], v[104:105], v[92:93], v[32:47]
    s_nop 8
    v_max3_f32 v16, v16, v17, v18
    v_max3_f32 v19, v19, v20, v21
    v_max3_f32 v22, v22, v23, v24
    v_max3_f32 v25, v25, v26, v27
    v_max3_f32 v28, v28, v29, v30
    v_max3_f32 v16, v16, v19, v22
    v_max3_f32 v25, v25, v28, v31
    v_max_f32 v16, v16, v25
    v_mov_b32 v17, v16
    v_max3_f32 v32, v32, v33, v34
    v_max3_f32 v35, v35, v36, v37
    v_permlane32_swap_b32 v16, v17
    v_max_f32 v16, v16, v17
    v_sub_f32 v16, 0xc2cc0000, v16
    v_lshrrev_b32 v17, 16, v16
    v_cndmask_b32 v88, v17, v88, vcc
    v_and_b32 v128, 0xffff0000, v16
    v_mov_b32 v91, v88
    v_mfma_f32_32x32x16_bf16 v[16:31], v[96:99], v[80:83], 0
    v_mfma_f32_32x32x8_bf16 v[16:31], v[104:105], v[88:89], v[16:31]
    v_max3_f32 v38, v38, v39, v40
    v_max3_f32 v41, v41, v42, v43
    v_max3_f32 v44, v44, v45, v46
    v_max3_f32 v32, v32, v35, v38
    v_max3_f32 v41, v41, v44, v47
    v_max_f32 v32, v32, v41
    v_mov_b32 v33, v32
    s_nop 1
    v_permlane32_swap_b32 v32, v33
    v_max_f32 v32, v32, v33
    v_sub_f32 v32, 0xc2cc0000, v32
    v_lshrrev_b32 v33, 16, v32
    v_cndmask_b32 v92, v33, v92, vcc
    v_and_b32 v129, 0xffff0000, v32
    v_mov_b32 v95, v92
    s_waitcnt lgkmcnt(0)
    v_lshl_or_b32 v142, v33, 0, v128
    s_mov_b32 exec_hi, 0
    ds_write_b32 v14, v142
    s_mov_b64 exec, -1
Lloop:
    v_exp_f32 v16, v16
    v_exp_f32 v17, v17
    v_exp_f32 v18, v18
    v_exp_f32 v19, v19
    v_mfma_f32_32x32x16_bf16 v[32:47], v[96:99], v[84:87], 0
    v_exp_f32 v20, v20
    v_exp_f32 v21, v21
    v_exp_f32 v22, v22
    v_mfma_f32_32x32x8_bf16 v[32:47], v[104:105], v[92:93], v[32:47]
    v_exp_f32 v23, v23
    v_exp_f32 v24, v24
    v_exp_f32 v25, v25
    v_exp_f32 v26, v26
    v_smfmac_f32_32x32x32_bf16 v[48:63], v[112:115], v[16:23], v130
    v_exp_f32 v27, v27
    v_exp_f32 v28, v28
    s_mov_b64 exec, s[36:37]
    ds_read_b128 v[120:123], v132 offset:5248
    ds_read_b128 v[124:127], v132 offset:5824
    s_mov_b64 exec, -1
    s_waitcnt lgkmcnt(2)
    v_exp_f32 v29, v29
    v_exp_f32 v30, v30
    v_exp_f32 v31, v31
    v_exp_f32 v32, v32
    v_exp_f32 v33, v33
    v_smfmac_f32_32x32x32_bf16 v[48:63], v[116:119], v[24:31], v130
    v_exp_f32 v34, v34
    v_exp_f32 v35, v35
    v_mfma_f32_32x32x16_bf16 v[16:31], v[100:103], v[80:83], 0
    v_exp_f32 v36, v36
    v_exp_f32 v37, v37
    v_exp_f32 v38, v38
    v_mfma_f32_32x32x8_bf16 v[16:31], v[104:105], v[90:91], v[16:31]
    v_exp_f32 v39, v39
    v_exp_f32 v40, v40
    v_exp_f32 v41, v41
    v_exp_f32 v42, v42
    v_smfmac_f32_32x32x32_bf16 v[64:79], v[112:115], v[32:39], v130
    v_exp_f32 v43, v43
    v_exp_f32 v44, v44
    ds_read_b128 v[96:99], v131 offset:2048
    s_waitcnt lgkmcnt(1)
    v_exp_f32 v45, v45
    v_exp_f32 v46, v46
    v_exp_f32 v47, v47
    v_exp_f32 v16, v16
    v_exp_f32 v17, v17
    v_smfmac_f32_32x32x32_bf16 v[64:79], v[116:119], v[40:47], v130
    v_exp_f32 v18, v18
    v_exp_f32 v19, v19
    v_mfma_f32_32x32x16_bf16 v[32:47], v[100:103], v[84:87], 0
    v_exp_f32 v20, v20
    v_exp_f32 v21, v21
    v_exp_f32 v22, v22
    v_mfma_f32_32x32x8_bf16 v[32:47], v[104:105], v[94:95], v[32:47]
    v_exp_f32 v23, v23
    v_exp_f32 v24, v24
    v_exp_f32 v25, v25
    v_exp_f32 v26, v26
    v_smfmac_f32_32x32x32_bf16 v[48:63], v[120:123], v[16:23], v130
    v_exp_f32 v27, v27
    v_exp_f32 v28, v28
    s_mov_b64 exec, 1
    v_mov_b32 v142, 1
    ds_add_u32 v3, v142 offset:168
    s_mov_b64 exec, -1
    s_mov_b64 exec, s[36:37]
    ds_read_b128 v[112:115], v132 offset:6400
    ds_read_b128 v[116:119], v132 offset:6976
    s_mov_b64 exec, -1
    s_waitcnt lgkmcnt(2)
    v_exp_f32 v29, v29
    v_exp_f32 v30, v30
    v_exp_f32 v31, v31
    v_exp_f32 v32, v32
    v_exp_f32 v33, v33
    v_smfmac_f32_32x32x32_bf16 v[48:63], v[124:127], v[24:31], v130
    v_exp_f32 v34, v34
    v_exp_f32 v35, v35
    v_mfma_f32_32x32x16_bf16 v[16:31], v[96:99], v[80:83], 0
    v_exp_f32 v36, v36
    v_exp_f32 v37, v37
    v_exp_f32 v38, v38
    v_mfma_f32_32x32x8_bf16 v[16:31], v[106:107], v[88:89], v[16:31]
    v_exp_f32 v39, v39
    v_exp_f32 v40, v40
    v_exp_f32 v41, v41
    v_exp_f32 v42, v42
    v_smfmac_f32_32x32x32_bf16 v[64:79], v[120:123], v[32:39], v130
    v_exp_f32 v43, v43
    v_exp_f32 v44, v44
    ds_read_b128 v[100:103], v131 offset:3072
    s_waitcnt lgkmcnt(1)
    v_exp_f32 v45, v45
    v_exp_f32 v46, v46
    v_exp_f32 v47, v47
    v_exp_f32 v16, v16
    v_exp_f32 v17, v17
    v_smfmac_f32_32x32x32_bf16 v[64:79], v[124:127], v[40:47], v130
    v_exp_f32 v18, v18
    v_exp_f32 v19, v19
    v_mfma_f32_32x32x16_bf16 v[32:47], v[96:99], v[84:87], 0
    v_exp_f32 v20, v20
    v_exp_f32 v21, v21
    v_exp_f32 v22, v22
    v_mfma_f32_32x32x8_bf16 v[32:47], v[106:107], v[92:93], v[32:47]
    v_exp_f32 v23, v23
    v_exp_f32 v24, v24
    v_exp_f32 v25, v25
    v_exp_f32 v26, v26
    v_smfmac_f32_32x32x32_bf16 v[48:63], v[112:115], v[16:23], v130
    v_exp_f32 v27, v27
    v_exp_f32 v28, v28
    ds_read_b32 v143, v134 offset:224
    s_mov_b64 exec, s[36:37]
    ds_read_b128 v[120:123], v132 offset:7552
    ds_read_b128 v[124:127], v132 offset:8128
    s_mov_b64 exec, -1
    s_waitcnt lgkmcnt(2)
    v_exp_f32 v29, v29
    v_exp_f32 v30, v30
    v_exp_f32 v31, v31
    v_exp_f32 v32, v32
    v_exp_f32 v33, v33
    v_smfmac_f32_32x32x32_bf16 v[48:63], v[116:119], v[24:31], v130
    v_exp_f32 v34, v34
    v_exp_f32 v35, v35
    v_mfma_f32_32x32x16_bf16 v[16:31], v[100:103], v[80:83], 0
    v_exp_f32 v36, v36
    v_exp_f32 v37, v37
    v_exp_f32 v38, v38
    v_mfma_f32_32x32x8_bf16 v[16:31], v[106:107], v[90:91], v[16:31]
    v_exp_f32 v39, v39
    v_exp_f32 v40, v40
    v_exp_f32 v41, v41
    v_exp_f32 v42, v42
    v_smfmac_f32_32x32x32_bf16 v[64:79], v[112:115], v[32:39], v130
    v_exp_f32 v43, v43
    v_exp_f32 v44, v44
    v_readfirstlane_b32 s14, v143
    s_nop 0
    s_cmp_ge_u32 s14, 1
    s_cbranch_scc1 Lok_120
    s_mov_b32 s15, 200000
Lspin_121:
    ds_read_b32 v142, v134 offset:224
    s_waitcnt lgkmcnt(0)
    v_readfirstlane_b32 s14, v142
    s_nop 0
    s_cmp_ge_u32 s14, 1
    s_cbranch_scc1 Lsd_122
    s_sleep 1
    s_sub_u32 s15, s15, 1
    s_cbranch_scc0 Lspin_121
Lsd_122:
Lok_120:
    ds_read_b128 v[96:99], v131 offset:9216
    s_mov_b32 exec_hi, 0
    ds_read_b128 v[108:111], v133 offset:17920
    s_mov_b64 exec, -1
    s_waitcnt lgkmcnt(2)
    v_exp_f32 v45, v45
    v_exp_f32 v46, v46
    v_exp_f32 v47, v47
    v_exp_f32 v16, v16
    v_exp_f32 v17, v17
    v_smfmac_f32_32x32x32_bf16 v[64:79], v[116:119], v[40:47], v130
    v_exp_f32 v18, v18
    v_exp_f32 v19, v19
    v_mfma_f32_32x32x16_bf16 v[32:47], v[100:103], v[84:87], 0
    v_exp_f32 v20, v20
    v_exp_f32 v21, v21
    v_exp_f32 v22, v22
    v_mfma_f32_32x32x8_bf16 v[32:47], v[106:107], v[94:95], v[32:47]
    v_exp_f32 v23, v23
    v_exp_f32 v24, v24
    v_exp_f32 v25, v25
    v_exp_f32 v26, v26
    v_smfmac_f32_32x32x32_bf16 v[48:63], v[120:123], v[16:23], v130
    v_exp_f32 v27, v27
    v_exp_f32 v28, v28
    s_mov_b64 exec, s[36:37]
    ds_read_b128 v[112:115], v132 offset:13312
    ds_read_b128 v[116:119], v132 offset:13888
    s_mov_b64 exec, -1
    s_waitcnt lgkmcnt(2)
    v_exp_f32 v29, v29
    v_exp_f32 v30, v30
    v_exp_f32 v31, v31
    v_exp_f32 v32, v32
    v_exp_f32 v33, v33
    v_smfmac_f32_32x32x32_bf16 v[48:63], v[124:127], v[24:31], v130
    v_exp_f32 v34, v34
    v_exp_f32 v35, v35
    v_mfma_f32_32x32x16_bf16 v[16:31], v[96:99], v[80:83], 0
    v_exp_f32 v36, v36
    v_exp_f32 v37, v37
    v_exp_f32 v38, v38
    v_mfma_f32_32x32x8_bf16 v[16:31], v[108:109], v[88:89], v[16:31]
    v_exp_f32 v39, v39
    v_exp_f32 v40, v40
    v_exp_f32 v41, v41
    v_exp_f32 v42, v42
    v_smfmac_f32_32x32x32_bf16 v[64:79], v[120:123], v[32:39], v130
    v_exp_f32 v43, v43
    v_exp_f32 v44, v44
    ds_read_b128 v[100:103], v131 offset:10240
    s_waitcnt lgkmcnt(1)
    v_exp_f32 v45, v45
    v_exp_f32 v46, v46
    v_exp_f32 v47, v47
    v_exp_f32 v16, v16
    v_exp_f32 v17, v17
    v_smfmac_f32_32x32x32_bf16 v[64:79], v[124:127], v[40:47], v130
    v_exp_f32 v18, v18
    v_exp_f32 v19, v19
    v_mfma_f32_32x32x16_bf16 v[32:47], v[96:99], v[84:87], 0
    v_exp_f32 v20, v20
    v_exp_f32 v21, v21
    v_exp_f32 v22, v22
    v_mfma_f32_32x32x8_bf16 v[32:47], v[108:109], v[92:93], v[32:47]
    v_exp_f32 v23, v23
    v_exp_f32 v24, v24
    v_exp_f32 v25, v25
    v_exp_f32 v26, v26
    v_smfmac_f32_32x32x32_bf16 v[48:63], v[112:115], v[16:23], v130
    v_exp_f32 v27, v27
    v_exp_f32 v28, v28
    s_mov_b64 exec, s[36:37]
    ds_read_b128 v[120:123], v132 offset:14464
    ds_read_b128 v[124:127], v132 offset:15040
    s_mov_b64 exec, -1
    s_waitcnt lgkmcnt(2)
    v_exp_f32 v29, v29
    v_exp_f32 v30, v30
    v_exp_f32 v31, v31
    v_exp_f32 v32, v32
    v_exp_f32 v33, v33
    v_smfmac_f32_32x32x32_bf16 v[48:63], v[116:119], v[24:31], v130
    v_exp_f32 v34, v34
    v_exp_f32 v35, v35
    v_mfma_f32_32x32x16_bf16 v[16:31], v[100:103], v[80:83], 0
    v_exp_f32 v36, v36
    v_exp_f32 v37, v37
    v_exp_f32 v38, v38
    v_mfma_f32_32x32x8_bf16 v[16:31], v[108:109], v[90:91], v[16:31]
    v_exp_f32 v39, v39
    v_exp_f32 v40, v40
    v_exp_f32 v41, v41
    v_exp_f32 v42, v42
    v_smfmac_f32_32x32x32_bf16 v[64:79], v[112:115], v[32:39], v130
    v_exp_f32 v43, v43
    v_exp_f32 v44, v44
    ds_read_b128 v[96:99], v131 offset:11264
    s_waitcnt lgkmcnt(1)
    v_exp_f32 v45, v45
    v_exp_f32 v46, v46
    v_exp_f32 v47, v47
    v_exp_f32 v16, v16
    v_exp_f32 v17, v17
    v_smfmac_f32_32x32x32_bf16 v[64:79], v[116:119], v[40:47], v130
    v_exp_f32 v18, v18
    v_exp_f32 v19, v19
    v_mfma_f32_32x32x16_bf16 v[32:47], v[100:103], v[84:87], 0
    v_exp_f32 v20, v20
    v_exp_f32 v21, v21
    v_exp_f32 v22, v22
    v_mfma_f32_32x32x8_bf16 v[32:47], v[108:109], v[94:95], v[32:47]
    v_exp_f32 v23, v23
    v_exp_f32 v24, v24
    v_exp_f32 v25, v25
    v_exp_f32 v26, v26
    v_smfmac_f32_32x32x32_bf16 v[48:63], v[120:123], v[16:23], v130
    v_exp_f32 v27, v27
    v_exp_f32 v28, v28
    s_mov_b64 exec, s[36:37]
    ds_read_b128 v[112:115], v132 offset:15616
    ds_read_b128 v[116:119], v132 offset:16192
    s_mov_b64 exec, -1
    s_waitcnt lgkmcnt(2)
    v_exp_f32 v29, v29
    v_exp_f32 v30, v30
    v_exp_f32 v31, v31
    v_exp_f32 v32, v32
    v_exp_f32 v33, v33
    v_smfmac_f32_32x32x32_bf16 v[48:63], v[124:127], v[24:31], v130
    v_exp_f32 v34, v34
    v_exp_f32 v35, v35
    v_mfma_f32_32x32x16_bf16 v[16:31], v[96:99], v[80:83], 0
    v_exp_f32 v36, v36
    v_exp_f32 v37, v37
    v_exp_f32 v38, v38
    v_mfma_f32_32x32x8_bf16 v[16:31], v[110:111], v[88:89], v[16:31]
    v_exp_f32 v39, v39
    v_exp_f32 v40, v40
    v_exp_f32 v41, v41
    v_exp_f32 v42, v42
    v_smfmac_f32_32x32x32_bf16 v[64:79], v[120:123], v[32:39], v130
    v_exp_f32 v43, v43
    v_exp_f32 v44, v44
    ds_read_b128 v[100:103], v131 offset:12288
    s_waitcnt lgkmcnt(1)
    v_exp_f32 v45, v45
    v_exp_f32 v46, v46
    v_exp_f32 v47, v47
    v_exp_f32 v16, v16
    v_exp_f32 v17, v17
    v_smfmac_f32_32x32x32_bf16 v[64:79], v[124:127], v[40:47], v130
    v_exp_f32 v18, v18
    v_exp_f32 v19, v19
    v_mfma_f32_32x32x16_bf16 v[32:47], v[96:99], v[84:87], 0
    v_exp_f32 v20, v20
    v_exp_f32 v21, v21
    v_exp_f32 v22, v22
    v_mfma_f32_32x32x8_bf16 v[32:47], v[110:111], v[92:93], v[32:47]
    v_exp_f32 v23, v23
    v_exp_f32 v24, v24
    v_exp_f32 v25, v25
    v_exp_f32 v26, v26
    v_smfmac_f32_32x32x32_bf16 v[48:63], v[112:115], v[16:23], v130
    v_exp_f32 v27, v27
    v_exp_f32 v28, v28
    ds_read_b32 v143, v134 offset:212
    s_mov_b64 exec, s[36:37]
    ds_read_b128 v[120:123], v132 offset:16768
    ds_read_b128 v[124:127], v132 offset:17344
    s_mov_b64 exec, -1
    s_waitcnt lgkmcnt(2)
    v_exp_f32 v29, v29
    v_exp_f32 v30, v30
    v_exp_f32 v31, v31
    v_exp_f32 v32, v32
    v_exp_f32 v33, v33
    v_smfmac_f32_32x32x32_bf16 v[48:63], v[116:119], v[24:31], v130
    v_exp_f32 v34, v34
    v_exp_f32 v35, v35
    v_mfma_f32_32x32x16_bf16 v[16:31], v[100:103], v[80:83], 0
    v_exp_f32 v36, v36
    v_exp_f32 v37, v37
    v_exp_f32 v38, v38
    v_mfma_f32_32x32x8_bf16 v[16:31], v[110:111], v[90:91], v[16:31]
    v_exp_f32 v39, v39
    v_exp_f32 v40, v40
    v_exp_f32 v41, v41
    v_exp_f32 v42, v42
    v_smfmac_f32_32x32x32_bf16 v[64:79], v[112:115], v[32:39], v130
    v_exp_f32 v43, v43
    v_exp_f32 v44, v44
    v_readfirstlane_b32 s14, v143
    s_nop 0
    s_cmp_ge_u32 s14, 1
    s_cbranch_scc1 Lok_123
    s_mov_b32 s15, 200000
Lspin_124:
    ds_read_b32 v142, v134 offset:212
    s_waitcnt lgkmcnt(0)
    v_readfirstlane_b32 s14, v142
    s_nop 0
    s_cmp_ge_u32 s14, 1
    s_cbranch_scc1 Lsd_125
    s_sleep 1
    s_sub_u32 s15, s15, 1
    s_cbranch_scc0 Lspin_124
Lsd_125:
Lok_123:
    ds_read_b128 v[96:99], v131 offset:18432
    s_mov_b32 exec_hi, 0
    ds_read_b128 v[104:107], v133 offset:27136
    s_mov_b64 exec, -1
    s_waitcnt lgkmcnt(2)
    v_exp_f32 v45, v45
    v_exp_f32 v46, v46
    v_exp_f32 v47, v47
    v_exp_f32 v16, v16
    v_exp_f32 v17, v17
    v_smfmac_f32_32x32x32_bf16 v[64:79], v[116:119], v[40:47], v130
    v_exp_f32 v18, v18
    v_exp_f32 v19, v19
    v_mfma_f32_32x32x16_bf16 v[32:47], v[100:103], v[84:87], 0
    v_exp_f32 v20, v20
    v_exp_f32 v21, v21
    v_exp_f32 v22, v22
    v_mfma_f32_32x32x8_bf16 v[32:47], v[110:111], v[94:95], v[32:47]
    v_exp_f32 v23, v23
    v_exp_f32 v24, v24
    v_exp_f32 v25, v25
    v_exp_f32 v26, v26
    v_smfmac_f32_32x32x32_bf16 v[48:63], v[120:123], v[16:23], v130
    v_exp_f32 v27, v27
    v_exp_f32 v28, v28
    s_mov_b64 exec, s[36:37]
    ds_read_b128 v[112:115], v132 offset:22528
    ds_read_b128 v[116:119], v132 offset:23104
    s_mov_b64 exec, -1
    s_waitcnt lgkmcnt(2)
    v_exp_f32 v29, v29
    v_exp_f32 v30, v30
    v_exp_f32 v31, v31
    v_exp_f32 v32, v32
    v_exp_f32 v33, v33
    v_smfmac_f32_32x32x32_bf16 v[48:63], v[124:127], v[24:31], v130
    v_exp_f32 v34, v34
    v_exp_f32 v35, v35
    v_mfma_f32_32x32x16_bf16 v[16:31], v[96:99], v[80:83], 0
    v_exp_f32 v36, v36
    v_exp_f32 v37, v37
    v_exp_f32 v38, v38
    v_mfma_f32_32x32x8_bf16 v[16:31], v[104:105], v[88:89], v[16:31]
    v_exp_f32 v39, v39
    v_exp_f32 v40, v40
    v_exp_f32 v41, v41
    v_exp_f32 v42, v42
    v_smfmac_f32_32x32x32_bf16 v[64:79], v[120:123], v[32:39], v130
    v_exp_f32 v43, v43
    v_exp_f32 v44, v44
    ds_read_b128 v[100:103], v131 offset:19456
    s_waitcnt lgkmcnt(1)
    v_exp_f32 v45, v45
    v_exp_f32 v46, v46
    v_exp_f32 v47, v47
    v_exp_f32 v16, v16
    v_exp_f32 v17, v17
    v_smfmac_f32_32x32x32_bf16 v[64:79], v[124:127], v[40:47], v130
    v_exp_f32 v18, v18
    v_exp_f32 v19, v19
    v_mfma_f32_32x32x16_bf16 v[32:47], v[96:99], v[84:87], 0
    v_exp_f32 v20, v20
    v_exp_f32 v21, v21
    v_exp_f32 v22, v22
    v_mfma_f32_32x32x8_bf16 v[32:47], v[104:105], v[92:93], v[32:47]
    v_exp_f32 v23, v23
    v_exp_f32 v24, v24
    v_exp_f32 v25, v25
    v_exp_f32 v26, v26
    v_smfmac_f32_32x32x32_bf16 v[48:63], v[112:115], v[16:23], v130
    v_exp_f32 v27, v27
    v_exp_f32 v28, v28
    s_mov_b64 exec, s[36:37]
    ds_read_b128 v[120:123], v132 offset:23680
    ds_read_b128 v[124:127], v132 offset:24256
    s_mov_b64 exec, -1
    s_waitcnt lgkmcnt(2)
    v_exp_f32 v29, v29
    v_exp_f32 v30, v30
    v_exp_f32 v31, v31
    v_exp_f32 v32, v32
    v_exp_f32 v33, v33
    v_smfmac_f32_32x32x32_bf16 v[48:63], v[116:119], v[24:31], v130
    v_exp_f32 v34, v34
    v_exp_f32 v35, v35
    v_mfma_f32_32x32x16_bf16 v[16:31], v[100:103], v[80:83], 0
    v_exp_f32 v36, v36
    v_exp_f32 v37, v37
    v_exp_f32 v38, v38
    v_mfma_f32_32x32x8_bf16 v[16:31], v[104:105], v[90:91], v[16:31]
    v_exp_f32 v39, v39
    v_exp_f32 v40, v40
    v_exp_f32 v41, v41
    v_exp_f32 v42, v42
    v_smfmac_f32_32x32x32_bf16 v[64:79], v[112:115], v[32:39], v130
    v_exp_f32 v43, v43
    v_exp_f32 v44, v44
    ds_read_b128 v[96:99], v131 offset:20480
    s_waitcnt lgkmcnt(1)
    v_exp_f32 v45, v45
    v_exp_f32 v46, v46
    v_exp_f32 v47, v47
    v_exp_f32 v16, v16
    v_exp_f32 v17, v17
    v_smfmac_f32_32x32x32_bf16 v[64:79], v[116:119], v[40:47], v130
    v_exp_f32 v18, v18
    v_exp_f32 v19, v19
    v_mfma_f32_32x32x16_bf16 v[32:47], v[100:103], v[84:87], 0
    v_exp_f32 v20, v20
    v_exp_f32 v21, v21
    v_exp_f32 v22, v22
    v_mfma_f32_32x32x8_bf16 v[32:47], v[104:105], v[94:95], v[32:47]
    v_exp_f32 v23, v23
    v_exp_f32 v24, v24
    v_exp_f32 v25, v25
    v_exp_f32 v26, v26
    v_smfmac_f32_32x32x32_bf16 v[48:63], v[120:123], v[16:23], v130
    v_exp_f32 v27, v27
    v_exp_f32 v28, v28
    s_mov_b64 exec, s[36:37]
    ds_read_b128 v[112:115], v132 offset:24832
    ds_read_b128 v[116:119], v132 offset:25408
    s_mov_b64 exec, -1
    s_waitcnt lgkmcnt(2)
    v_exp_f32 v29, v29
    v_exp_f32 v30, v30
    v_exp_f32 v31, v31
    v_exp_f32 v32, v32
    v_exp_f32 v33, v33
    v_smfmac_f32_32x32x32_bf16 v[48:63], v[124:127], v[24:31], v130
    v_exp_f32 v34, v34
    v_exp_f32 v35, v35
    v_mfma_f32_32x32x16_bf16 v[16:31], v[96:99], v[80:83], 0
    v_exp_f32 v36, v36
    v_exp_f32 v37, v37
    v_exp_f32 v38, v38
    v_mfma_f32_32x32x8_bf16 v[16:31], v[106:107], v[88:89], v[16:31]
    v_exp_f32 v39, v39
    v_exp_f32 v40, v40
    v_exp_f32 v41, v41
    v_exp_f32 v42, v42
    v_smfmac_f32_32x32x32_bf16 v[64:79], v[120:123], v[32:39], v130
    v_exp_f32 v43, v43
    v_exp_f32 v44, v44
    ds_read_b128 v[100:103], v131 offset:21504
    s_waitcnt lgkmcnt(1)
    v_exp_f32 v45, v45
    v_exp_f32 v46, v46
    v_exp_f32 v47, v47
    v_exp_f32 v16, v16
    v_exp_f32 v17, v17
    v_smfmac_f32_32x32x32_bf16 v[64:79], v[124:127], v[40:47], v130
    v_exp_f32 v18, v18
    v_exp_f32 v19, v19
    v_mfma_f32_32x32x16_bf16 v[32:47], v[96:99], v[84:87], 0
    v_exp_f32 v20, v20
    v_exp_f32 v21, v21
    v_exp_f32 v22, v22
    v_mfma_f32_32x32x8_bf16 v[32:47], v[106:107], v[92:93], v[32:47]
    v_exp_f32 v23, v23
    v_exp_f32 v24, v24
    v_exp_f32 v25, v25
    v_exp_f32 v26, v26
    v_smfmac_f32_32x32x32_bf16 v[48:63], v[112:115], v[16:23], v130
    v_exp_f32 v27, v27
    v_exp_f32 v28, v28
    ds_read_b32 v143, v134 offset:152
    s_mov_b64 exec, s[36:37]
    ds_read_b128 v[120:123], v132 offset:25984
    ds_read_b128 v[124:127], v132 offset:26560
    s_mov_b64 exec, -1
    s_waitcnt lgkmcnt(2)
    v_exp_f32 v29, v29
    v_exp_f32 v30, v30
    v_exp_f32 v31, v31
    v_exp_f32 v32, v32
    v_exp_f32 v33, v33
    v_smfmac_f32_32x32x32_bf16 v[48:63], v[116:119], v[24:31], v130
    v_exp_f32 v34, v34
    v_exp_f32 v35, v35
    v_mfma_f32_32x32x16_bf16 v[16:31], v[100:103], v[80:83], 0
    v_exp_f32 v36, v36
    v_exp_f32 v37, v37
    v_exp_f32 v38, v38
    v_mfma_f32_32x32x8_bf16 v[16:31], v[106:107], v[90:91], v[16:31]
    v_exp_f32 v39, v39
    v_exp_f32 v40, v40
    v_exp_f32 v41, v41
    v_exp_f32 v42, v42
    v_smfmac_f32_32x32x32_bf16 v[64:79], v[112:115], v[32:39], v130
    v_exp_f32 v43, v43
    v_exp_f32 v44, v44
    v_readfirstlane_b32 s14, v143
    s_nop 0
    s_cmp_ge_u32 s14, 4
    s_cbranch_scc1 Lok_126
    s_mov_b32 s15, 200000
Lspin_127:
    ds_read_b32 v142, v134 offset:152
    s_waitcnt lgkmcnt(0)
    v_readfirstlane_b32 s14, v142
    s_nop 0
    s_cmp_ge_u32 s14, 4
    s_cbranch_scc1 Lsd_128
    s_sleep 1
    s_sub_u32 s15, s15, 1
    s_cbranch_scc0 Lspin_127
Lsd_128:
Lok_126:
    ds_read_b128 v[96:99], v131 offset:27648
    s_mov_b32 exec_hi, 0
    ds_read_b128 v[108:111], v133 offset:36352
    s_mov_b64 exec, -1
    s_waitcnt lgkmcnt(2)
    v_exp_f32 v45, v45
    v_exp_f32 v46, v46
    v_exp_f32 v47, v47
    v_exp_f32 v16, v16
    v_exp_f32 v17, v17
    v_smfmac_f32_32x32x32_bf16 v[64:79], v[116:119], v[40:47], v130
    v_exp_f32 v18, v18
    v_exp_f32 v19, v19
    v_mfma_f32_32x32x16_bf16 v[32:47], v[100:103], v[84:87], 0
    v_exp_f32 v20, v20
    v_exp_f32 v21, v21
    v_exp_f32 v22, v22
    v_mfma_f32_32x32x8_bf16 v[32:47], v[106:107], v[94:95], v[32:47]
    v_exp_f32 v23, v23
    v_exp_f32 v24, v24
    v_exp_f32 v25, v25
    v_exp_f32 v26, v26
    v_smfmac_f32_32x32x32_bf16 v[48:63], v[120:123], v[16:23], v130
    v_exp_f32 v27, v27
    v_exp_f32 v28, v28
    s_mov_b64 exec, 1
    v_mov_b32 v142, 1
    ds_add_u32 v134, v142 offset:24
    s_mov_b64 exec, -1
    s_mov_b64 exec, s[36:37]
    ds_read_b128 v[112:115], v132 offset:31744
    ds_read_b128 v[116:119], v132 offset:32320
    s_mov_b64 exec, -1
    s_waitcnt lgkmcnt(2)
    v_exp_f32 v29, v29
    v_exp_f32 v30, v30
    v_exp_f32 v31, v31
    v_exp_f32 v32, v32
    v_exp_f32 v33, v33
    v_smfmac_f32_32x32x32_bf16 v[48:63], v[124:127], v[24:31], v130
    v_exp_f32 v34, v34
    v_exp_f32 v35, v35
    v_mfma_f32_32x32x16_bf16 v[16:31], v[96:99], v[80:83], 0
    v_exp_f32 v36, v36
    v_exp_f32 v37, v37
    v_exp_f32 v38, v38
    v_mfma_f32_32x32x8_bf16 v[16:31], v[108:109], v[88:89], v[16:31]
    v_exp_f32 v39, v39
    v_exp_f32 v40, v40
    v_exp_f32 v41, v41
    v_exp_f32 v42, v42
    v_smfmac_f32_32x32x32_bf16 v[64:79], v[120:123], v[32:39], v130
    v_exp_f32 v43, v43
    v_exp_f32 v44, v44
    ds_read_b128 v[100:103], v131 offset:28672
    s_waitcnt lgkmcnt(1)
    v_exp_f32 v45, v45
    v_exp_f32 v46, v46
    v_exp_f32 v47, v47
    v_exp_f32 v16, v16
    v_exp_f32 v17, v17
    v_smfmac_f32_32x32x32_bf16 v[64:79], v[124:127], v[40:47], v130
    v_exp_f32 v18, v18
    v_exp_f32 v19, v19
    v_mfma_f32_32x32x16_bf16 v[32:47], v[96:99], v[84:87], 0
    v_exp_f32 v20, v20
    v_exp_f32 v21, v21
    v_exp_f32 v22, v22
    v_mfma_f32_32x32x8_bf16 v[32:47], v[108:109], v[92:93], v[32:47]
    v_exp_f32 v23, v23
    v_exp_f32 v24, v24
    v_exp_f32 v25, v25
    v_exp_f32 v26, v26
    v_smfmac_f32_32x32x32_bf16 v[48:63], v[112:115], v[16:23], v130
    v_exp_f32 v27, v27
    v_exp_f32 v28, v28
    s_mov_b64 exec, s[36:37]
    ds_read_b128 v[120:123], v132 offset:32896
    ds_read_b128 v[124:127], v132 offset:33472
    s_mov_b64 exec, -1
    s_waitcnt lgkmcnt(2)
    v_exp_f32 v29, v29
    v_exp_f32 v30, v30
    v_exp_f32 v31, v31
    v_exp_f32 v32, v32
    v_exp_f32 v33, v33
    v_smfmac_f32_32x32x32_bf16 v[48:63], v[116:119], v[24:31], v130
    v_exp_f32 v34, v34
    v_exp_f32 v35, v35
    v_mfma_f32_32x32x16_bf16 v[16:31], v[100:103], v[80:83], 0
    v_exp_f32 v36, v36
    v_exp_f32 v37, v37
    v_exp_f32 v38, v38
    v_mfma_f32_32x32x8_bf16 v[16:31], v[108:109], v[90:91], v[16:31]
    v_exp_f32 v39, v39
    v_exp_f32 v40, v40
    v_exp_f32 v41, v41
    v_exp_f32 v42, v42
    v_smfmac_f32_32x32x32_bf16 v[64:79], v[112:115], v[32:39], v130
    v_exp_f32 v43, v43
    v_exp_f32 v44, v44
    ds_read_b128 v[96:99], v131 offset:29696
    s_waitcnt lgkmcnt(1)
    v_exp_f32 v45, v45
    v_exp_f32 v46, v46
    v_exp_f32 v47, v47
    v_exp_f32 v16, v16
    v_exp_f32 v17, v17
    v_smfmac_f32_32x32x32_bf16 v[64:79], v[116:119], v[40:47], v130
    v_exp_f32 v18, v18
    v_exp_f32 v19, v19
    v_mfma_f32_32x32x16_bf16 v[32:47], v[100:103], v[84:87], 0
    v_exp_f32 v20, v20
    v_exp_f32 v21, v21
    v_exp_f32 v22, v22
    v_mfma_f32_32x32x8_bf16 v[32:47], v[108:109], v[94:95], v[32:47]
    v_exp_f32 v23, v23
    v_exp_f32 v24, v24
    v_exp_f32 v25, v25
    v_exp_f32 v26, v26
    v_smfmac_f32_32x32x32_bf16 v[48:63], v[120:123], v[16:23], v130
    v_exp_f32 v27, v27
    v_exp_f32 v28, v28
    s_mov_b64 exec, s[36:37]
    ds_read_b128 v[112:115], v132 offset:34048
    ds_read_b128 v[116:119], v132 offset:34624
    s_mov_b64 exec, -1
    s_waitcnt lgkmcnt(2)
    v_exp_f32 v29, v29
    v_exp_f32 v30, v30
    v_exp_f32 v31, v31
    v_exp_f32 v32, v32
    v_exp_f32 v33, v33
    v_smfmac_f32_32x32x32_bf16 v[48:63], v[124:127], v[24:31], v130
    v_exp_f32 v34, v34
    v_exp_f32 v35, v35
    v_mfma_f32_32x32x16_bf16 v[16:31], v[96:99], v[80:83], 0
    v_exp_f32 v36, v36
    v_exp_f32 v37, v37
    v_exp_f32 v38, v38
    v_mfma_f32_32x32x8_bf16 v[16:31], v[110:111], v[88:89], v[16:31]
    v_exp_f32 v39, v39
    v_exp_f32 v40, v40
    v_exp_f32 v41, v41
    v_exp_f32 v42, v42
    v_smfmac_f32_32x32x32_bf16 v[64:79], v[120:123], v[32:39], v130
    v_exp_f32 v43, v43
    v_exp_f32 v44, v44
    ds_read_b128 v[100:103], v131 offset:30720
    s_waitcnt lgkmcnt(1)
    v_exp_f32 v45, v45
    v_exp_f32 v46, v46
    v_exp_f32 v47, v47
    v_exp_f32 v16, v16
    v_exp_f32 v17, v17
    v_smfmac_f32_32x32x32_bf16 v[64:79], v[124:127], v[40:47], v130
    v_exp_f32 v18, v18
    v_exp_f32 v19, v19
    v_mfma_f32_32x32x16_bf16 v[32:47], v[96:99], v[84:87], 0
    v_exp_f32 v20, v20
    v_exp_f32 v21, v21
    v_exp_f32 v22, v22
    v_mfma_f32_32x32x8_bf16 v[32:47], v[110:111], v[92:93], v[32:47]
    v_exp_f32 v23, v23
    v_exp_f32 v24, v24
    v_exp_f32 v25, v25
    v_exp_f32 v26, v26
    v_smfmac_f32_32x32x32_bf16 v[48:63], v[112:115], v[16:23], v130
    v_exp_f32 v27, v27
    v_exp_f32 v28, v28
    s_mov_b64 exec, s[36:37]
    ds_read_b128 v[120:123], v132 offset:35200
    ds_read_b128 v[124:127], v132 offset:35776
    s_mov_b64 exec, -1
    s_waitcnt lgkmcnt(2)
    v_exp_f32 v29, v29
    v_exp_f32 v30, v30
    v_exp_f32 v31, v31
    v_exp_f32 v32, v32
    v_exp_f32 v33, v33
    v_smfmac_f32_32x32x32_bf16 v[48:63], v[116:119], v[24:31], v130
    v_exp_f32 v34, v34
    v_exp_f32 v35, v35
    v_mfma_f32_32x32x16_bf16 v[16:31], v[100:103], v[80:83], 0
    v_exp_f32 v36, v36
    v_exp_f32 v37, v37
    v_exp_f32 v38, v38
    v_mfma_f32_32x32x8_bf16 v[16:31], v[110:111], v[90:91], v[16:31]
    v_exp_f32 v39, v39
    v_exp_f32 v40, v40
    v_exp_f32 v41, v41
    v_exp_f32 v42, v42
    v_smfmac_f32_32x32x32_bf16 v[64:79], v[112:115], v[32:39], v130
    v_exp_f32 v43, v43
    v_exp_f32 v44, v44
    ds_read_b128 v[96:99], v131 offset:36864
    s_mov_b32 exec_hi, 0
    ds_read_b128 v[104:107], v133 offset:45568
    s_mov_b64 exec, -1
    s_waitcnt lgkmcnt(2)
    v_exp_f32 v45, v45
    v_exp_f32 v46, v46
    v_exp_f32 v47, v47
    v_exp_f32 v16, v16
    v_exp_f32 v17, v17
    v_smfmac_f32_32x32x32_bf16 v[64:79], v[116:119], v[40:47], v130
    v_exp_f32 v18, v18
    v_exp_f32 v19, v19
    v_mfma_f32_32x32x16_bf16 v[32:47], v[100:103], v[84:87], 0
    v_exp_f32 v20, v20
    v_exp_f32 v21, v21
    v_exp_f32 v22, v22
    v_mfma_f32_32x32x8_bf16 v[32:47], v[110:111], v[94:95], v[32:47]
    v_exp_f32 v23, v23
    v_exp_f32 v24, v24
    v_exp_f32 v25, v25
    v_exp_f32 v26, v26
    v_smfmac_f32_32x32x32_bf16 v[48:63], v[120:123], v[16:23], v130
    v_exp_f32 v27, v27
    v_exp_f32 v28, v28
    s_mov_b64 exec, s[36:37]
    ds_read_b128 v[112:115], v132 offset:40960
    ds_read_b128 v[116:119], v132 offset:41536
    s_mov_b64 exec, -1
    s_waitcnt lgkmcnt(2)
    v_exp_f32 v29, v29
    v_exp_f32 v30, v30
    v_exp_f32 v31, v31
    v_exp_f32 v32, v32
    v_exp_f32 v33, v33
    v_smfmac_f32_32x32x32_bf16 v[48:63], v[124:127], v[24:31], v130
    v_exp_f32 v34, v34
    v_exp_f32 v35, v35
    v_mfma_f32_32x32x16_bf16 v[16:31], v[96:99], v[80:83], 0
    v_exp_f32 v36, v36
    v_exp_f32 v37, v37
    v_exp_f32 v38, v38
    v_mfma_f32_32x32x8_bf16 v[16:31], v[104:105], v[88:89], v[16:31]
    v_exp_f32 v39, v39
    v_exp_f32 v40, v40
    v_exp_f32 v41, v41
    v_exp_f32 v42, v42
    v_smfmac_f32_32x32x32_bf16 v[64:79], v[120:123], v[32:39], v130
    v_exp_f32 v43, v43
    v_exp_f32 v44, v44
    ds_read_b128 v[100:103], v131 offset:37888
    s_waitcnt lgkmcnt(1)
    v_exp_f32 v45, v45
    v_exp_f32 v46, v46
    v_exp_f32 v47, v47
    v_exp_f32 v16, v16
    v_exp_f32 v17, v17
    v_smfmac_f32_32x32x32_bf16 v[64:79], v[124:127], v[40:47], v130
    v_exp_f32 v18, v18
    v_exp_f32 v19, v19
    v_mfma_f32_32x32x16_bf16 v[32:47], v[96:99], v[84:87], 0
    v_exp_f32 v20, v20
    v_exp_f32 v21, v21
    v_exp_f32 v22, v22
    v_mfma_f32_32x32x8_bf16 v[32:47], v[104:105], v[92:93], v[32:47]
    v_exp_f32 v23, v23
    v_exp_f32 v24, v24
    v_exp_f32 v25, v25
    v_exp_f32 v26, v26
    v_smfmac_f32_32x32x32_bf16 v[48:63], v[112:115], v[16:23], v130
    v_exp_f32 v27, v27
    v_exp_f32 v28, v28
    s_mov_b64 exec, s[36:37]
    ds_read_b128 v[120:123], v132 offset:42112
    ds_read_b128 v[124:127], v132 offset:42688
    s_mov_b64 exec, -1
    s_waitcnt lgkmcnt(2)
    v_exp_f32 v29, v29
    v_exp_f32 v30, v30
    v_exp_f32 v31, v31
    v_exp_f32 v32, v32
    v_exp_f32 v33, v33
    v_smfmac_f32_32x32x32_bf16 v[48:63], v[116:119], v[24:31], v130
    v_exp_f32 v34, v34
    v_exp_f32 v35, v35
    v_mfma_f32_32x32x16_bf16 v[16:31], v[100:103], v[80:83], 0
    v_exp_f32 v36, v36
    v_exp_f32 v37, v37
    v_exp_f32 v38, v38
    v_mfma_f32_32x32x8_bf16 v[16:31], v[104:105], v[90:91], v[16:31]
    v_exp_f32 v39, v39
    v_exp_f32 v40, v40
    v_exp_f32 v41, v41
    v_exp_f32 v42, v42
    v_smfmac_f32_32x32x32_bf16 v[64:79], v[112:115], v[32:39], v130
    v_exp_f32 v43, v43
    v_exp_f32 v44, v44
    ds_read_b128 v[96:99], v131 offset:38912
    s_waitcnt lgkmcnt(1)
    v_exp_f32 v45, v45
    v_exp_f32 v46, v46
    v_exp_f32 v47, v47
    v_exp_f32 v16, v16
    v_exp_f32 v17, v17
    v_smfmac_f32_32x32x32_bf16 v[64:79], v[116:119], v[40:47], v130
    v_exp_f32 v18, v18
    v_exp_f32 v19, v19
    v_mfma_f32_32x32x16_bf16 v[32:47], v[100:103], v[84:87], 0
    v_exp_f32 v20, v20
    v_exp_f32 v21, v21
    v_exp_f32 v22, v22
    v_mfma_f32_32x32x8_bf16 v[32:47], v[104:105], v[94:95], v[32:47]
    v_exp_f32 v23, v23
    v_exp_f32 v24, v24
    v_exp_f32 v25, v25
    v_exp_f32 v26, v26
    v_smfmac_f32_32x32x32_bf16 v[48:63], v[120:123], v[16:23], v130
    v_exp_f32 v27, v27
    v_exp_f32 v28, v28
    s_mov_b64 exec, s[36:37]
    ds_read_b128 v[112:115], v132 offset:43264
    ds_read_b128 v[116:119], v132 offset:43840
    s_mov_b64 exec, -1
    s_waitcnt lgkmcnt(2)
    v_exp_f32 v29, v29
    v_exp_f32 v30, v30
    v_exp_f32 v31, v31
    v_exp_f32 v32, v32
    v_exp_f32 v33, v33
    v_smfmac_f32_32x32x32_bf16 v[48:63], v[124:127], v[24:31], v130
    v_exp_f32 v34, v34
    v_exp_f32 v35, v35
    v_mfma_f32_32x32x16_bf16 v[16:31], v[96:99], v[80:83], 0
    v_exp_f32 v36, v36
    v_exp_f32 v37, v37
    v_exp_f32 v38, v38
    v_mfma_f32_32x32x8_bf16 v[16:31], v[106:107], v[88:89], v[16:31]
    v_exp_f32 v39, v39
    v_exp_f32 v40, v40
    v_exp_f32 v41, v41
    v_exp_f32 v42, v42
    v_smfmac_f32_32x32x32_bf16 v[64:79], v[120:123], v[32:39], v130
    v_exp_f32 v43, v43
    v_exp_f32 v44, v44
    ds_read_b128 v[100:103], v131 offset:39936
    s_waitcnt lgkmcnt(1)
    v_exp_f32 v45, v45
    v_exp_f32 v46, v46
    v_exp_f32 v47, v47
    v_exp_f32 v16, v16
    v_exp_f32 v17, v17
    v_smfmac_f32_32x32x32_bf16 v[64:79], v[124:127], v[40:47], v130
    v_exp_f32 v18, v18
    v_exp_f32 v19, v19
    v_mfma_f32_32x32x16_bf16 v[32:47], v[96:99], v[84:87], 0
    v_exp_f32 v20, v20
    v_exp_f32 v21, v21
    v_exp_f32 v22, v22
    v_mfma_f32_32x32x8_bf16 v[32:47], v[106:107], v[92:93], v[32:47]
    v_exp_f32 v23, v23
    v_exp_f32 v24, v24
    v_exp_f32 v25, v25
    v_exp_f32 v26, v26
    v_smfmac_f32_32x32x32_bf16 v[48:63], v[112:115], v[16:23], v130
    v_exp_f32 v27, v27
    v_exp_f32 v28, v28
    ds_read_b32 v143, v4 offset:152
    s_mov_b64 exec, s[36:37]
    ds_read_b128 v[120:123], v132 offset:44416
    ds_read_b128 v[124:127], v132 offset:44992
    s_mov_b64 exec, -1
    s_waitcnt lgkmcnt(2)
    v_exp_f32 v29, v29
    v_exp_f32 v30, v30
    v_exp_f32 v31, v31
    v_exp_f32 v32, v32
    v_exp_f32 v33, v33
    v_smfmac_f32_32x32x32_bf16 v[48:63], v[116:119], v[24:31], v130
    v_exp_f32 v34, v34
    v_exp_f32 v35, v35
    v_mfma_f32_32x32x16_bf16 v[16:31], v[100:103], v[80:83], 0
    v_exp_f32 v36, v36
    v_exp_f32 v37, v37
    v_exp_f32 v38, v38
    v_mfma_f32_32x32x8_bf16 v[16:31], v[106:107], v[90:91], v[16:31]
    v_exp_f32 v39, v39
    v_exp_f32 v40, v40
    v_exp_f32 v41, v41
    v_exp_f32 v42, v42
    v_smfmac_f32_32x32x32_bf16 v[64:79], v[112:115], v[32:39], v130
    v_exp_f32 v43, v43
    v_exp_f32 v44, v44
    v_readfirstlane_b32 s14, v143
    s_nop 0
    s_cmp_ge_u32 s14, 4
    s_cbranch_scc1 Lok_129
    s_mov_b32 s15, 200000
Lspin_130:
    ds_read_b32 v142, v4 offset:152
    s_waitcnt lgkmcnt(0)
    v_readfirstlane_b32 s14, v142
    s_nop 0
    s_cmp_ge_u32 s14, 4
    s_cbranch_scc1 Lsd_131
    s_sleep 1
    s_sub_u32 s15, s15, 1
    s_cbranch_scc0 Lspin_130
Lsd_131:
Lok_129:
    ds_read_b128 v[96:99], v131 offset:46080
    s_mov_b32 exec_hi, 0
    ds_read_b128 v[108:111], v133 offset:54784
    s_mov_b64 exec, -1
    s_waitcnt lgkmcnt(2)
    v_exp_f32 v45, v45
    v_exp_f32 v46, v46
    v_exp_f32 v47, v47
    v_exp_f32 v16, v16
    v_exp_f32 v17, v17
    v_smfmac_f32_32x32x32_bf16 v[64:79], v[116:119], v[40:47], v130
    v_exp_f32 v18, v18
    v_exp_f32 v19, v19
    v_mfma_f32_32x32x16_bf16 v[32:47], v[100:103], v[84:87], 0
    v_exp_f32 v20, v20
    v_exp_f32 v21, v21
    v_exp_f32 v22, v22
    v_mfma_f32_32x32x8_bf16 v[32:47], v[106:107], v[94:95], v[32:47]
    v_exp_f32 v23, v23
    v_exp_f32 v24, v24
    v_exp_f32 v25, v25
    v_exp_f32 v26, v26
    v_smfmac_f32_32x32x32_bf16 v[48:63], v[120:123], v[16:23], v130
    v_exp_f32 v27, v27
    v_exp_f32 v28, v28
    s_mov_b64 exec, 1
    v_mov_b32 v142, 1
    ds_add_u32 v134, v142 offset:32
    s_mov_b64 exec, -1
    s_mov_b64 exec, s[36:37]
    ds_read_b128 v[112:115], v132 offset:50176
    ds_read_b128 v[116:119], v132 offset:50752
    s_mov_b64 exec, -1
    s_waitcnt lgkmcnt(2)
    v_exp_f32 v29, v29
    v_exp_f32 v30, v30
    v_exp_f32 v31, v31
    v_exp_f32 v32, v32
    v_exp_f32 v33, v33
    v_smfmac_f32_32x32x32_bf16 v[48:63], v[124:127], v[24:31], v130
    v_exp_f32 v34, v34
    v_exp_f32 v35, v35
    v_mfma_f32_32x32x16_bf16 v[16:31], v[96:99], v[80:83], 0
    v_exp_f32 v36, v36
    v_exp_f32 v37, v37
    v_exp_f32 v38, v38
    v_mfma_f32_32x32x8_bf16 v[16:31], v[108:109], v[88:89], v[16:31]
    v_exp_f32 v39, v39
    v_exp_f32 v40, v40
    v_exp_f32 v41, v41
    v_exp_f32 v42, v42
    v_smfmac_f32_32x32x32_bf16 v[64:79], v[120:123], v[32:39], v130
    v_exp_f32 v43, v43
    v_exp_f32 v44, v44
    ds_read_b128 v[100:103], v131 offset:47104
    s_waitcnt lgkmcnt(1)
    v_exp_f32 v45, v45
    v_exp_f32 v46, v46
    v_exp_f32 v47, v47
    v_exp_f32 v16, v16
    v_exp_f32 v17, v17
    v_smfmac_f32_32x32x32_bf16 v[64:79], v[124:127], v[40:47], v130
    v_exp_f32 v18, v18
    v_exp_f32 v19, v19
    v_mfma_f32_32x32x16_bf16 v[32:47], v[96:99], v[84:87], 0
    v_exp_f32 v20, v20
    v_exp_f32 v21, v21
    v_exp_f32 v22, v22
    v_mfma_f32_32x32x8_bf16 v[32:47], v[108:109], v[92:93], v[32:47]
    v_exp_f32 v23, v23
    v_exp_f32 v24, v24
    v_exp_f32 v25, v25
    v_exp_f32 v26, v26
    v_smfmac_f32_32x32x32_bf16 v[48:63], v[112:115], v[16:23], v130
    v_exp_f32 v27, v27
    v_exp_f32 v28, v28
    s_mov_b64 exec, s[36:37]
    ds_read_b128 v[120:123], v132 offset:51328
    ds_read_b128 v[124:127], v132 offset:51904
    s_mov_b64 exec, -1
    s_waitcnt lgkmcnt(2)
    v_exp_f32 v29, v29
    v_exp_f32 v30, v30
    v_exp_f32 v31, v31
    v_exp_f32 v32, v32
    v_exp_f32 v33, v33
    v_smfmac_f32_32x32x32_bf16 v[48:63], v[116:119], v[24:31], v130
    v_exp_f32 v34, v34
    v_exp_f32 v35, v35
    v_mfma_f32_32x32x16_bf16 v[16:31], v[100:103], v[80:83], 0
    v_exp_f32 v36, v36
    v_exp_f32 v37, v37
    v_exp_f32 v38, v38
    v_mfma_f32_32x32x8_bf16 v[16:31], v[108:109], v[90:91], v[16:31]
    v_exp_f32 v39, v39
    v_exp_f32 v40, v40
    v_exp_f32 v41, v41
    v_exp_f32 v42, v42
    v_smfmac_f32_32x32x32_bf16 v[64:79], v[112:115], v[32:39], v130
    v_exp_f32 v43, v43
    v_exp_f32 v44, v44
    ds_read_b128 v[96:99], v131 offset:48128
    s_waitcnt lgkmcnt(1)
    v_exp_f32 v45, v45
    v_exp_f32 v46, v46
    v_exp_f32 v47, v47
    v_exp_f32 v16, v16
    v_exp_f32 v17, v17
    v_smfmac_f32_32x32x32_bf16 v[64:79], v[116:119], v[40:47], v130
    v_exp_f32 v18, v18
    v_exp_f32 v19, v19
    v_mfma_f32_32x32x16_bf16 v[32:47], v[100:103], v[84:87], 0
    v_exp_f32 v20, v20
    v_exp_f32 v21, v21
    v_exp_f32 v22, v22
    v_mfma_f32_32x32x8_bf16 v[32:47], v[108:109], v[94:95], v[32:47]
    v_exp_f32 v23, v23
    v_exp_f32 v24, v24
    v_exp_f32 v25, v25
    v_exp_f32 v26, v26
    v_smfmac_f32_32x32x32_bf16 v[48:63], v[120:123], v[16:23], v130
    v_exp_f32 v27, v27
    v_exp_f32 v28, v28
    s_mov_b64 exec, s[36:37]
    ds_read_b128 v[112:115], v132 offset:52480
    ds_read_b128 v[116:119], v132 offset:53056
    s_mov_b64 exec, -1
    s_waitcnt lgkmcnt(2)
    v_exp_f32 v29, v29
    v_exp_f32 v30, v30
    v_exp_f32 v31, v31
    v_exp_f32 v32, v32
    v_exp_f32 v33, v33
    v_smfmac_f32_32x32x32_bf16 v[48:63], v[124:127], v[24:31], v130
    v_exp_f32 v34, v34
    v_exp_f32 v35, v35
    v_mfma_f32_32x32x16_bf16 v[16:31], v[96:99], v[80:83], 0
    v_exp_f32 v36, v36
    v_exp_f32 v37, v37
    v_exp_f32 v38, v38
    v_mfma_f32_32x32x8_bf16 v[16:31], v[110:111], v[88:89], v[16:31]
    v_exp_f32 v39, v39
    v_exp_f32 v40, v40
    v_exp_f32 v41, v41
    v_exp_f32 v42, v42
    v_smfmac_f32_32x32x32_bf16 v[64:79], v[120:123], v[32:39], v130
    v_exp_f32 v43, v43
    v_exp_f32 v44, v44
    ds_read_b128 v[100:103], v131 offset:49152
    s_waitcnt lgkmcnt(1)
    v_exp_f32 v45, v45
    v_exp_f32 v46, v46
    v_exp_f32 v47, v47
    v_exp_f32 v16, v16
    v_exp_f32 v17, v17
    v_smfmac_f32_32x32x32_bf16 v[64:79], v[124:127], v[40:47], v130
    v_exp_f32 v18, v18
    v_exp_f32 v19, v19
    v_mfma_f32_32x32x16_bf16 v[32:47], v[96:99], v[84:87], 0
    v_exp_f32 v20, v20
    v_exp_f32 v21, v21
    v_exp_f32 v22, v22
    v_mfma_f32_32x32x8_bf16 v[32:47], v[110:111], v[92:93], v[32:47]
    v_exp_f32 v23, v23
    v_exp_f32 v24, v24
    v_exp_f32 v25, v25
    v_exp_f32 v26, v26
    v_smfmac_f32_32x32x32_bf16 v[48:63], v[112:115], v[16:23], v130
    v_exp_f32 v27, v27
    v_exp_f32 v28, v28
    ds_read_b32 v143, v134 offset:156
    s_mov_b64 exec, s[36:37]
    ds_read_b128 v[120:123], v132 offset:53632
    ds_read_b128 v[124:127], v132 offset:54208
    s_mov_b64 exec, -1
    s_waitcnt lgkmcnt(2)
    v_exp_f32 v29, v29
    v_exp_f32 v30, v30
    v_exp_f32 v31, v31
    v_exp_f32 v32, v32
    v_exp_f32 v33, v33
    v_smfmac_f32_32x32x32_bf16 v[48:63], v[116:119], v[24:31], v130
    v_exp_f32 v34, v34
    v_exp_f32 v35, v35
    v_mfma_f32_32x32x16_bf16 v[16:31], v[100:103], v[80:83], 0
    v_exp_f32 v36, v36
    v_exp_f32 v37, v37
    v_exp_f32 v38, v38
    v_mfma_f32_32x32x8_bf16 v[16:31], v[110:111], v[90:91], v[16:31]
    v_exp_f32 v39, v39
    v_exp_f32 v40, v40
    v_exp_f32 v41, v41
    v_exp_f32 v42, v42
    v_smfmac_f32_32x32x32_bf16 v[64:79], v[112:115], v[32:39], v130
    v_exp_f32 v43, v43
    v_exp_f32 v44, v44
    v_readfirstlane_b32 s14, v143
    s_nop 0
    s_cmp_ge_u32 s14, 4
    s_cbranch_scc1 Lok_132
    s_mov_b32 s15, 200000
Lspin_133:
    ds_read_b32 v142, v134 offset:156
    s_waitcnt lgkmcnt(0)
    v_readfirstlane_b32 s14, v142
    s_nop 0
    s_cmp_ge_u32 s14, 4
    s_cbranch_scc1 Lsd_134
    s_sleep 1
    s_sub_u32 s15, s15, 1
    s_cbranch_scc0 Lspin_133
Lsd_134:
Lok_132:
    ds_read_b128 v[96:99], v131 offset:55296
    v_add_u32 v133, 55296, v133
    s_mov_b32 exec_hi, 0
    ds_read_b128 v[104:107], v133 offset:8704
    s_mov_b64 exec, -1
    s_waitcnt lgkmcnt(2)
    v_exp_f32 v45, v45
    v_exp_f32 v46, v46
    v_exp_f32 v47, v47
    v_exp_f32 v16, v16
    v_exp_f32 v17, v17
    v_smfmac_f32_32x32x32_bf16 v[64:79], v[116:119], v[40:47], v130
    v_exp_f32 v18, v18
    v_exp_f32 v19, v19
    v_mfma_f32_32x32x16_bf16 v[32:47], v[100:103], v[84:87], 0
    v_exp_f32 v20, v20
    v_exp_f32 v21, v21
    v_exp_f32 v22, v22
    v_mfma_f32_32x32x8_bf16 v[32:47], v[110:111], v[94:95], v[32:47]
    v_exp_f32 v23, v23
    v_exp_f32 v24, v24
    v_exp_f32 v25, v25
    v_exp_f32 v26, v26
    v_smfmac_f32_32x32x32_bf16 v[48:63], v[120:123], v[16:23], v130
    v_exp_f32 v27, v27
    v_exp_f32 v28, v28
    s_mov_b64 exec, 1
    v_mov_b32 v142, 1
    ds_add_u32 v134, v142 offset:176
    s_mov_b64 exec, -1
    s_mov_b64 exec, s[36:37]
    ds_read_b128 v[112:115], v132 offset:59392
    ds_read_b128 v[116:119], v132 offset:59968
    s_mov_b64 exec, -1
    s_waitcnt lgkmcnt(2)
    v_exp_f32 v29, v29
    v_exp_f32 v30, v30
    v_exp_f32 v31, v31
    v_exp_f32 v32, v32
    v_exp_f32 v33, v33
    v_smfmac_f32_32x32x32_bf16 v[48:63], v[124:127], v[24:31], v130
    v_exp_f32 v34, v34
    v_exp_f32 v35, v35
    v_mfma_f32_32x32x16_bf16 v[16:31], v[96:99], v[80:83], 0
    v_exp_f32 v36, v36
    v_exp_f32 v37, v37
    v_exp_f32 v38, v38
    v_mfma_f32_32x32x8_bf16 v[16:31], v[104:105], v[88:89], v[16:31]
    v_exp_f32 v39, v39
    v_exp_f32 v40, v40
    v_exp_f32 v41, v41
    v_exp_f32 v42, v42
    v_smfmac_f32_32x32x32_bf16 v[64:79], v[120:123], v[32:39], v130
    v_exp_f32 v43, v43
    v_exp_f32 v44, v44
    ds_read_b128 v[100:103], v131 offset:56320
    s_waitcnt lgkmcnt(1)
    v_exp_f32 v45, v45
    v_exp_f32 v46, v46
    v_exp_f32 v47, v47
    v_exp_f32 v16, v16
    v_exp_f32 v17, v17
    v_smfmac_f32_32x32x32_bf16 v[64:79], v[124:127], v[40:47], v130
    v_exp_f32 v18, v18
    v_exp_f32 v19, v19
    v_mfma_f32_32x32x16_bf16 v[32:47], v[96:99], v[84:87], 0
    v_exp_f32 v20, v20
    v_exp_f32 v21, v21
    v_exp_f32 v22, v22
    v_mfma_f32_32x32x8_bf16 v[32:47], v[104:105], v[92:93], v[32:47]
    v_exp_f32 v23, v23
    v_exp_f32 v24, v24
    v_exp_f32 v25, v25
    v_exp_f32 v26, v26
    v_smfmac_f32_32x32x32_bf16 v[48:63], v[112:115], v[16:23], v130
    v_exp_f32 v27, v27
    v_exp_f32 v28, v28
    s_mov_b64 exec, s[36:37]
    ds_read_b128 v[120:123], v132 offset:60544
    ds_read_b128 v[124:127], v132 offset:61120
    s_mov_b64 exec, -1
    s_waitcnt lgkmcnt(2)
    v_exp_f32 v29, v29
    v_exp_f32 v30, v30
    v_exp_f32 v31, v31
    s_cmp_eq_u32 s11, 0
    s_cbranch_scc0 Lnosw
    s_setprio 1
Lnosw:
    v_exp_f32 v32, v32
    v_exp_f32 v33, v33
    v_smfmac_f32_32x32x32_bf16 v[48:63], v[116:119], v[24:31], v130
    v_exp_f32 v34, v34
    v_exp_f32 v35, v35
    v_mfma_f32_32x32x16_bf16 v[16:31], v[100:103], v[80:83], 0
    v_exp_f32 v36, v36
    v_exp_f32 v37, v37
    v_exp_f32 v38, v38
    v_mfma_f32_32x32x8_bf16 v[16:31], v[104:105], v[90:91], v[16:31]
    v_exp_f32 v39, v39
    v_exp_f32 v40, v40
    v_exp_f32 v41, v41
    v_exp_f32 v42, v42
    v_smfmac_f32_32x32x32_bf16 v[64:79], v[112:115], v[32:39], v130
    v_exp_f32 v43, v43
    v_exp_f32 v44, v44
    ds_read_b128 v[96:99], v131 offset:57344
    s_waitcnt lgkmcnt(1)
    v_exp_f32 v45, v45
    v_exp_f32 v46, v46
    v_exp_f32 v47, v47
    v_exp_f32 v16, v16
    v_exp_f32 v17, v17
    v_smfmac_f32_32x32x32_bf16 v[64:79], v[116:119], v[40:47], v130
    v_exp_f32 v18, v18
    v_exp_f32 v19, v19
    v_mfma_f32_32x32x16_bf16 v[32:47], v[100:103], v[84:87], 0
    v_exp_f32 v20, v20
    v_exp_f32 v21, v21
    v_exp_f32 v22, v22
    v_mfma_f32_32x32x8_bf16 v[32:47], v[104:105], v[94:95], v[32:47]
    v_exp_f32 v23, v23
    v_exp_f32 v24, v24
    v_exp_f32 v25, v25
    v_exp_f32 v26, v26
    v_smfmac_f32_32x32x32_bf16 v[48:63], v[120:123], v[16:23], v130
    v_exp_f32 v27, v27
    v_exp_f32 v28, v28
    v_add_u32 v132, 55296, v132
    s_mov_b64 exec, s[36:37]
    ds_read_b128 v[112:115], v132 offset:6400
    ds_read_b128 v[116:119], v132 offset:6976
    s_mov_b64 exec, -1
    s_waitcnt lgkmcnt(2)
    v_exp_f32 v29, v29
    v_exp_f32 v30, v30
    v_exp_f32 v31, v31
    v_exp_f32 v32, v32
    v_exp_f32 v33, v33
    v_smfmac_f32_32x32x32_bf16 v[48:63], v[124:127], v[24:31], v130
    v_exp_f32 v34, v34
    v_exp_f32 v35, v35
    v_mfma_f32_32x32x16_bf16 v[16:31], v[96:99], v[80:83], 0
    v_exp_f32 v36, v36
    v_exp_f32 v37, v37
    v_exp_f32 v38, v38
    v_mfma_f32_32x32x8_bf16 v[16:31], v[106:107], v[88:89], v[16:31]
    v_exp_f32 v39, v39
    v_exp_f32 v40, v40
    v_exp_f32 v41, v41
    v_exp_f32 v42, v42
    v_smfmac_f32_32x32x32_bf16 v[64:79], v[120:123], v[32:39], v130
    v_exp_f32 v43, v43
    v_exp_f32 v44, v44
    ds_read_b128 v[100:103], v131 offset:58368
    s_waitcnt lgkmcnt(1)
    v_exp_f32 v45, v45
    v_exp_f32 v46, v46
    v_exp_f32 v47, v47
    v_exp_f32 v16, v16
    v_exp_f32 v17, v17
    v_smfmac_f32_32x32x32_bf16 v[64:79], v[124:127], v[40:47], v130
    v_exp_f32 v18, v18
    v_exp_f32 v19, v19
    v_mfma_f32_32x32x16_bf16 v[32:47], v[96:99], v[84:87], 0
    v_exp_f32 v20, v20
    v_exp_f32 v21, v21
    v_exp_f32 v22, v22
    v_mfma_f32_32x32x8_bf16 v[32:47], v[106:107], v[92:93], v[32:47]
    v_exp_f32 v23, v23
    v_exp_f32 v24, v24
    v_exp_f32 v25, v25
    v_exp_f32 v26, v26
    v_smfmac_f32_32x32x32_bf16 v[48:63], v[112:115], v[16:23], v130
    v_exp_f32 v27, v27
    v_exp_f32 v28, v28
    s_mov_b64 exec, s[36:37]
    ds_read_b128 v[120:123], v132 offset:7552
    ds_read_b128 v[124:127], v132 offset:8128
    s_mov_b64 exec, -1
    s_waitcnt lgkmcnt(2)
    v_exp_f32 v29, v29
    v_exp_f32 v30, v30
    v_exp_f32 v31, v31
    v_exp_f32 v32, v32
    v_exp_f32 v33, v33
    v_smfmac_f32_32x32x32_bf16 v[48:63], v[116:119], v[24:31], v130
    v_exp_f32 v34, v34
    v_exp_f32 v35, v35
    v_mfma_f32_32x32x16_bf16 v[16:31], v[100:103], v[80:83], 0
    v_exp_f32 v36, v36
    v_exp_f32 v37, v37
    v_exp_f32 v38, v38
    v_mfma_f32_32x32x8_bf16 v[16:31], v[106:107], v[90:91], v[16:31]
    v_exp_f32 v39, v39
    v_exp_f32 v40, v40
    v_exp_f32 v41, v41
    v_exp_f32 v42, v42
    v_smfmac_f32_32x32x32_bf16 v[64:79], v[112:115], v[32:39], v130
    v_exp_f32 v43, v43
    v_exp_f32 v44, v44
    v_add_u32 v131, 64512, v131
    ds_read_b128 v[96:99], v131 offset:0
    s_mov_b32 exec_hi, 0
    ds_read_b128 v[108:111], v133 offset:17920
    s_mov_b64 exec, -1
    s_waitcnt lgkmcnt(2)
    v_exp_f32 v45, v45
    v_exp_f32 v46, v46
    v_exp_f32 v47, v47
    v_exp_f32 v16, v16
    v_exp_f32 v17, v17
    v_smfmac_f32_32x32x32_bf16 v[64:79], v[116:119], v[40:47], v130
    v_exp_f32 v18, v18
    v_exp_f32 v19, v19
    v_mfma_f32_32x32x16_bf16 v[32:47], v[100:103], v[84:87], 0
    v_exp_f32 v20, v20
    v_exp_f32 v21, v21
    v_exp_f32 v22, v22
    v_mfma_f32_32x32x8_bf16 v[32:47], v[106:107], v[94:95], v[32:47]
    v_exp_f32 v23, v23
    v_exp_f32 v24, v24
    v_exp_f32 v25, v25
    v_exp_f32 v26, v26
    v_smfmac_f32_32x32x32_bf16 v[48:63], v[120:123], v[16:23], v130
    v_exp_f32 v27, v27
    v_exp_f32 v28, v28
    s_mov_b64 exec, s[36:37]
    ds_read_b128 v[112:115], v132 offset:13312
    ds_read_b128 v[116:119], v132 offset:13888
    s_mov_b64 exec, -1
    s_waitcnt lgkmcnt(2)
    v_exp_f32 v29, v29
    v_exp_f32 v30, v30
    v_exp_f32 v31, v31
    v_exp_f32 v32, v32
    v_exp_f32 v33, v33
    v_smfmac_f32_32x32x32_bf16 v[48:63], v[124:127], v[24:31], v130
    v_exp_f32 v34, v34
    v_exp_f32 v35, v35
    v_mfma_f32_32x32x16_bf16 v[16:31], v[96:99], v[80:83], 0
    v_exp_f32 v36, v36
    v_exp_f32 v37, v37
    v_exp_f32 v38, v38
    v_mfma_f32_32x32x8_bf16 v[16:31], v[108:109], v[88:89], v[16:31]
    v_exp_f32 v39, v39
    v_exp_f32 v40, v40
    v_exp_f32 v41, v41
    v_exp_f32 v42, v42
    v_smfmac_f32_32x32x32_bf16 v[64:79], v[120:123], v[32:39], v130
    v_exp_f32 v43, v43
    v_exp_f32 v44, v44
    ds_read_b128 v[100:103], v131 offset:1024
    s_waitcnt lgkmcnt(1)
    v_exp_f32 v45, v45
    v_exp_f32 v46, v46
    v_exp_f32 v47, v47
    v_exp_f32 v16, v16
    v_exp_f32 v17, v17
    v_smfmac_f32_32x32x32_bf16 v[64:79], v[124:127], v[40:47], v130
    v_exp_f32 v18, v18
    v_exp_f32 v19, v19
    v_mfma_f32_32x32x16_bf16 v[32:47], v[96:99], v[84:87], 0
    v_exp_f32 v20, v20
    v_exp_f32 v21, v21
    v_exp_f32 v22, v22
    v_mfma_f32_32x32x8_bf16 v[32:47], v[108:109], v[92:93], v[32:47]
    v_exp_f32 v23, v23
    v_exp_f32 v24, v24
    v_exp_f32 v25, v25
    v_exp_f32 v26, v26
    v_smfmac_f32_32x32x32_bf16 v[48:63], v[112:115], v[16:23], v130
    v_exp_f32 v27, v27
    v_exp_f32 v28, v28
    s_mov_b64 exec, s[36:37]
    ds_read_b128 v[120:123], v132 offset:14464
    ds_read_b128 v[124:127], v132 offset:15040
    s_mov_b64 exec, -1
    s_waitcnt lgkmcnt(2)
    v_exp_f32 v29, v29
    v_exp_f32 v30, v30
    v_exp_f32 v31, v31
    v_exp_f32 v32, v32
    v_exp_f32 v33, v33
    v_smfmac_f32_32x32x32_bf16 v[48:63], v[116:119], v[24:31], v130
    v_exp_f32 v34, v34
    v_exp_f32 v35, v35
    v_mfma_f32_32x32x16_bf16 v[16:31], v[100:103], v[80:83], 0
    v_exp_f32 v36, v36
    v_exp_f32 v37, v37
    v_exp_f32 v38, v38
    v_mfma_f32_32x32x8_bf16 v[16:31], v[108:109], v[90:91], v[16:31]
    v_exp_f32 v39, v39
    v_exp_f32 v40, v40
    v_exp_f32 v41, v41
    v_exp_f32 v42, v42
    v_smfmac_f32_32x32x32_bf16 v[64:79], v[112:115], v[32:39], v130
    v_exp_f32 v43, v43
    v_exp_f32 v44, v44
    ds_read_b128 v[96:99], v131 offset:2048
    s_waitcnt lgkmcnt(1)
    v_exp_f32 v45, v45
    v_exp_f32 v46, v46
    v_exp_f32 v47, v47
    v_exp_f32 v16, v16
    v_exp_f32 v17, v17
    v_smfmac_f32_32x32x32_bf16 v[64:79], v[116:119], v[40:47], v130
    v_exp_f32 v18, v18
    v_exp_f32 v19, v19
    v_mfma_f32_32x32x16_bf16 v[32:47], v[100:103], v[84:87], 0
    v_exp_f32 v20, v20
    v_exp_f32 v21, v21
    v_exp_f32 v22, v22
    v_mfma_f32_32x32x8_bf16 v[32:47], v[108:109], v[94:95], v[32:47]
    v_exp_f32 v23, v23
    v_exp_f32 v24, v24
    v_exp_f32 v25, v25
    v_exp_f32 v26, v26
    v_smfmac_f32_32x32x32_bf16 v[48:63], v[120:123], v[16:23], v130
    v_exp_f32 v27, v27
    v_exp_f32 v28, v28
    s_mov_b64 exec, s[36:37]
    ds_read_b128 v[112:115], v132 offset:15616
    ds_read_b128 v[116:119], v132 offset:16192
    s_mov_b64 exec, -1
    s_waitcnt lgkmcnt(2)
    v_exp_f32 v29, v29
    v_exp_f32 v30, v30
    v_exp_f32 v31, v31
    s_setprio 1
    v_exp_f32 v32, v32
    v_exp_f32 v33, v33
    v_smfmac_f32_32x32x32_bf16 v[48:63], v[124:127], v[24:31], v130
    v_exp_f32 v34, v34
    v_exp_f32 v35, v35
    v_mfma_f32_32x32x16_bf16 v[16:31], v[96:99], v[80:83], 0
    v_exp_f32 v36, v36
    v_exp_f32 v37, v37
    v_exp_f32 v38, v38
    v_mfma_f32_32x32x8_bf16 v[16:31], v[110:111], v[88:89], v[16:31]
    v_exp_f32 v39, v39
    v_exp_f32 v40, v40
    v_exp_f32 v41, v41
    v_exp_f32 v42, v42
    v_smfmac_f32_32x32x32_bf16 v[64:79], v[120:123], v[32:39], v130
    v_exp_f32 v43, v43
    v_exp_f32 v44, v44
    ds_read_b128 v[100:103], v131 offset:3072
    s_waitcnt lgkmcnt(1)
    v_exp_f32 v45, v45
    v_exp_f32 v46, v46
    v_exp_f32 v47, v47
    v_exp_f32 v16, v16
    v_exp_f32 v17, v17
    v_smfmac_f32_32x32x32_bf16 v[64:79], v[124:127], v[40:47], v130
    v_exp_f32 v18, v18
    v_exp_f32 v19, v19
    v_mfma_f32_32x32x16_bf16 v[32:47], v[96:99], v[84:87], 0
    v_exp_f32 v20, v20
    v_exp_f32 v21, v21
    v_exp_f32 v22, v22
    v_mfma_f32_32x32x8_bf16 v[32:47], v[110:111], v[92:93], v[32:47]
    v_exp_f32 v23, v23
    v_exp_f32 v24, v24
    v_exp_f32 v25, v25
    v_exp_f32 v26, v26
    v_smfmac_f32_32x32x32_bf16 v[48:63], v[112:115], v[16:23], v130
    v_exp_f32 v27, v27
    v_exp_f32 v28, v28
    s_mov_b64 exec, s[36:37]
    ds_read_b128 v[120:123], v132 offset:16768
    ds_read_b128 v[124:127], v132 offset:17344
    s_mov_b64 exec, -1
    s_waitcnt lgkmcnt(2)
    v_exp_f32 v29, v29
    v_exp_f32 v30, v30
    v_exp_f32 v31, v31
    v_exp_f32 v32, v32
    v_exp_f32 v33, v33
    v_smfmac_f32_32x32x32_bf16 v[48:63], v[116:119], v[24:31], v130
    v_exp_f32 v34, v34
    v_exp_f32 v35, v35
    v_mfma_f32_32x32x16_bf16 v[16:31], v[100:103], v[80:83], 0
    v_exp_f32 v36, v36
    v_exp_f32 v37, v37
    v_exp_f32 v38, v38
    v_mfma_f32_32x32x8_bf16 v[16:31], v[110:111], v[90:91], v[16:31]
    v_exp_f32 v39, v39
    v_exp_f32 v40, v40
    v_exp_f32 v41, v41
    v_exp_f32 v42, v42
    v_smfmac_f32_32x32x32_bf16 v[64:79], v[112:115], v[32:39], v130
    v_exp_f32 v43, v43
    v_exp_f32 v44, v44
    s_waitcnt lgkmcnt(0)
    v_exp_f32 v45, v45
    v_exp_f32 v46, v46
    v_exp_f32 v47, v47
    s_nop 0
    v_exp_f32 v16, v16
    v_exp_f32 v17, v17
    v_smfmac_f32_32x32x32_bf16 v[64:79], v[116:119], v[40:47], v130
    v_exp_f32 v18, v18
    v_exp_f32 v19, v19
    v_mfma_f32_32x32x16_bf16 v[32:47], v[100:103], v[84:87], 0
    v_exp_f32 v20, v20
    v_exp_f32 v21, v21
    v_exp_f32 v22, v22
    v_mfma_f32_32x32x8_bf16 v[32:47], v[110:111], v[94:95], v[32:47]
    v_exp_f32 v23, v23
    v_exp_f32 v24, v24
    v_exp_f32 v25, v25
    v_exp_f32 v26, v26
    v_smfmac_f32_32x32x32_bf16 v[48:63], v[120:123], v[16:23], v130
    v_exp_f32 v27, v27
    v_exp_f32 v28, v28
    ds_read_b32 v143, v141 offset:0
    ds_read_b32 v13, v3 offset:172
    s_waitcnt lgkmcnt(0)
    v_exp_f32 v29, v29
    v_exp_f32 v30, v30
    v_exp_f32 v31, v31
    v_exp_f32 v32, v32
    v_exp_f32 v33, v33
    v_smfmac_f32_32x32x32_bf16 v[48:63], v[124:127], v[24:31], v130
    v_exp_f32 v34, v34
    v_exp_f32 v35, v35
    v_exp_f32 v36, v36
    v_exp_f32 v37, v37
    v_exp_f32 v38, v38
    v_exp_f32 v39, v39
    v_exp_f32 v40, v40
    v_exp_f32 v41, v41
    v_exp_f32 v42, v42
    v_smfmac_f32_32x32x32_bf16 v[64:79], v[120:123], v[32:39], v130
    v_exp_f32 v43, v43
    v_exp_f32 v44, v44
    v_readfirstlane_b32 s14, v143
    s_nop 0
    s_cmp_ge_u32 s14, 1
    s_cbranch_scc1 Lok_135
    s_mov_b32 s15, 200000
Lspin_136:
    ds_read_b32 v142, v141 offset:0
    s_waitcnt lgkmcnt(0)
    v_readfirstlane_b32 s14, v142
    s_nop 0
    s_cmp_ge_u32 s14, 1
    s_cbranch_scc1 Lsd_137
    s_sleep 1
    s_sub_u32 s15, s15, 1
    s_cbranch_scc0 Lspin_136
Lsd_137:
Lok_135:
    ds_read_b128 v[144:147], v137 offset:0
    ds_read_b128 v[148:151], v137 offset:1024
    ds_read_b128 v[152:155], v137 offset:2048
    ds_read_b128 v[156:159], v137 offset:3072
    ds_read_b128 v[160:163], v137 offset:4096
    ds_read_b128 v[164:167], v137 offset:5120
    v_exp_f32 v45, v45
    v_exp_f32 v46, v46
    v_exp_f32 v47, v47
    s_nop 1
    v_smfmac_f32_32x32x32_bf16 v[64:79], v[124:127], v[40:47], v130
    v_cmp_gt_u32 vcc, 32, v1
    s_mov_b32 s14, 0x67800000
    s_cmp_eq_u32 s11, 0
    s_cselect_b32 s15, 0x07800000, 0
    s_cselect_b64 s[24:25], 0, -1
    s_lshl_b32 s30, s4, 3
    s_add_u32 s30, s30, s5
    s_lshl_b32 s30, s30, 4
    s_add_u32 s30, s30, s10
    s_lshl_b32 s30, s30, 3
    s_add_u32 s30, s30, 299008
    v_cndmask_b32 v96, v56, v58, vcc
    v_cmp_nle_f32 s[12:13], v96, s14
    v_cmp_nge_f32 s[28:29], v96, s15
    s_waitcnt lgkmcnt(0)
    v_cmp_ne_u32 s[20:21], v155, v128
    v_cmp_ne_u32 s[22:23], v167, v129
    s_or_b64 s[12:13], s[12:13], s[28:29]
    s_or_b64 s[20:21], s[20:21], s[22:23]
    s_and_b64 s[20:21], s[20:21], s[24:25]
    s_or_b64 s[12:13], s[12:13], s[20:21]
    v_cndmask_b32 v98, v72, v74, vcc
    v_cmp_nle_f32 s[28:29], v98, s14
    v_cmp_nge_f32 s[26:27], v98, s15
    s_or_b64 s[12:13], s[12:13], s[28:29]
    s_or_b64 s[12:13], s[12:13], s[26:27]
    s_cbranch_scc1 Lslow
Lchecked:
    s_cmp_eq_u32 s11, 0
    s_cbranch_scc0 Lkh1
    s_mov_b32 s53, 0
    s_cmp_ge_u32 s53, 14
    s_cbranch_scc1 Lpg_138
    s_mov_b32 s15, 200000
Lpl_139:
    ds_read_b128 v[100:103], v3 offset:112
    s_waitcnt lgkmcnt(0)
    v_min3_u32 v100, v100, v101, v102
    s_nop 0
    v_readfirstlane_b32 s53, v100
    s_nop 0
    s_cmp_ge_u32 s53, 14
    s_cbranch_scc1 Lpg_138
    s_sleep 6
    s_sub_u32 s15, s15, 1
    s_cbranch_scc0 Lpl_139
Lpg_138:
    v_mov_b32 v59, v128
    ds_write_b128 v137, v[48:51] offset:0
    ds_write_b128 v137, v[52:55] offset:1024
    ds_write_b128 v137, v[56:59] offset:2048
    v_mov_b32 v75, v129
    ds_write_b128 v137, v[64:67] offset:3072
    ds_write_b128 v137, v[68:71] offset:4096
    ds_write_b128 v137, v[72:75] offset:5120
    s_waitcnt lgkmcnt(0)
    s_mov_b64 exec, 1
    v_mov_b32 v142, 1
    ds_add_u32 v138, v142 offset:64
    s_mov_b64 exec, -1
    s_endpgm
Lkh1:
    v_readfirstlane_b32 s14, v13
    s_nop 0
    s_cmp_eq_u32 s14, 0
    s_cbranch_scc1 Lkh1far
    v_cndmask_b32 v97, v152, v154, vcc
    v_add_f32 v97, v97, v96
    v_rcp_f32 v97, v97
    v_pk_add_f32 v[48:49], v[48:49], v[144:145]
    v_pk_add_f32 v[50:51], v[50:51], v[146:147]
    v_pk_add_f32 v[52:53], v[52:53], v[148:149]
    v_pk_add_f32 v[54:55], v[54:55], v[150:151]
    v_pk_add_f32 v[56:57], v[56:57], v[152:153]
    v_mul_f32 v96, 0x33800000, v97
    v_pk_mul_f32 v[48:49], v[48:49], v[96:97] op_sel_hi:[1,0]
    v_pk_mul_f32 v[50:51], v[50:51], v[96:97] op_sel_hi:[1,0]
    v_pk_mul_f32 v[52:53], v[52:53], v[96:97] op_sel_hi:[1,0]
    v_pk_mul_f32 v[54:55], v[54:55], v[96:97] op_sel_hi:[1,0]
    v_pk_mul_f32 v[56:57], v[56:57], v[96:97] op_sel_hi:[1,0]
    v_cvt_pk_bf16_f32 v48, v48, v49
    v_cvt_pk_bf16_f32 v49, v50, v51
    v_cvt_pk_bf16_f32 v50, v52, v53
    v_cvt_pk_bf16_f32 v51, v54, v55
    v_cvt_pk_bf16_f32 v52, v56, v57
    buffer_store_dwordx4 v[48:51], v140, s[44:47], s38 offen
    s_add_u32 s38, s38, 36864
    v_cndmask_b32 v99, v164, v166, vcc
    v_add_f32 v99, v99, v98
    v_rcp_f32 v99, v99
    v_pk_add_f32 v[64:65], v[64:65], v[156:157]
    v_pk_add_f32 v[66:67], v[66:67], v[158:159]
    v_pk_add_f32 v[68:69], v[68:69], v[160:161]
    v_pk_add_f32 v[70:71], v[70:71], v[162:163]
    v_pk_add_f32 v[72:73], v[72:73], v[164:165]
    v_mul_f32 v98, 0x33800000, v99
    v_pk_mul_f32 v[64:65], v[64:65], v[98:99] op_sel_hi:[1,0]
    v_pk_mul_f32 v[66:67], v[66:67], v[98:99] op_sel_hi:[1,0]
    v_pk_mul_f32 v[68:69], v[68:69], v[98:99] op_sel_hi:[1,0]
    v_pk_mul_f32 v[70:71], v[70:71], v[98:99] op_sel_hi:[1,0]
    v_pk_mul_f32 v[72:73], v[72:73], v[98:99] op_sel_hi:[1,0]
    v_cvt_pk_bf16_f32 v64, v64, v65
    v_cvt_pk_bf16_f32 v65, v66, v67
    v_cvt_pk_bf16_f32 v66, v68, v69
    v_cvt_pk_bf16_f32 v67, v70, v71
    v_cvt_pk_bf16_f32 v68, v72, v73
    buffer_store_dwordx4 v[64:67], v140, s[44:47], s38 offen
    s_nop 0
    v_permlane32_swap_b32 v52, v68
    buffer_store_dword v52, v139, s[44:47], s39 offen
    s_mov_b64 exec, 1
    v_mov_b32 v142, 1
    ds_add_u32 v3, v142 offset:44
    s_mov_b64 exec, -1
    s_waitcnt vmcnt(0)
    s_mov_b64 exec, 1
    buffer_store_dwordx2 v[10:11], off, s[44:47], s30
    s_mov_b64 exec, -1
    s_mov_b64 exec, 1
    v_mov_b32 v142, 1
    ds_add_u32 v3, v142 offset:48
    s_mov_b64 exec, -1
    s_endpgm
Lkh1far:
    v_cndmask_b32 v97, v152, v154, vcc
    v_add_f32 v97, v97, v96
    v_rcp_f32 v97, v97
    v_pk_add_f32 v[48:49], v[48:49], v[144:145]
    v_pk_add_f32 v[50:51], v[50:51], v[146:147]
    v_pk_add_f32 v[52:53], v[52:53], v[148:149]
    v_pk_add_f32 v[54:55], v[54:55], v[150:151]
    v_pk_add_f32 v[56:57], v[56:57], v[152:153]
    v_mul_f32 v96, 0x33800000, v97
    v_pk_mul_f32 v[48:49], v[48:49], v[96:97] op_sel_hi:[1,0]
    v_pk_mul_f32 v[50:51], v[50:51], v[96:97] op_sel_hi:[1,0]
    v_pk_mul_f32 v[52:53], v[52:53], v[96:97] op_sel_hi:[1,0]
    v_pk_mul_f32 v[54:55], v[54:55], v[96:97] op_sel_hi:[1,0]
    v_pk_mul_f32 v[56:57], v[56:57], v[96:97] op_sel_hi:[1,0]
    v_cvt_pk_bf16_f32 v48, v48, v49
    v_cvt_pk_bf16_f32 v49, v50, v51
    v_cvt_pk_bf16_f32 v50, v52, v53
    v_cvt_pk_bf16_f32 v51, v54, v55
    v_cvt_pk_bf16_f32 v52, v56, v57
    buffer_store_dwordx4 v[48:51], v140, s[44:47], s38 offen sc1
    s_add_u32 s38, s38, 36864
    v_cndmask_b32 v99, v164, v166, vcc
    v_add_f32 v99, v99, v98
    v_rcp_f32 v99, v99
    v_pk_add_f32 v[64:65], v[64:65], v[156:157]
    v_pk_add_f32 v[66:67], v[66:67], v[158:159]
    v_pk_add_f32 v[68:69], v[68:69], v[160:161]
    v_pk_add_f32 v[70:71], v[70:71], v[162:163]
    v_pk_add_f32 v[72:73], v[72:73], v[164:165]
    v_mul_f32 v98, 0x33800000, v99
    v_pk_mul_f32 v[64:65], v[64:65], v[98:99] op_sel_hi:[1,0]
    v_pk_mul_f32 v[66:67], v[66:67], v[98:99] op_sel_hi:[1,0]
    v_pk_mul_f32 v[68:69], v[68:69], v[98:99] op_sel_hi:[1,0]
    v_pk_mul_f32 v[70:71], v[70:71], v[98:99] op_sel_hi:[1,0]
    v_pk_mul_f32 v[72:73], v[72:73], v[98:99] op_sel_hi:[1,0]
    v_cvt_pk_bf16_f32 v64, v64, v65
    v_cvt_pk_bf16_f32 v65, v66, v67
    v_cvt_pk_bf16_f32 v66, v68, v69
    v_cvt_pk_bf16_f32 v67, v70, v71
    v_cvt_pk_bf16_f32 v68, v72, v73
    buffer_store_dwordx4 v[64:67], v140, s[44:47], s38 offen sc1
    s_nop 0
    v_permlane32_swap_b32 v52, v68
    buffer_store_dword v52, v139, s[44:47], s39 offen sc1
    s_mov_b64 exec, 1
    v_mov_b32 v142, 1
    ds_add_u32 v3, v142 offset:44
    s_mov_b64 exec, -1
    s_waitcnt vmcnt(0)
    s_mov_b64 exec, 1
    buffer_store_dwordx2 v[10:11], off, s[44:47], s30 sc1
    s_mov_b64 exec, -1
    s_mov_b64 exec, 1
    v_mov_b32 v142, 1
    ds_add_u32 v3, v142 offset:48
    s_mov_b64 exec, -1
    s_endpgm
Lmget:
    s_cmp_eq_u32 s97, 0
    s_cbranch_scc1 Lmgs
    s_setprio 3
    s_waitcnt vmcnt(4)
    s_cmp_eq_u32 s97, 2
    s_cbranch_scc1 Lmgt
    s_waitcnt vmcnt(0)
Lmgt:
    s_lshl_b32 s12, s96, 2
    v_add_u32 v8, s12, v3
    s_mov_b64 exec, 1
    v_mov_b32 v9, 1
    ds_add_u32 v8, v9 offset:224
    s_mov_b64 exec, -1
Lmgs:
    ds_read_b32 v142, v14
    s_waitcnt lgkmcnt(0)
    ds_read_b128 v[96:99], v131 offset:0
    s_mov_b32 exec_hi, 0
    ds_read_b128 v[104:107], v133 offset:8704
    ds_read_b32 v88, v135 offset:32
    ds_read_b32 v92, v135 offset:5408
    s_mov_b64 exec, -1
    ds_read2_b32 v[80:81], v136 offset0:0 offset1:1
    ds_read2_b32 v[82:83], v136 offset0:2 offset1:3
    ds_read2_b32 v[84:85], v15 offset0:0 offset1:1
    ds_read2_b32 v[86:87], v15 offset0:2 offset1:3
    s_mov_b64 exec, s[36:37]
    ds_read_b128 v[112:115], v132 offset:4096
    ds_read_b128 v[116:119], v132 offset:4672
    s_mov_b64 exec, -1
    ds_read_b128 v[100:103], v131 offset:1024
    ds_read_b64 v[10:11], v3 offset:136
    s_cmp_eq_u32 s97, 0
    s_cbranch_scc1 Lmg0
    s_waitcnt vmcnt(0)
    s_mov_b64 exec, 1
    v_mov_b32 v8, 1
    ds_add_rtn_u32 v8, v3, v8 offset:8
    s_mov_b64 exec, -1
    s_waitcnt lgkmcnt(0)
    v_readfirstlane_b32 s14, v8
    s_nop 0
    s_cmp_eq_u32 s14, 1
    s_cbranch_scc0 Lnf_140
    s_lshl_b32 s13, s4, 3
    s_add_u32 s13, s13, s5
    s_add_u32 s13, s13, 256
    s_lshl_b32 s14, s13, 7
    s_add_u32 s14, s14, 4096
    s_mov_b64 exec, 1
    v_mov_b32 v8, s6
    v_mov_b32 v9, s7
    buffer_store_dwordx2 v[8:9], off, s[44:47], s14 sc1
    s_mov_b64 exec, -1
Lnf_140:
    s_setprio 2
Lmg0:
    s_mov_b32 s15, 200000
Lmg1:
    ds_read_b32 v142, v14
    s_waitcnt lgkmcnt(0)
    v_cmp_eq_u32 vcc, -1, v142
    s_cbranch_vccz Lmg2
    s_sleep 0
    s_sub_u32 s15, s15, 1
    s_cbranch_scc0 Lmg1
Lmg2:
    v_cmp_gt_u32 vcc, 32, v1
    v_and_b32 v128, 0xffff0000, v142
    v_lshlrev_b32 v129, 16, v142
    v_lshrrev_b32 v143, 16, v142
    v_and_b32 v142, 0xffff, v142
    v_cndmask_b32 v88, v143, v88, vcc
    v_cndmask_b32 v92, v142, v92, vcc
    v_mov_b32 v91, v88
    v_mov_b32 v95, v92
    v_mfma_f32_32x32x16_bf16 v[16:31], v[96:99], v[80:83], 0
    v_mfma_f32_32x32x8_bf16 v[16:31], v[104:105], v[88:89], v[16:31]
    s_nop 10
    s_branch Lloop
Lslow:
    s_nop 7
    v_lshlrev_b32 v4, 4, v1
    v_and_b32 v5, 31, v1
    v_lshlrev_b32 v5, 4, v5
    v_lshrrev_b32 v6, 5, v1
    v_mul_u32_u24 v6, 288, v6
    v_add_u32 v6, v6, v5
    v_cndmask_b32 v88, 0, v88, vcc
    v_mov_b32 v8, 0xff800000
    v_mov_b32 v48, 0
    v_mov_b32 v49, 0
    v_mov_b32 v50, 0
    v_mov_b32 v51, 0
    v_mov_b32 v52, 0
    v_mov_b32 v53, 0
    v_mov_b32 v54, 0
    v_mov_b32 v55, 0
    v_mov_b32 v56, 0
    v_mov_b32 v57, 0
    v_mov_b32 v58, 0
    v_mov_b32 v59, 0
    v_mov_b32 v60, 0
    v_mov_b32 v61, 0
    v_mov_b32 v62, 0
    v_mov_b32 v63, 0
    v_cndmask_b32 v92, 0, v92, vcc
    v_mov_b32 v9, 0xff800000
    v_mov_b32 v64, 0
    v_mov_b32 v65, 0
    v_mov_b32 v66, 0
    v_mov_b32 v67, 0
    v_mov_b32 v68, 0
    v_mov_b32 v69, 0
    v_mov_b32 v70, 0
    v_mov_b32 v71, 0
    v_mov_b32 v72, 0
    v_mov_b32 v73, 0
    v_mov_b32 v74, 0
    v_mov_b32 v75, 0
    v_mov_b32 v76, 0
    v_mov_b32 v77, 0
    v_mov_b32 v78, 0
    v_mov_b32 v79, 0
    s_mov_b32 s24, 0
Lsl_pass:
    s_mov_b32 s25, 0
Lsl_kb:
    s_lshr_b32 s12, s25, 2
    s_add_u32 s12, s12, s9
    s_and_b32 s12, s12, 7
    s_lshl_b32 s12, s12, 1
    s_add_u32 s12, s12, s11
    s_mul_i32 s12, s12, 9216
    s_add_u32 s12, s12, 458752
    s_and_b32 s13, s25, 3
    s_lshl_b32 s14, s13, 10
    s_add_u32 s14, s14, s12
    buffer_load_dwordx4 v[96:99], v4, s[44:47], s14 offen sc1
    s_lshl_b32 s14, s13, 2
    s_add_u32 s14, s14, s12
    s_add_u32 s14, s14, 8704
    s_mov_b32 exec_hi, 0
    buffer_load_dword v104, v5, s[44:47], s14 offen sc1
    s_mul_i32 s14, s13, 1152
    s_add_u32 s14, s14, s12
    s_add_u32 s14, s14, 4096
    s_mov_b64 exec, s[36:37]
    buffer_load_dwordx4 v[112:115], v6, s[44:47], s14 offen sc1
    buffer_load_dwordx4 v[116:119], v6, s[44:47], s14 offen offset:576 sc1
    s_mov_b64 exec, -1
    s_waitcnt vmcnt(0)
    v_mfma_f32_32x32x16_bf16 v[16:31], v[96:99], v[80:83], 0
    v_mfma_f32_32x32x8_bf16 v[16:31], v[104:105], v[88:89], v[16:31]
    v_mfma_f32_32x32x16_bf16 v[32:47], v[96:99], v[84:87], 0
    v_mfma_f32_32x32x8_bf16 v[32:47], v[104:105], v[92:93], v[32:47]
    s_cmp_eq_u32 s24, 0
    s_cbranch_scc0 Lsl_p2
    s_nop 7
    v_max3_f32 v8, v8, v16, v17
    v_max3_f32 v8, v8, v18, v19
    v_max3_f32 v8, v8, v20, v21
    v_max3_f32 v8, v8, v22, v23
    v_max3_f32 v8, v8, v24, v25
    v_max3_f32 v8, v8, v26, v27
    v_max3_f32 v8, v8, v28, v29
    v_max3_f32 v8, v8, v30, v31
    v_max3_f32 v9, v9, v32, v33
    v_max3_f32 v9, v9, v34, v35
    v_max3_f32 v9, v9, v36, v37
    v_max3_f32 v9, v9, v38, v39
    v_max3_f32 v9, v9, v40, v41
    v_max3_f32 v9, v9, v42, v43
    v_max3_f32 v9, v9, v44, v45
    v_max3_f32 v9, v9, v46, v47
    s_branch Lsl_next
Lsl_p2:
    s_nop 11
    v_add_f32 v16, v128, v16
    v_exp_f32 v16, v16
    v_add_f32 v17, v128, v17
    v_exp_f32 v17, v17
    v_add_f32 v18, v128, v18
    v_exp_f32 v18, v18
    v_add_f32 v19, v128, v19
    v_exp_f32 v19, v19
    v_add_f32 v20, v128, v20
    v_exp_f32 v20, v20
    v_add_f32 v21, v128, v21
    v_exp_f32 v21, v21
    v_add_f32 v22, v128, v22
    v_exp_f32 v22, v22
    v_add_f32 v23, v128, v23
    v_exp_f32 v23, v23
    v_add_f32 v24, v128, v24
    v_exp_f32 v24, v24
    v_add_f32 v25, v128, v25
    v_exp_f32 v25, v25
    v_add_f32 v26, v128, v26
    v_exp_f32 v26, v26
    v_add_f32 v27, v128, v27
    v_exp_f32 v27, v27
    v_add_f32 v28, v128, v28
    v_exp_f32 v28, v28
    v_add_f32 v29, v128, v29
    v_exp_f32 v29, v29
    v_add_f32 v30, v128, v30
    v_exp_f32 v30, v30
    v_add_f32 v31, v128, v31
    v_exp_f32 v31, v31
    v_smfmac_f32_32x32x32_bf16 v[48:63], v[112:115], v[16:23], v130
    s_nop 0
    v_smfmac_f32_32x32x32_bf16 v[48:63], v[116:119], v[24:31], v130
    v_add_f32 v32, v129, v32
    v_exp_f32 v32, v32
    v_add_f32 v33, v129, v33
    v_exp_f32 v33, v33
    v_add_f32 v34, v129, v34
    v_exp_f32 v34, v34
    v_add_f32 v35, v129, v35
    v_exp_f32 v35, v35
    v_add_f32 v36, v129, v36
    v_exp_f32 v36, v36
    v_add_f32 v37, v129, v37
    v_exp_f32 v37, v37
    v_add_f32 v38, v129, v38
    v_exp_f32 v38, v38
    v_add_f32 v39, v129, v39
    v_exp_f32 v39, v39
    v_add_f32 v40, v129, v40
    v_exp_f32 v40, v40
    v_add_f32 v41, v129, v41
    v_exp_f32 v41, v41
    v_add_f32 v42, v129, v42
    v_exp_f32 v42, v42
    v_add_f32 v43, v129, v43
    v_exp_f32 v43, v43
    v_add_f32 v44, v129, v44
    v_exp_f32 v44, v44
    v_add_f32 v45, v129, v45
    v_exp_f32 v45, v45
    v_add_f32 v46, v129, v46
    v_exp_f32 v46, v46
    v_add_f32 v47, v129, v47
    v_exp_f32 v47, v47
    v_smfmac_f32_32x32x32_bf16 v[64:79], v[112:115], v[32:39], v130
    s_nop 0
    v_smfmac_f32_32x32x32_bf16 v[64:79], v[116:119], v[40:47], v130
Lsl_next:
    s_add_u32 s25, s25, 1
    s_cmp_lt_u32 s25, 32
    s_cbranch_scc1 Lsl_kb
    s_cmp_eq_u32 s24, 0
    s_cbranch_scc0 Lsl_done
    v_mov_b32 v16, v8
    s_nop 1
    v_permlane32_swap_b32 v8, v16
    v_max_f32 v8, v8, v16
    v_sub_f32 v128, 0, v8
    v_mov_b32 v32, v9
    s_nop 1
    v_permlane32_swap_b32 v9, v32
    v_max_f32 v9, v9, v32
    v_sub_f32 v129, 0, v9
    s_mov_b32 s24, 1
    s_branch Lsl_pass
Lsl_done:
    s_nop 11
    s_cmp_eq_u32 s11, 0
    s_cbranch_scc1 Lchecked
    v_min_f32 v16, v155, v128
    v_sub_f32 v17, v16, v155
    v_exp_f32 v17, v17
    v_sub_f32 v18, v16, v128
    v_exp_f32 v18, v18
    v_mul_f32 v144, v144, v17
    v_mul_f32 v48, v48, v18
    v_mul_f32 v145, v145, v17
    v_mul_f32 v49, v49, v18
    v_mul_f32 v146, v146, v17
    v_mul_f32 v50, v50, v18
    v_mul_f32 v147, v147, v17
    v_mul_f32 v51, v51, v18
    v_mul_f32 v148, v148, v17
    v_mul_f32 v52, v52, v18
    v_mul_f32 v149, v149, v17
    v_mul_f32 v53, v53, v18
    v_mul_f32 v150, v150, v17
    v_mul_f32 v54, v54, v18
    v_mul_f32 v151, v151, v17
    v_mul_f32 v55, v55, v18
    v_mul_f32 v152, v152, v17
    v_mul_f32 v56, v56, v18
    v_mul_f32 v153, v153, v17
    v_mul_f32 v57, v57, v18
    v_mul_f32 v154, v154, v17
    v_mul_f32 v58, v58, v18
    v_cndmask_b32 v96, v56, v58, vcc
    v_min_f32 v32, v167, v129
    v_sub_f32 v33, v32, v167
    v_exp_f32 v33, v33
    v_sub_f32 v34, v32, v129
    v_exp_f32 v34, v34
    v_mul_f32 v156, v156, v33
    v_mul_f32 v64, v64, v34
    v_mul_f32 v157, v157, v33
    v_mul_f32 v65, v65, v34
    v_mul_f32 v158, v158, v33
    v_mul_f32 v66, v66, v34
    v_mul_f32 v159, v159, v33
    v_mul_f32 v67, v67, v34
    v_mul_f32 v160, v160, v33
    v_mul_f32 v68, v68, v34
    v_mul_f32 v161, v161, v33
    v_mul_f32 v69, v69, v34
    v_mul_f32 v162, v162, v33
    v_mul_f32 v70, v70, v34
    v_mul_f32 v163, v163, v33
    v_mul_f32 v71, v71, v34
    v_mul_f32 v164, v164, v33
    v_mul_f32 v72, v72, v34
    v_mul_f32 v165, v165, v33
    v_mul_f32 v73, v73, v34
    v_mul_f32 v166, v166, v33
    v_mul_f32 v74, v74, v34
    v_cndmask_b32 v98, v72, v74, vcc
    s_nop 1
    s_branch Lchecked
Lend:
    s_endpgm
.section .rodata,"a"
.p2align 6
.amdhsa_kernel gated_mix__spectral_fnet__grouped_kv_mqa__prompt_kernel
  .amdhsa_next_free_vgpr 168
  .amdhsa_next_free_sgpr 100
  .amdhsa_accum_offset 168
  .amdhsa_group_segment_fixed_size 0
  .amdhsa_kernarg_size 112
  .amdhsa_user_sgpr_count 2
  .amdhsa_user_sgpr_kernarg_segment_ptr 1
  .amdhsa_system_sgpr_workgroup_id_x 1
.end_amdhsa_kernel
```
